```python
import torch

def _softmax(x, axis=-1):
    return torch.softmax(x, dim=axis)
def _gelu(x):
    return torch.nn.functional.gelu(x, approximate="tanh")
def _silu(x):
    return torch.nn.functional.silu(x)
def _sigmoid(x):
    return torch.sigmoid(x)
def _layernorm(x, axis=-1, eps=1e-5):
    m = x.mean(dim=axis, keepdim=True)
    v = x.var(dim=axis, keepdim=True, unbiased=False)
    return (x - m) / torch.sqrt(v + eps)
def _scatter_add(tgt, idx, src, axis=0):
    return tgt.clone().index_add_(axis, idx, src)
def _segment_sum(src, seg, n):
    out = torch.zeros((n,) + src.shape[1:], dtype=src.dtype)
    return out.index_add_(0, seg, src)
def _pad(x, pw):
    flat = tuple(v for pair in reversed(pw) for v in pair)
    return torch.nn.functional.pad(x, flat)

kernel_name = 'sequential_preLN__spectral_fnet__geglu_ffn__prompt'

def setup_inputs():

    _w = (lambda a: (lambda t: t.to(torch.bfloat16) if t.is_floating_point() else t)(torch.as_tensor(a)))
    def _A_setup():
        B, S, D = 1, 2048, 640
        ns = torch.arange(S)[:, None] * torch.arange(S)[None, :]
        nd = torch.arange(D)[:, None] * torch.arange(D)[None, :]
        Ws_re = torch.cos(-2.0 * torch.pi * ns / S).to(float)
        Ws_im = torch.sin(-2.0 * torch.pi * ns / S).to(float)
        Wd_re = torch.cos(-2.0 * torch.pi * nd / D).to(float)
        Wd_im = torch.sin(-2.0 * torch.pi * nd / D).to(float)
        return {
            "x": _w((lambda *s: torch.randn(*s, dtype=torch.bfloat16) * 0.05)(B, S, D)),
            "dft_seq_re": _w(Ws_re),
            "dft_seq_im": _w(Ws_im),
            "dft_hid_re": _w(Wd_re),
            "dft_hid_im": _w(Wd_im),
        }
    _A_in = _A_setup()

    def _B_setup():
        B, S, D, F = 1, 2048, 640, 1536
        return {
            "x": _w((lambda *s: torch.randn(*s, dtype=torch.bfloat16) * 0.05)(B, S, D)),
            "w_gate": _w((lambda *s: torch.randn(*s, dtype=torch.bfloat16) * 0.2)(D, F)),
            "w_up": _w((lambda *s: torch.randn(*s, dtype=torch.bfloat16) * 0.2)(D, F)),
            "w_down": _w((lambda *s: torch.randn(*s, dtype=torch.bfloat16) * 0.2)(F, D)),
        }
    _B_in = _B_setup()

    return {
        "A_x": _A_in["x"],
        "A_dft_seq_re": _A_in["dft_seq_re"],
        "A_dft_seq_im": _A_in["dft_seq_im"],
        "A_dft_hid_re": _A_in["dft_hid_re"],
        "A_dft_hid_im": _A_in["dft_hid_im"],
        "B_x": _B_in["x"],
        "B_w_gate": _B_in["w_gate"],
        "B_w_up": _B_in["w_up"],
        "B_w_down": _B_in["w_down"],
    }

def reference(A_x, A_dft_seq_re, A_dft_seq_im, A_dft_hid_re, A_dft_hid_im, B_x, B_w_gate, B_w_up, B_w_down):
    def _A_ref(x, dft_seq_re, dft_seq_im, dft_hid_re, dft_hid_im):
        a = torch.einsum("bsd,ed->bse", x, dft_hid_re)
        b = torch.einsum("bsd,ed->bse", x, dft_hid_im)
        y = torch.einsum("ts,bse->bte", dft_seq_re, a) - torch.einsum("ts,bse->bte", dft_seq_im, b)
        return y

    def _B_ref(x, w_gate, w_up, w_down):
        return (_gelu(x @ w_gate) * (x @ w_up)) @ w_down

    x = A_x
    h = x + _A_ref(_layernorm(x, axis=-1), A_dft_seq_re, A_dft_seq_im, A_dft_hid_re, A_dft_hid_im)
    h2 = h + _B_ref(_layernorm(h, axis=-1), B_w_gate, B_w_up, B_w_down)
    return h2
```

```asm
; @launch kernel=kf_kernel grid=(256,1,1) block=(256,1,1) lds=163840
.amdgcn_target "amdgcn-amd-amdhsa--gfx950"
.text
.globl kf_kernel
.p2align 8
.type kf_kernel,@function
kf_kernel:
    s_cmp_ge_u32 s2, 256
    s_cbranch_scc1 kf_end
    s_mov_b32 s70, 0
    s_mov_b32 s23, s2
k1_body:
    s_load_dwordx2 s[4:5], s[0:1], 0
    s_load_dwordx4 s[8:11], s[0:1], 24
    s_load_dwordx2 s[6:7], s[0:1], 88
    s_load_dwordx4 s[56:59], s[0:1], 8
    s_load_dwordx4 s[12:15], s[0:1], 48
    s_load_dwordx2 s[36:37], s[0:1], 64
    v_lshrrev_b32 v4, 6, v0
    v_and_b32 v1, 63, v0
    v_readfirstlane_b32 s16, v4
    v_and_b32 v2, 15, v1
    v_lshrrev_b32 v3, 4, v1
    s_getpc_b64 s[96:97]
    ct_pc1:
    s_sub_u32 s96, s96, ct_pc1-kf_kernel
    s_subb_u32 s97, s97, 0
    s_mov_b32 s98, code_end-kf_kernel
    s_mov_b32 s99, 0x20000
    s_lshr_b32 s21, s2, 3
    s_lshl_b32 s21, s21, 11
    v_bfe_u32 v154, v0, 3, 2
    v_lshl_add_u32 v154, v4, 2, v154
    v_lshlrev_b32 v154, 7, v154
    v_add_u32 v154, s21, v154
    v_lshlrev_b32 v155, 10, v1
    v_and_b32 v155, 0x8000, v155
    v_xor_b32 v154, v154, v155
    buffer_load_dword v155, v154, s[96:99], 0 offen
    s_and_b32 s17, s23, 1
    s_bfe_u32 s19, s23, 0x20001
    s_bfe_u32 s21, s23, 0x20003
    s_lshl_b32 s19, s19, 2
    s_add_u32 s19, s19, s21
    s_lshr_b32 s20, s23, 5
    s_lshl_b32 s3, s17, 3
    s_add_u32 s3, s3, s20
    v_lshlrev_b32 v8, 4, v1
    s_mul_i32 s48, s20, 5
    s_lshr_b32 s48, s48, 3
    s_add_u32 s48, s48, 2
    v_lshrrev_b32 v25, 3, v1
    v_and_b32 v26, 7, v1
    v_xor_b32 v26, v26, v25
    v_mul_u32_u24 v25, 1280, v25
    v_lshl_add_u32 v25, v26, 4, v25
    s_mul_i32 s21, s20, 102400
    s_and_b32 s22, s16, 1
    s_mul_i32 s22, s22, 10240
    s_add_u32 s21, s21, s22
    s_lshr_b32 s22, s16, 1
    s_lshl_b32 s18, s22, 7
    s_xor_b32 s91, s18, 128
    s_add_u32 s21, s21, s18
    v_add_u32 v148, s21, v25
    s_lshl_b32 s21, s19, 7
    s_lshl_b32 s22, s16, 5
    s_add_u32 s21, s21, s22
    s_mul_i32 s21, s21, 1280
    v_add_u32 v144, s21, v25
    v_add_u32 v145, 9216, v144
    v_add_u32 v146, 18432, v144
    v_add_u32 v147, 27648, v144
    s_mul_i32 s46, s16, 40960
    s_mul_i32 s49, s48, 205
    s_lshr_b32 s49, s49, 10
    s_mul_i32 s49, s49, 5
    s_sub_u32 s49, s48, s49
    s_lshl_b32 s50, s49, 8
    s_add_u32 s49, s49, 1
    s_cmp_ge_u32 s49, 5
    s_cselect_b32 s49, 0, s49
    s_lshl_b32 s51, s49, 8
    s_add_u32 s49, s49, 1
    s_cmp_ge_u32 s49, 5
    s_cselect_b32 s49, 0, s49
    s_lshl_b32 s52, s49, 8
    s_add_u32 s49, s49, 1
    s_cmp_ge_u32 s49, 5
    s_cselect_b32 s49, 0, s49
    s_lshl_b32 s53, s49, 8
    s_add_u32 s49, s49, 1
    s_cmp_ge_u32 s49, 5
    s_cselect_b32 s49, 0, s49
    s_lshl_b32 s54, s49, 8
    s_add_u32 s49, s49, 1
    s_cmp_ge_u32 s49, 5
    s_cselect_b32 s49, 0, s49
    s_bitcmp1_b32 s19, 0
    s_mov_b32 s49, s50
    s_cselect_b32 s50, s51, s50
    s_cselect_b32 s51, s52, s51
    s_cselect_b32 s52, s49, s52
    s_bitcmp1_b32 s19, 1
    s_mov_b32 s49, s52
    s_cselect_b32 s52, s51, s52
    s_cselect_b32 s51, s50, s51
    s_cselect_b32 s50, s49, s50
    s_mov_b32 s26, 2621440
    s_mov_b32 s27, 0x20000
    s_mov_b32 s30, 819200
    s_mov_b32 s31, 0x20000
    s_cmp_eq_u32 s17, 0
    s_waitcnt lgkmcnt(0)
    s_cselect_b32 s28, s8, s10
    s_cselect_b32 s29, s9, s11
    s_mov_b64 s[24:25], s[4:5]
    s_add_u32 m0, s46, 31744
    s_add_u32 s83, s50, 0
    buffer_load_dwordx4 v148, s[28:31], s83 offen offset:0 lds
    s_lshl_b32 s22, s19, 19
    s_load_dword s100, s[56:57], s22
    s_load_dword s100, s[58:59], s22
    s_load_dword s100, s[12:13], 0
    s_load_dword s100, s[14:15], 0
    s_load_dword s100, s[36:37], 0
    s_mov_b32 s22, 1966016
    s_load_dword s100, s[12:13], s22
    s_load_dword s100, s[14:15], s22
    s_load_dword s100, s[36:37], s22
    s_add_u32 s83, s50, 19456
    buffer_load_dwordx4 v148, s[28:31], s83 offen offset:1024 lds
    s_add_u32 s83, s50, 38912
    buffer_load_dwordx4 v148, s[28:31], s83 offen offset:2048 lds
    s_add_u32 s83, s50, 58368
    buffer_load_dwordx4 v148, s[28:31], s83 offen offset:3072 lds
    s_add_u32 m0, s46, 35840
    s_add_u32 s83, s50, 81920
    buffer_load_dwordx4 v148, s[28:31], s83 offen offset:0 lds
    s_add_u32 m0, s46, 10240
    s_add_u32 s82, s50, s18
    buffer_load_dwordx4 v144, s[24:27], s82 offen offset:0 lds
    buffer_load_dwordx4 v145, s[24:27], s82 offen offset:1024 lds
    buffer_load_dwordx4 v146, s[24:27], s82 offen offset:2048 lds
    buffer_load_dwordx4 v147, s[24:27], s82 offen offset:3072 lds
    s_add_u32 m0, s46, 14336
    s_add_u32 s82, s50, s91
    buffer_load_dwordx4 v144, s[24:27], s82 offen offset:0 lds
    s_mov_b64 s[64:65], s[6:7]
    s_mov_b32 s66, 0x10000000
    s_mov_b32 s67, 0x20000
    v_mov_b32 v156, -1
    v_mov_b32 v157, -1
    v_mov_b32 v158, -1
    v_mov_b32 v159, -1
    buffer_load_dwordx4 v145, s[24:27], s82 offen offset:1024 lds
    s_cmp_lg_u32 s70, 0
    s_cbranch_scc1 k1_par
    s_mov_b32 s76, s3
    s_mov_b32 s73, s3
    s_mov_b32 s71, 0
    s_mov_b32 s72, 2
    s_mov_b32 s74, 5242880
    s_mov_b32 s69, 400
    k1_par:
    buffer_load_dwordx4 v146, s[24:27], s82 offen offset:2048 lds
    s_cmp_eq_u32 s17, 0
    s_cselect_b32 s56, s56, s58
    s_cselect_b32 s57, s57, s59
    s_sub_u32 s56, s56, 4096
    s_subb_u32 s57, s57, 0
    s_mov_b32 s58, 8392704
    s_mov_b32 s59, 0x20000
    buffer_load_dwordx4 v147, s[24:27], s82 offen offset:3072 lds
    v_lshlrev_b32 v14, 6, v1
    s_add_u32 s21, s16, s20
    s_and_b32 s21, s21, 3
    s_lshl_b32 s21, s21, 8
    v_add_u32 v14, s21, v14
    v_and_b32 v14, 0x3c0, v14
    s_lshl_b32 s61, s16, 10
    v_add_u32 v14, s61, v14
    s_lshl_b32 s60, s3, 12
    s_add_u32 s60, s60, 29360128
    s_add_u32 s61, s60, s61
    s_add_u32 m0, s46, 0
    s_add_u32 s83, s51, 0
    buffer_load_dwordx4 v148, s[28:31], s83 offen offset:0 lds
    s_lshr_b32 s21, s3, 3
    s_lshl4_add_u32 s21, s19, s21
    s_lshl2_add_u32 s21, s21, s16
    s_lshl_b32 s94, s21, 11
    s_add_u32 s94, s94, 14680064
    s_cmp_eq_u32 s70, 0
    s_cselect_b32 s61, s61, 27262976
    s_cselect_b32 s94, s94, 27262976
    s_add_u32 s83, s51, 19456
    buffer_load_dwordx4 v148, s[28:31], s83 offen offset:1024 lds
    buffer_store_dwordx4 v[156:159], v8, s[64:67], s61 offen sc1
    buffer_store_dwordx4 v[156:159], v8, s[64:67], s94 offen sc1
    buffer_store_dwordx4 v[156:159], v8, s[64:67], s94 offen offset:1024 sc1
    v_and_b32 v26, 7, v2
    v_xor_b32 v25, v26, v3
    v_lshlrev_b32 v25, 4, v25
    s_and_b32 s21, s16, 1
    s_lshl_b32 s21, s21, 6
    v_xor_b32 v25, s21, v25
    v_lshl_add_u32 v238, v2, 7, v25
    v_add_u32 v238, s46, v238
    v_xor_b32 v239, 64, v238
    s_add_u32 s83, s51, 38912
    buffer_load_dwordx4 v148, s[28:31], s83 offen offset:2048 lds
    v_lshl_add_u32 v25, v26, 7, v25
    v_lshrrev_b32 v26, 3, v2
    v_mul_u32_u24 v26, 40960, v26
    v_add_u32 v25, v25, v26
    s_mul_i32 s21, s18, 640
    v_add_u32 v240, s21, v25
    s_mul_i32 s21, s91, 640
    v_add_u32 v242, s21, v25
    s_add_u32 s83, s51, 58368
    buffer_load_dwordx4 v148, s[28:31], s83 offen offset:3072 lds
    v_xor_b32 v241, 64, v240
    v_xor_b32 v243, 64, v242
    v_mov_b32 v248, 0x3f803f80
    v_mov_b32 v249, 0x3f803f80
    v_mov_b32 v250, 0x3f803f80
    v_mov_b32 v251, 0x3f803f80
    s_add_u32 m0, s46, 4096
    s_add_u32 s83, s51, 81920
    buffer_load_dwordx4 v148, s[28:31], s83 offen offset:0 lds
    s_mov_b32 s39, 0x20000
    s_cmp_ge_u32 s19, 10
    s_cbranch_scc1 k1_pdn
    s_mov_b64 s[36:37], s[12:13]
    v_bfe_u32 v224, v1, 3, 2
    v_and_b32 v225, 3, v1
    v_lshrrev_b32 v226, 5, v1
    v_mul_u32_u24 v253, 24576, v224
    v_lshl_add_u32 v253, v225, 4, v253
    v_mul_u32_u24 v227, 12288, v226
    v_add_u32 v253, v253, v227
    v_bfe_u32 v227, v1, 2, 1
    v_mul_u32_u24 v227, 98304, v227
    v_add_u32 v253, v253, v227
    s_mul_i32 s49, s3, 3
    s_add_u32 s49, s49, s16
    s_mul_i32 s8, s19, 196608
    s_lshl_b32 s9, s49, 6
    s_add_u32 s8, s8, s9
    s_mov_b32 s9, s8
    s_mov_b32 s10, 3072
    v_and_b32 v225, 7, v1
    v_mul_u32_u24 v225, 1056, v225
    v_lshl_add_u32 v225, v224, 8, v225
    v_lshl_add_u32 v160, v226, 3, v225
    s_mov_b32 s4, 64
    s_mov_b32 s5, 32
    s_mul_i32 s87, s49, 81920
    s_lshl_b32 s92, s19, 11
    s_add_u32 s87, s87, s92
    s_add_u32 s87, s87, 16777216
    s_mov_b32 s88, 20480
    s_mov_b32 s92, -60416
    s_branch k1_pk
    k1_pdn:
    s_mul_i32 s11, s3, 5
    s_add_u32 s11, s11, s19
    s_mul_i32 s11, s11, 3
    s_add_u32 s11, s11, s16
    s_sub_u32 s11, s11, 30
    s_mul_i32 s49, s11, 43691
    s_lshr_b32 s49, s49, 21
    s_mul_i32 s92, s49, 48
    s_sub_u32 s92, s11, s92
    s_mov_b64 s[14:15], s[36:37]
    v_mul_u32_u24 v253, 10240, v3
    v_lshl_add_u32 v253, v2, 4, v253
    s_mul_i32 s8, s92, 40960
    s_lshl_b32 s9, s49, 8
    s_add_u32 s8, s8, s9
    s_add_u32 s9, s8, 5120
    s_mov_b32 s10, 1280
    v_lshrrev_b32 v225, 1, v2
    v_mul_u32_u24 v225, 1056, v225
    v_and_b32 v227, 1, v2
    v_lshlrev_b32 v227, 7, v227
    v_lshl_add_u32 v227, v3, 8, v227
    v_xor_b32 v160, v227, v225
    s_mov_b32 s4, 32
    s_mov_b32 s5, 8
    s_mul_i32 s87, s49, 393216
    s_lshl_b32 s92, s92, 10
    s_add_u32 s87, s87, s92
    s_add_u32 s87, s87, 20971520
    s_mov_b32 s88, 49152
    s_mov_b32 s92, 49152
    k1_pk:
    s_cmp_lt_u32 s19, 15
    s_cselect_b32 s95, -1, 0
    s_cmp_lt_u32 s16, 3
    s_cselect_b32 s95, s95, 0
    s_and_b32 s38, s95, 1966080
    s_and_b32 s8, s8, s95
    s_and_b32 s9, s9, s95
    s_and_b32 s10, s10, s95
    s_and_b32 s92, s92, s95
    s_and_b32 s88, s88, s95
    s_cselect_b32 s87, s87, 27262976
    s_add_u32 s11, s46, 32768
    v_add_u32 v160, s11, v160
    v_xor_b32 v161, s4, v160
    s_lshl_b32 s4, s4, 1
    v_xor_b32 v162, s4, v160
    v_xor_b32 v163, s4, v161
    v_xor_b32 v164, s5, v160
    v_xor_b32 v165, s5, v161
    v_xor_b32 v166, s5, v162
    v_xor_b32 v167, s5, v163
    s_mov_b32 s89, 0x05040100
    s_mov_b32 s90, 0x07060302
    v_mul_u32_u24 v244, 40960, v3
    v_lshl_add_u32 v244, v2, 4, v244
    s_lshl_b32 s21, s16, 2
    v_add_u32 v244, s21, v244
    v_lshlrev_b32 v245, 4, v2
    v_add_u32 v245, s46, v245
    v_lshlrev_b32 v247, 4, v3
    v_add_u32 v247, s46, v247
    v_lshrrev_b32 v246, 1, v3
    v_lshlrev_b32 v246, 7, v246
    v_lshl_add_u32 v246, v2, 2, v246
    s_add_u32 s21, s46, 11520
    v_add_u32 v246, s21, v246
    v_lshrrev_b32 v254, 2, v2
    v_xor_b32 v254, v254, v3
    v_and_b32 v254, 1, v254
    v_lshl_add_u32 v246, v254, 8, v246
    s_mov_b32 vcc_lo, 0xaaaaaaaa
    s_mov_b32 vcc_hi, 0xaaaaaaaa
    s_mov_b32 s4, 0xcccccccc
    s_mov_b32 s5, 0xcccccccc
    s_mov_b32 s12, 0xff00ff00
    s_mov_b32 s13, 0xff00ff00
    v_and_b32 v252, 1, v3
    v_lshlrev_b32 v252, 9, v252
    v_lshrrev_b32 v254, 1, v3
    v_lshl_add_u32 v252, v254, 8, v252
    v_lshl_add_u32 v252, v2, 4, v252
    s_lshl_b32 s21, s19, 2
    s_add_u32 s49, s21, s16
    s_lshl_b32 s49, s49, 10
    s_mul_i32 s21, s3, 327680
    s_add_u32 s49, s49, s21
    buffer_load_dwordx4 v[192:195], v253, s[36:39], s8 offen
    s_add_u32 s8, s8, s10
    buffer_load_dwordx4 v[196:199], v253, s[36:39], s8 offen
    s_add_u32 s8, s8, s10
    buffer_load_dwordx4 v[200:203], v253, s[36:39], s8 offen
    s_add_u32 s8, s8, s10
    buffer_load_dwordx4 v[204:207], v253, s[36:39], s8 offen
    s_mov_b64 s[36:37], s[14:15]
    buffer_load_dwordx4 v[208:211], v253, s[36:39], s9 offen
    s_add_u32 s9, s9, s10
    buffer_load_dwordx4 v[212:215], v253, s[36:39], s9 offen
    s_add_u32 s9, s9, s10
    buffer_load_dwordx4 v[216:219], v253, s[36:39], s9 offen
    s_add_u32 s9, s9, s10
    buffer_load_dwordx4 v[220:223], v253, s[36:39], s9 offen
    s_waitcnt vmcnt(20)
    s_barrier
    ds_read_b128 v[112:115], v238 offset:10240
    ds_read_b128 v[120:123], v238 offset:12288
    ds_read_b128 a[0:3], v240 offset:31744
    ds_read_b128 a[8:11], v240 offset:32768
    ds_read_b128 a[16:19], v240 offset:33792
    ds_read_b128 a[24:27], v240 offset:34816
    ds_read_b128 a[32:35], v240 offset:35840
    ds_read_b128 v[116:119], v239 offset:10240
    ds_read_b128 v[124:127], v239 offset:12288
    ds_read_b128 a[4:7], v241 offset:31744
    ds_read_b128 a[12:15], v241 offset:32768
    ds_read_b128 a[20:23], v241 offset:33792
    ds_read_b128 a[28:31], v241 offset:34816
    ds_read_b128 a[36:39], v241 offset:35840
    s_waitcnt lgkmcnt(0)
    v_mfma_f32_16x16x32_bf16 v[96:99], v[112:115], v[112:115], 0
    s_add_u32 m0, s46, 23552
    s_lshl_b32 s21, s19, 3
    ds_read_b128 a[40:43], v242 offset:31744
    v_mfma_f32_16x16x32_bf16 v[92:95], v[248:251], v[112:115], 0
    s_add_u32 s82, s51, s18
    s_add_u32 s21, s21, s20
    ds_read_b128 a[48:51], v242 offset:32768
    v_mfma_f32_16x16x32_bf16 v[104:107], v[120:123], v[120:123], 0
    s_lshl_b32 s21, s21, 2
    s_add_u32 s21, s21, s16
    ds_read_b128 a[56:59], v242 offset:33792
    v_mfma_f32_16x16x32_bf16 v[100:103], v[248:251], v[120:123], 0
    s_lshl_b32 s55, s21, 14
    s_add_u32 s55, s55, 4096
    ds_read_b128 a[64:67], v242 offset:34816
    v_mfma_f32_16x16x32_bf16 v[72:75], v[248:251], a[0:3], 0
    buffer_load_dwordx4 v144, s[24:27], s82 offen offset:0 lds
    v_mfma_f32_16x16x32_bf16 v[76:79], v[248:251], a[8:11], 0
    ds_read_b128 a[72:75], v242 offset:35840
    v_lshrrev_b32 v154, 2, v1
    v_mfma_f32_16x16x32_bf16 v[80:83], v[248:251], a[16:19], 0
    ds_read_b128 a[44:47], v243 offset:31744
    v_lshlrev_b32 v154, 10, v154
    v_mfma_f32_16x16x32_bf16 v[84:87], v[248:251], a[24:27], 0
    ds_read_b128 a[52:55], v243 offset:32768
    v_and_b32 v254, 3, v1
    v_mfma_f32_16x16x32_bf16 v[88:91], v[248:251], a[32:35], 0
    ds_read_b128 a[60:63], v243 offset:33792
    v_lshl_add_u32 v154, v254, 7, v154
    v_mfma_f32_16x16x32_bf16 v[32:35], v[112:115], a[0:3], 0
    buffer_load_dwordx4 v145, s[24:27], s82 offen offset:1024 lds
    v_mfma_f32_16x16x32_bf16 v[52:55], v[120:123], a[0:3], 0
    ds_read_b128 a[68:71], v243 offset:34816
    v_lshrrev_b32 v4, 3, v1
    v_mfma_f32_16x16x32_bf16 v[36:39], v[112:115], a[8:11], 0
    ds_read_b128 a[76:79], v243 offset:35840
    v_and_b32 v5, 7, v1
    v_mfma_f32_16x16x32_bf16 v[56:59], v[120:123], a[8:11], 0
    buffer_load_dwordx4 v146, s[24:27], s82 offen offset:2048 lds
    v_mfma_f32_16x16x32_bf16 v[40:43], v[112:115], a[16:19], 0
    v_xor_b32 v5, v5, v4
    v_mul_u32_u24 v4, 4096, v4
    v_mfma_f32_16x16x32_bf16 v[60:63], v[120:123], a[16:19], 0
    v_lshl_add_u32 v4, v5, 4, v4
    v_mfma_f32_16x16x32_bf16 v[44:47], v[112:115], a[24:27], 0
    buffer_load_dwordx4 v147, s[24:27], s82 offen offset:3072 lds
    v_mfma_f32_16x16x32_bf16 v[64:67], v[120:123], a[24:27], 0
    s_mul_i32 s22, s19, 524288
    v_add_u32 v4, s22, v4
    v_mfma_f32_16x16x32_bf16 v[48:51], v[112:115], a[32:35], 0
    s_lshl_b32 s23, s16, 1
    s_add_u32 s22, s23, 2
    s_and_b32 s22, s22, 7
    v_mfma_f32_16x16x32_bf16 v[68:71], v[120:123], a[32:35], 0
    s_add_u32 m0, s46, 27648
    s_mul_i32 s22, s22, 65536
    s_add_u32 s22, s22, 4096
    v_mfma_f32_16x16x32_bf16 v[96:99], v[116:119], v[116:119], v[96:99]
    s_add_u32 s82, s51, s91
    v_add_u32 v16, s22, v4
    v_mfma_f32_16x16x32_bf16 v[92:95], v[248:251], v[116:119], v[92:95]
    buffer_load_dwordx4 v144, s[24:27], s82 offen offset:0 lds
    v_mfma_f32_16x16x32_bf16 v[104:107], v[124:127], v[124:127], v[104:107]
    s_add_u32 s22, s23, 2
    s_and_b32 s22, s22, 7
    s_mul_i32 s22, s22, 65536
    v_mfma_f32_16x16x32_bf16 v[100:103], v[248:251], v[124:127], v[100:103]
    s_add_u32 s22, s22, 35840
    v_add_u32 v17, s22, v4
    v_mfma_f32_16x16x32_bf16 v[32:35], v[116:119], a[4:7], v[32:35]
    s_waitcnt vmcnt(21)
    s_add_u32 s22, s23, 4
    ds_read_b128 v[128:131], v238 offset:14336
    v_mfma_f32_16x16x32_bf16 v[52:55], v[124:127], a[4:7], v[52:55]
    s_and_b32 s22, s22, 7
    s_mul_i32 s22, s22, 65536
    ds_read_b128 v[136:139], v238 offset:16384
    v_mfma_f32_16x16x32_bf16 v[36:39], v[116:119], a[12:15], v[36:39]
    s_add_u32 s22, s22, 2048
    ds_read_b128 v[132:135], v239 offset:14336
    v_add_u32 v18, s22, v4
    v_mfma_f32_16x16x32_bf16 v[56:59], v[124:127], a[12:15], v[56:59]
    s_add_u32 s22, s23, 4
    s_and_b32 s22, s22, 7
    ds_read_b128 v[140:143], v239 offset:16384
    v_mfma_f32_16x16x32_bf16 v[40:43], v[116:119], a[20:23], v[40:43]
    buffer_load_dwordx4 v145, s[24:27], s82 offen offset:1024 lds
    v_mfma_f32_16x16x32_bf16 v[60:63], v[124:127], a[20:23], v[60:63]
    s_mul_i32 s22, s22, 65536
    v_mfma_f32_16x16x32_bf16 v[44:47], v[116:119], a[28:31], v[44:47]
    buffer_load_dwordx4 v146, s[24:27], s82 offen offset:2048 lds
    v_mfma_f32_16x16x32_bf16 v[64:67], v[124:127], a[28:31], v[64:67]
    v_mfma_f32_16x16x32_bf16 v[48:51], v[116:119], a[36:39], v[48:51]
    v_mfma_f32_16x16x32_bf16 v[68:71], v[124:127], a[36:39], v[68:71]
    s_waitcnt vmcnt(15) lgkmcnt(0)
    s_barrier
    v_mfma_f32_16x16x32_bf16 v[96:99], v[128:131], v[128:131], v[96:99]
    s_add_u32 s22, s22, 33792
    ds_read_b128 a[0:3], v240 offset:0
    v_add_u32 v19, s22, v4
    v_mfma_f32_16x16x32_bf16 v[92:95], v[248:251], v[128:131], v[92:95]
    s_add_u32 s22, s23, 6
    s_and_b32 s22, s22, 7
    ds_read_b128 a[8:11], v240 offset:1024
    v_mfma_f32_16x16x32_bf16 v[104:107], v[136:139], v[136:139], v[104:107]
    s_mul_i32 s22, s22, 65536
    s_add_u32 s22, s22, 4096
    ds_read_b128 a[16:19], v240 offset:2048
    v_mfma_f32_16x16x32_bf16 v[100:103], v[248:251], v[136:139], v[100:103]
    ds_read_b128 a[24:27], v240 offset:3072
    v_add_u32 v20, s22, v4
    v_mfma_f32_16x16x32_bf16 v[32:35], v[128:131], a[40:43], v[32:35]
    buffer_load_dwordx4 v147, s[24:27], s82 offen offset:3072 lds
    v_mfma_f32_16x16x32_bf16 v[52:55], v[136:139], a[40:43], v[52:55]
    s_add_u32 m0, s46, 5120
    s_add_u32 s22, s23, 6
    ds_read_b128 a[32:35], v240 offset:4096
    v_mfma_f32_16x16x32_bf16 v[36:39], v[128:131], a[48:51], v[36:39]
    s_add_u32 s83, s52, 0
    s_and_b32 s22, s22, 7
    ds_read_b128 a[4:7], v241 offset:0
    v_mfma_f32_16x16x32_bf16 v[56:59], v[136:139], a[48:51], v[56:59]
    s_mul_i32 s22, s22, 65536
    s_add_u32 s22, s22, 35840
    ds_read_b128 a[12:15], v241 offset:1024
    v_mfma_f32_16x16x32_bf16 v[40:43], v[128:131], a[56:59], v[40:43]
    ds_read_b128 a[20:23], v241 offset:2048
    v_add_u32 v21, s22, v4
    v_mfma_f32_16x16x32_bf16 v[60:63], v[136:139], a[56:59], v[60:63]
    buffer_load_dwordx4 v148, s[28:31], s83 offen offset:0 lds
    v_mfma_f32_16x16x32_bf16 v[44:47], v[128:131], a[64:67], v[44:47]
    s_add_u32 s83, s52, 19456
    s_add_u32 s22, s23, 8
    ds_read_b128 a[28:31], v241 offset:3072
    v_mfma_f32_16x16x32_bf16 v[64:67], v[136:139], a[64:67], v[64:67]
    s_and_b32 s22, s22, 7
    s_mul_i32 s22, s22, 65536
    ds_read_b128 a[36:39], v241 offset:4096
    v_mfma_f32_16x16x32_bf16 v[48:51], v[128:131], a[72:75], v[48:51]
    buffer_load_dwordx4 v148, s[28:31], s83 offen offset:1024 lds
    v_mfma_f32_16x16x32_bf16 v[68:71], v[136:139], a[72:75], v[68:71]
    s_add_u32 s83, s52, 38912
    s_add_u32 s22, s22, 2048
    v_add_u32 v22, s22, v4
    v_mfma_f32_16x16x32_bf16 v[96:99], v[132:135], v[132:135], v[96:99]
    buffer_load_dwordx4 v148, s[28:31], s83 offen offset:2048 lds
    v_mfma_f32_16x16x32_bf16 v[92:95], v[248:251], v[132:135], v[92:95]
    s_add_u32 s22, s23, 8
    s_and_b32 s22, s22, 7
    s_mul_i32 s22, s22, 65536
    v_mfma_f32_16x16x32_bf16 v[104:107], v[140:143], v[140:143], v[104:107]
    s_add_u32 s22, s22, 33792
    v_add_u32 v23, s22, v4
    v_mfma_f32_16x16x32_bf16 v[100:103], v[248:251], v[140:143], v[100:103]
    s_mul_i32 s22, s3, 327680
    v_add_u32 v24, s22, v8
    v_add_u32 v25, 65536, v24
    v_mfma_f32_16x16x32_bf16 v[32:35], v[132:135], a[44:47], v[32:35]
    s_waitcnt vmcnt(7)
    ds_read_b128 v[112:115], v238 offset:23552
    v_add_u32 v26, 131072, v24
    v_mfma_f32_16x16x32_bf16 v[52:55], v[140:143], a[44:47], v[52:55]
    s_add_u32 s83, s52, 58368
    ds_read_b128 v[120:123], v238 offset:25600
    v_add_u32 v27, 196608, v24
    v_mfma_f32_16x16x32_bf16 v[36:39], v[132:135], a[52:55], v[36:39]
    ds_read_b128 v[116:119], v239 offset:23552
    v_add_u32 v28, 262144, v24
    v_mfma_f32_16x16x32_bf16 v[56:59], v[140:143], a[52:55], v[56:59]
    s_mul_i32 s41, s17, 65536
    s_sub_u32 s40, 65536, s41
    ds_read_b128 v[124:127], v239 offset:25600
    v_mfma_f32_16x16x32_bf16 v[40:43], v[132:135], a[60:63], v[40:43]
    buffer_load_dwordx4 v148, s[28:31], s83 offen offset:3072 lds
    v_mfma_f32_16x16x32_bf16 v[60:63], v[140:143], a[60:63], v[60:63]
    s_add_u32 m0, s46, 9216
    s_lshl_b32 s22, s16, 10
    s_add_u32 s40, s40, s22
    v_mfma_f32_16x16x32_bf16 v[44:47], v[132:135], a[68:71], v[44:47]
    s_add_u32 s83, s52, 81920
    s_add_u32 s41, s41, s22
    s_lshl_b32 s47, s16, 14
    v_mfma_f32_16x16x32_bf16 v[64:67], v[140:143], a[68:71], v[64:67]
    buffer_load_dwordx4 v148, s[28:31], s83 offen offset:0 lds
    v_mfma_f32_16x16x32_bf16 v[48:51], v[132:135], a[76:79], v[48:51]
    s_add_u32 m0, s46, 36864
    s_add_u32 s55, s16, s20
    s_and_b32 s55, s55, 3
    v_mfma_f32_16x16x32_bf16 v[68:71], v[140:143], a[76:79], v[68:71]
    s_waitcnt lgkmcnt(0)
    s_lshl_b32 s55, s55, 8
    v_mfma_f32_16x16x32_bf16 v[96:99], v[112:115], v[112:115], v[96:99]
    s_add_u32 s82, s52, s18
    s_lshl_b32 s93, s20, 5
    ds_read_b128 a[40:43], v242 offset:0
    v_mfma_f32_16x16x32_bf16 v[92:95], v[248:251], v[112:115], v[92:95]
    s_and_b32 s93, s93, 128
    s_add_u32 s55, s55, s93
    ds_read_b128 a[48:51], v242 offset:1024
    v_mfma_f32_16x16x32_bf16 v[104:107], v[120:123], v[120:123], v[104:107]
    s_xor_b32 s93, s55, 128
    ds_read_b128 a[56:59], v242 offset:2048
    v_and_b32 v5, 7, v2
    v_mfma_f32_16x16x32_bf16 v[100:103], v[248:251], v[120:123], v[100:103]
    ds_read_b128 a[64:67], v242 offset:3072
    v_xor_b32 v5, v5, v3
    v_mfma_f32_16x16x32_bf16 v[72:75], v[248:251], a[0:3], v[72:75]
    buffer_load_dwordx4 v144, s[24:27], s82 offen offset:0 lds
    v_mfma_f32_16x16x32_bf16 v[76:79], v[248:251], a[8:11], v[76:79]
    ds_read_b128 a[72:75], v242 offset:4096
    v_lshlrev_b32 v4, 7, v2
    v_mfma_f32_16x16x32_bf16 v[80:83], v[248:251], a[16:19], v[80:83]
    ds_read_b128 a[44:47], v243 offset:0
    v_lshl_add_u32 v4, v5, 4, v4
    v_mfma_f32_16x16x32_bf16 v[84:87], v[248:251], a[24:27], v[84:87]
    ds_read_b128 a[52:55], v243 offset:1024
    v_add_u32 v29, s46, v4
    v_mfma_f32_16x16x32_bf16 v[88:91], v[248:251], a[32:35], v[88:91]
    ds_read_b128 a[60:63], v243 offset:2048
    v_xor_b32 v30, 64, v29
    v_mfma_f32_16x16x32_bf16 v[32:35], v[112:115], a[0:3], v[32:35]
    buffer_load_dwordx4 v145, s[24:27], s82 offen offset:1024 lds
    v_mfma_f32_16x16x32_bf16 v[52:55], v[120:123], a[0:3], v[52:55]
    ds_read_b128 a[68:71], v243 offset:3072
    v_add_u32 v9, s46, v8
    v_mfma_f32_16x16x32_bf16 v[36:39], v[112:115], a[8:11], v[36:39]
    s_sub_u32 s22, s16, 1
    s_and_b32 s22, s22, 3
    ds_read_b128 a[76:79], v243 offset:4096
    v_mfma_f32_16x16x32_bf16 v[56:59], v[120:123], a[8:11], v[56:59]
    buffer_load_dwordx4 v146, s[24:27], s82 offen offset:2048 lds
    v_mfma_f32_16x16x32_bf16 v[40:43], v[112:115], a[16:19], v[40:43]
    s_mul_i32 s22, s22, 40960
    v_add_u32 v4, s22, v8
    v_mfma_f32_16x16x32_bf16 v[60:63], v[120:123], a[16:19], v[60:63]
    buffer_load_dwordx4 v147, s[24:27], s82 offen offset:3072 lds
    v_mfma_f32_16x16x32_bf16 v[44:47], v[112:115], a[24:27], v[44:47]
    s_sub_u32 s22, s16, 2
    s_and_b32 s22, s22, 3
    s_mul_i32 s22, s22, 40960
    v_mfma_f32_16x16x32_bf16 v[64:67], v[120:123], a[24:27], v[64:67]
    s_add_u32 m0, s46, 10240
    v_add_u32 v5, s22, v8
    v_mfma_f32_16x16x32_bf16 v[48:51], v[112:115], a[32:35], v[48:51]
    s_add_u32 s82, s52, s91
    s_sub_u32 s22, s16, 3
    s_and_b32 s22, s22, 3
    v_mfma_f32_16x16x32_bf16 v[68:71], v[120:123], a[32:35], v[68:71]
    buffer_load_dwordx4 v144, s[24:27], s82 offen offset:0 lds
    v_mfma_f32_16x16x32_bf16 v[96:99], v[116:119], v[116:119], v[96:99]
    s_mul_i32 s22, s22, 40960
    v_add_u32 v6, s22, v8
    v_mfma_f32_16x16x32_bf16 v[92:95], v[248:251], v[116:119], v[92:95]
    s_lshl_b32 s21, s19, 3
    s_lshl_b32 s22, s16, 1
    s_add_u32 s21, s21, s22
    v_mfma_f32_16x16x32_bf16 v[104:107], v[124:127], v[124:127], v[104:107]
    s_add_u32 s21, s21, s17
    v_mul_u32_u24 v11, 1280, v2
    v_lshl_add_u32 v11, v3, 3, v11
    v_mfma_f32_16x16x32_bf16 v[100:103], v[248:251], v[124:127], v[100:103]
    v_lshrrev_b32 v7, 1, v3
    v_lshlrev_b32 v7, 8, v7
    v_mfma_f32_16x16x32_bf16 v[32:35], v[116:119], a[4:7], v[32:35]
    s_waitcnt vmcnt(10)
    ds_read_b128 v[128:131], v238 offset:27648
    v_lshl_add_u32 v7, v2, 4, v7
    v_mfma_f32_16x16x32_bf16 v[52:55], v[124:127], a[4:7], v[52:55]
    ds_read_b128 v[136:139], v238 offset:29696
    v_and_b32 v10, 1, v3
    v_mfma_f32_16x16x32_bf16 v[36:39], v[116:119], a[12:15], v[36:39]
    ds_read_b128 v[132:135], v239 offset:27648
    v_lshl_add_u32 v7, v10, 3, v7
    v_mfma_f32_16x16x32_bf16 v[56:59], v[124:127], a[12:15], v[56:59]
    ds_read_b128 v[140:143], v239 offset:29696
    v_lshlrev_b32 v10, 13, v3
    v_mfma_f32_16x16x32_bf16 v[40:43], v[116:119], a[20:23], v[40:43]
    buffer_load_dwordx4 v145, s[24:27], s82 offen offset:1024 lds
    v_mfma_f32_16x16x32_bf16 v[60:63], v[124:127], a[20:23], v[60:63]
    buffer_load_dwordx4 v146, s[24:27], s82 offen offset:2048 lds
    v_mfma_f32_16x16x32_bf16 v[44:47], v[116:119], a[28:31], v[44:47]
    v_lshl_add_u32 v10, v2, 3, v10
    v_mfma_f32_16x16x32_bf16 v[64:67], v[124:127], a[28:31], v[64:67]
    v_mfma_f32_16x16x32_bf16 v[48:51], v[116:119], a[36:39], v[48:51]
    v_mfma_f32_16x16x32_bf16 v[68:71], v[124:127], a[36:39], v[68:71]
    s_waitcnt vmcnt(7) lgkmcnt(0)
    s_barrier
    v_mfma_f32_16x16x32_bf16 v[96:99], v[128:131], v[128:131], v[96:99]
    s_lshl_b32 s63, s19, 3
    s_add_u32 s63, s63, s20
    ds_read_b128 a[0:3], v240 offset:5120
    v_mfma_f32_16x16x32_bf16 v[92:95], v[248:251], v[128:131], v[92:95]
    s_lshl_b32 s63, s63, 2
    s_add_u32 s63, s63, s16
    ds_read_b128 a[8:11], v240 offset:6144
    v_mfma_f32_16x16x32_bf16 v[104:107], v[136:139], v[136:139], v[104:107]
    s_lshl_b32 s63, s63, 1
    s_add_u32 s63, s63, s17
    ds_read_b128 a[16:19], v240 offset:7168
    v_mfma_f32_16x16x32_bf16 v[100:103], v[248:251], v[136:139], v[100:103]
    s_lshl_b32 s63, s63, 12
    s_add_u32 s63, s63, 23068672
    ds_read_b128 a[24:27], v240 offset:8192
    v_mfma_f32_16x16x32_bf16 v[32:35], v[128:131], a[40:43], v[32:35]
    buffer_load_dwordx4 v147, s[24:27], s82 offen offset:3072 lds
    v_mfma_f32_16x16x32_bf16 v[52:55], v[136:139], a[40:43], v[52:55]
    s_add_u32 m0, s46, 18432
    s_lshl2_add_u32 s48, s19, s16
    ds_read_b128 a[32:35], v240 offset:9216
    v_mfma_f32_16x16x32_bf16 v[36:39], v[128:131], a[48:51], v[36:39]
    s_add_u32 s83, s53, 0
    s_lshl_b32 s48, s48, 6
    ds_read_b128 a[4:7], v241 offset:5120
    v_mfma_f32_16x16x32_bf16 v[56:59], v[136:139], a[48:51], v[56:59]
    s_add_u32 s48, s48, s60
    ds_read_b128 a[12:15], v241 offset:6144
    v_lshlrev_b32 v12, 2, v1
    s_xor_b32 s68, s63, 4096
    s_mov_b32 s75, s68
    s_cmp_eq_u32 s70, 0
    s_cbranch_scc1 k2_xs
    s_lshl_b32 s63, s2, 2
    s_add_u32 s63, s63, s16
    s_lshl_b32 s63, s63, 1
    s_add_u32 s63, s63, s17
    s_lshl_b32 s63, s63, 13
    s_add_u32 s63, s63, 239075328
    s_xor_b32 s68, s63, 8192
    s_mov_b32 s75, 27262976
    s_mov_b32 s48, 27262976
    k2_xs:
    v_mfma_f32_16x16x32_bf16 v[40:43], v[128:131], a[56:59], v[40:43]
    s_mul_i32 s44, s21, 20480
    s_mul_i32 s62, s20, 2560
    ds_read_b128 a[20:23], v241 offset:7168
    v_mfma_f32_16x16x32_bf16 v[60:63], v[136:139], a[56:59], v[60:63]
    buffer_load_dwordx4 v148, s[28:31], s83 offen offset:0 lds
    v_mfma_f32_16x16x32_bf16 v[44:47], v[128:131], a[64:67], v[44:47]
    s_add_u32 s83, s53, 19456
    s_add_u32 s62, s62, s44
    ds_read_b128 a[28:31], v241 offset:8192
    v_mfma_f32_16x16x32_bf16 v[64:67], v[136:139], a[64:67], v[64:67]
    s_add_u32 s62, s62, s74
    s_mul_i32 s22, s20, 160
    ds_read_b128 a[36:39], v241 offset:9216
    v_mfma_f32_16x16x32_bf16 v[48:51], v[128:131], a[72:75], v[48:51]
    buffer_load_dwordx4 v148, s[28:31], s83 offen offset:1024 lds
    v_mfma_f32_16x16x32_bf16 v[68:71], v[136:139], a[72:75], v[68:71]
    s_add_u32 s83, s53, 38912
    s_add_u32 s44, s44, s22
    s_and_b32 s45, s21, 7
    v_mfma_f32_16x16x32_bf16 v[96:99], v[132:135], v[132:135], v[96:99]
    buffer_load_dwordx4 v148, s[28:31], s83 offen offset:2048 lds
    v_mfma_f32_16x16x32_bf16 v[92:95], v[248:251], v[132:135], v[92:95]
    s_lshl_b32 s45, s45, 7
    s_lshl_b32 s22, s20, 10
    s_add_u32 s45, s45, s22
    v_mfma_f32_16x16x32_bf16 v[104:107], v[140:143], v[140:143], v[104:107]
    s_add_u32 s83, s53, 58368
    s_lshl_b32 s22, s19, 17
    s_add_u32 s45, s45, s22
    v_mfma_f32_16x16x32_bf16 v[100:103], v[248:251], v[140:143], v[100:103]
    buffer_load_dwordx4 v148, s[28:31], s83 offen offset:3072 lds
    v_mfma_f32_16x16x32_bf16 v[32:35], v[132:135], a[44:47], v[32:35]
    s_waitcnt vmcnt(8)
    s_add_u32 s45, s45, s74
    ds_read_b128 v[112:115], v238 offset:36864
    v_mfma_f32_16x16x32_bf16 v[52:55], v[140:143], a[44:47], v[52:55]
    s_add_u32 m0, s46, 22528
    s_add_u32 s45, s45, 9437184
    ds_read_b128 v[120:123], v238 offset:38912
    v_mfma_f32_16x16x32_bf16 v[36:39], v[132:135], a[52:55], v[36:39]
    s_add_u32 s83, s53, 81920
    s_lshl_b32 s85, s19, 2
    ds_read_b128 v[116:119], v239 offset:36864
    v_mfma_f32_16x16x32_bf16 v[56:59], v[140:143], a[52:55], v[56:59]
    s_add_u32 s85, s85, s16
    s_mul_i32 s85, s85, 98304
    ds_read_b128 v[124:127], v239 offset:38912
    v_mfma_f32_16x16x32_bf16 v[40:43], v[132:135], a[60:63], v[40:43]
    buffer_load_dwordx4 v148, s[28:31], s83 offen offset:0 lds
    v_mfma_f32_16x16x32_bf16 v[60:63], v[140:143], a[60:63], v[60:63]
    s_mul_i32 s22, s76, 3072
    s_add_u32 s85, s85, s22
    s_mul_i32 s22, s76, 12
    s_add_u32 s85, s85, 8388608
    s_cmp_eq_u32 s70, 0
    s_cselect_b32 s85, s85, 27262976
    s_cselect_b32 s84, s62, 27262976
    s_add_u32 s86, s85, 49152
    v_mfma_f32_16x16x32_bf16 v[44:47], v[132:135], a[68:71], v[44:47]
    s_add_u32 m0, s46, 14336
    s_add_u32 s22, s22, s16
    s_mul_i32 s77, s22, 20480
    v_mfma_f32_16x16x32_bf16 v[64:67], v[140:143], a[68:71], v[64:67]
    s_add_u32 s82, s53, s18
    s_add_u32 s77, s77, 16777216
    v_mfma_f32_16x16x32_bf16 v[48:51], v[132:135], a[76:79], v[48:51]
    buffer_load_dwordx4 v144, s[24:27], s82 offen offset:0 lds
    v_mfma_f32_16x16x32_bf16 v[68:71], v[140:143], a[76:79], v[68:71]
    s_waitcnt lgkmcnt(0)
    v_mfma_f32_16x16x32_bf16 v[96:99], v[112:115], v[112:115], v[96:99]
    ds_read_b128 a[40:43], v242 offset:5120
    v_lshrrev_b32 v181, 1, v3
    v_mfma_f32_16x16x32_bf16 v[92:95], v[248:251], v[112:115], v[92:95]
    ds_read_b128 a[48:51], v242 offset:6144
    v_and_b32 v176, 7, v2
    v_mfma_f32_16x16x32_bf16 v[104:107], v[120:123], v[120:123], v[104:107]
    ds_read_b128 a[56:59], v242 offset:7168
    v_xor_b32 v181, v181, v176
    v_mfma_f32_16x16x32_bf16 v[100:103], v[248:251], v[120:123], v[100:103]
    ds_read_b128 a[64:67], v242 offset:8192
    v_lshlrev_b32 v181, 4, v181
    v_mfma_f32_16x16x32_bf16 v[72:75], v[248:251], a[0:3], v[72:75]
    buffer_load_dwordx4 v145, s[24:27], s82 offen offset:1024 lds
    v_mfma_f32_16x16x32_bf16 v[76:79], v[248:251], a[8:11], v[76:79]
    ds_read_b128 a[72:75], v242 offset:9216
    v_lshl_add_u32 v181, v2, 7, v181
    v_mfma_f32_16x16x32_bf16 v[80:83], v[248:251], a[16:19], v[80:83]
    ds_read_b128 a[44:47], v243 offset:5120
    v_and_b32 v176, 1, v3
    v_mfma_f32_16x16x32_bf16 v[84:87], v[248:251], a[24:27], v[84:87]
    ds_read_b128 a[52:55], v243 offset:6144
    v_lshl_add_u32 v181, v176, 3, v181
    v_mfma_f32_16x16x32_bf16 v[88:91], v[248:251], a[32:35], v[88:91]
    s_lshl_b32 s22, s17, 11
    s_add_u32 s22, s22, s46
    ds_read_b128 a[60:63], v243 offset:7168
    v_mfma_f32_16x16x32_bf16 v[32:35], v[112:115], a[0:3], v[32:35]
    buffer_load_dwordx4 v146, s[24:27], s82 offen offset:2048 lds
    v_mfma_f32_16x16x32_bf16 v[52:55], v[120:123], a[0:3], v[52:55]
    ds_read_b128 a[68:71], v243 offset:8192
    v_add_u32 v181, s22, v181
    v_mfma_f32_16x16x32_bf16 v[36:39], v[112:115], a[8:11], v[36:39]
    s_mul_i32 s100, s20, 160
    s_and_b32 s100, s100, 255
    ds_read_b128 a[76:79], v243 offset:9216
    v_mfma_f32_16x16x32_bf16 v[56:59], v[120:123], a[8:11], v[56:59]
    buffer_load_dwordx4 v147, s[24:27], s82 offen offset:3072 lds
    v_mfma_f32_16x16x32_bf16 v[40:43], v[112:115], a[16:19], v[40:43]
    s_mov_b32 s101, s18
    s_add_u32 s22, s100, 0
    s_xor_b32 s23, s22, s101
    v_mfma_f32_16x16x32_bf16 v[60:63], v[120:123], a[16:19], v[60:63]
    s_add_u32 m0, s46, 23552
    v_mfma_f32_16x16x32_bf16 v[44:47], v[112:115], a[24:27], v[44:47]
    s_add_u32 s82, s53, s91
    v_mfma_f32_16x16x32_bf16 v[64:67], v[120:123], a[24:27], v[64:67]
    buffer_load_dwordx4 v144, s[24:27], s82 offen offset:0 lds
    v_mfma_f32_16x16x32_bf16 v[48:51], v[112:115], a[32:35], v[48:51]
    v_mfma_f32_16x16x32_bf16 v[68:71], v[120:123], a[32:35], v[68:71]
    v_mfma_f32_16x16x32_bf16 v[96:99], v[116:119], v[116:119], v[96:99]
    v_mfma_f32_16x16x32_bf16 v[92:95], v[248:251], v[116:119], v[92:95]
    v_mfma_f32_16x16x32_bf16 v[104:107], v[124:127], v[124:127], v[104:107]
    buffer_load_dwordx4 v145, s[24:27], s82 offen offset:1024 lds
    v_mfma_f32_16x16x32_bf16 v[100:103], v[248:251], v[124:127], v[100:103]
    v_mfma_f32_16x16x32_bf16 v[32:35], v[116:119], a[4:7], v[32:35]
    s_waitcnt vmcnt(11)
    ds_read_b128 v[128:131], v238 offset:10240
    v_mfma_f32_16x16x32_bf16 v[52:55], v[124:127], a[4:7], v[52:55]
    ds_read_b128 v[136:139], v238 offset:12288
    v_mfma_f32_16x16x32_bf16 v[36:39], v[116:119], a[12:15], v[36:39]
    ds_read_b128 v[132:135], v239 offset:10240
    v_mfma_f32_16x16x32_bf16 v[56:59], v[124:127], a[12:15], v[56:59]
    ds_read_b128 v[140:143], v239 offset:12288
    v_mfma_f32_16x16x32_bf16 v[40:43], v[116:119], a[20:23], v[40:43]
    buffer_load_dwordx4 v146, s[24:27], s82 offen offset:2048 lds
    v_mfma_f32_16x16x32_bf16 v[60:63], v[124:127], a[20:23], v[60:63]
    v_mfma_f32_16x16x32_bf16 v[44:47], v[116:119], a[28:31], v[44:47]
    v_mfma_f32_16x16x32_bf16 v[64:67], v[124:127], a[28:31], v[64:67]
    buffer_load_dwordx4 v147, s[24:27], s82 offen offset:3072 lds
    v_mfma_f32_16x16x32_bf16 v[48:51], v[116:119], a[36:39], v[48:51]
    v_mfma_f32_16x16x32_bf16 v[68:71], v[124:127], a[36:39], v[68:71]
    s_waitcnt vmcnt(8) lgkmcnt(0)
    s_barrier
    v_mfma_f32_16x16x32_bf16 v[96:99], v[128:131], v[128:131], v[96:99]
    s_add_u32 m0, s46, 31744
    s_lshr_b32 s23, s23, 4
    ds_read_b128 a[0:3], v240 offset:18432
    v_mfma_f32_16x16x32_bf16 v[92:95], v[248:251], v[128:131], v[92:95]
    s_add_u32 s83, s54, 0
    s_and_b32 s23, s23, 0x18
    ds_read_b128 a[8:11], v240 offset:19456
    v_mfma_f32_16x16x32_bf16 v[104:107], v[136:139], v[136:139], v[104:107]
    s_lshr_b32 s23, 0x241b170e, s23
    s_and_b32 s23, s23, 0xff
    ds_read_b128 a[16:19], v240 offset:20480
    v_mfma_f32_16x16x32_bf16 v[100:103], v[248:251], v[136:139], v[100:103]
    s_lshl_b32 s23, s23, 10
    s_and_b32 s22, s22, 0x60
    ds_read_b128 a[24:27], v240 offset:21504
    v_mfma_f32_16x16x32_bf16 v[32:35], v[128:131], a[40:43], v[32:35]
    buffer_load_dwordx4 v148, s[28:31], s83 offen offset:0 lds
    v_mfma_f32_16x16x32_bf16 v[52:55], v[136:139], a[40:43], v[52:55]
    s_add_u32 s83, s54, 19456
    ds_read_b128 a[32:35], v240 offset:22528
    v_xor_b32 v176, s22, v181
    v_mfma_f32_16x16x32_bf16 v[36:39], v[128:131], a[48:51], v[36:39]
    ds_read_b128 a[4:7], v241 offset:18432
    v_add_u32 v176, s23, v176
    v_mfma_f32_16x16x32_bf16 v[56:59], v[136:139], a[48:51], v[56:59]
    s_add_u32 s22, s100, 32
    s_xor_b32 s23, s22, s101
    ds_read_b128 a[12:15], v241 offset:19456
    v_mfma_f32_16x16x32_bf16 v[40:43], v[128:131], a[56:59], v[40:43]
    s_lshr_b32 s23, s23, 4
    s_and_b32 s23, s23, 0x18
    ds_read_b128 a[20:23], v241 offset:20480
    v_mfma_f32_16x16x32_bf16 v[60:63], v[136:139], a[56:59], v[60:63]
    buffer_load_dwordx4 v148, s[28:31], s83 offen offset:1024 lds
    v_mfma_f32_16x16x32_bf16 v[44:47], v[128:131], a[64:67], v[44:47]
    s_add_u32 s83, s54, 38912
    s_lshr_b32 s23, 0x241b170e, s23
    ds_read_b128 a[28:31], v241 offset:21504
    v_mfma_f32_16x16x32_bf16 v[64:67], v[136:139], a[64:67], v[64:67]
    s_and_b32 s23, s23, 0xff
    s_lshl_b32 s23, s23, 10
    ds_read_b128 a[36:39], v241 offset:22528
    v_mfma_f32_16x16x32_bf16 v[48:51], v[128:131], a[72:75], v[48:51]
    buffer_load_dwordx4 v148, s[28:31], s83 offen offset:2048 lds
    v_mfma_f32_16x16x32_bf16 v[68:71], v[136:139], a[72:75], v[68:71]
    s_and_b32 s22, s22, 0x60
    v_mfma_f32_16x16x32_bf16 v[96:99], v[132:135], v[132:135], v[96:99]
    s_add_u32 s83, s54, 58368
    v_mfma_f32_16x16x32_bf16 v[92:95], v[248:251], v[132:135], v[92:95]
    buffer_load_dwordx4 v148, s[28:31], s83 offen offset:3072 lds
    v_mfma_f32_16x16x32_bf16 v[104:107], v[140:143], v[140:143], v[104:107]
    v_mfma_f32_16x16x32_bf16 v[100:103], v[248:251], v[140:143], v[100:103]
    v_mfma_f32_16x16x32_bf16 v[32:35], v[132:135], a[44:47], v[32:35]
    s_waitcnt vmcnt(8)
    ds_read_b128 v[112:115], v238 offset:14336
    v_mfma_f32_16x16x32_bf16 v[52:55], v[140:143], a[44:47], v[52:55]
    s_add_u32 m0, s46, 35840
    ds_read_b128 v[120:123], v238 offset:16384
    v_mfma_f32_16x16x32_bf16 v[36:39], v[132:135], a[52:55], v[36:39]
    s_add_u32 s83, s54, 81920
    ds_read_b128 v[116:119], v239 offset:14336
    v_mfma_f32_16x16x32_bf16 v[56:59], v[140:143], a[52:55], v[56:59]
    ds_read_b128 v[124:127], v239 offset:16384
    v_mfma_f32_16x16x32_bf16 v[40:43], v[132:135], a[60:63], v[40:43]
    buffer_load_dwordx4 v148, s[28:31], s83 offen offset:0 lds
    v_mfma_f32_16x16x32_bf16 v[60:63], v[140:143], a[60:63], v[60:63]
    s_add_u32 m0, s46, 27648
    v_mfma_f32_16x16x32_bf16 v[44:47], v[132:135], a[68:71], v[44:47]
    s_add_u32 s82, s54, s18
    v_mfma_f32_16x16x32_bf16 v[64:67], v[140:143], a[68:71], v[64:67]
    buffer_load_dwordx4 v144, s[24:27], s82 offen offset:0 lds
    v_mfma_f32_16x16x32_bf16 v[48:51], v[132:135], a[76:79], v[48:51]
    v_mfma_f32_16x16x32_bf16 v[68:71], v[140:143], a[76:79], v[68:71]
    s_waitcnt lgkmcnt(0)
    v_mfma_f32_16x16x32_bf16 v[96:99], v[112:115], v[112:115], v[96:99]
    ds_read_b128 a[40:43], v242 offset:18432
    v_xor_b32 v177, s22, v181
    v_mfma_f32_16x16x32_bf16 v[92:95], v[248:251], v[112:115], v[92:95]
    ds_read_b128 a[48:51], v242 offset:19456
    v_add_u32 v177, s23, v177
    v_mfma_f32_16x16x32_bf16 v[104:107], v[120:123], v[120:123], v[104:107]
    s_add_u32 s22, s100, 64
    s_xor_b32 s23, s22, s101
    ds_read_b128 a[56:59], v242 offset:20480
    v_mfma_f32_16x16x32_bf16 v[100:103], v[248:251], v[120:123], v[100:103]
    s_lshr_b32 s23, s23, 4
    s_and_b32 s23, s23, 0x18
    ds_read_b128 a[64:67], v242 offset:21504
    v_mfma_f32_16x16x32_bf16 v[72:75], v[248:251], a[0:3], v[72:75]
    buffer_load_dwordx4 v145, s[24:27], s82 offen offset:1024 lds
    v_mfma_f32_16x16x32_bf16 v[76:79], v[248:251], a[8:11], v[76:79]
    s_lshr_b32 s23, 0x241b170e, s23
    s_and_b32 s23, s23, 0xff
    ds_read_b128 a[72:75], v242 offset:22528
    v_mfma_f32_16x16x32_bf16 v[80:83], v[248:251], a[16:19], v[80:83]
    s_lshl_b32 s23, s23, 10
    s_and_b32 s22, s22, 0x60
    ds_read_b128 a[44:47], v243 offset:18432
    v_mfma_f32_16x16x32_bf16 v[84:87], v[248:251], a[24:27], v[84:87]
    ds_read_b128 a[52:55], v243 offset:19456
    v_xor_b32 v178, s22, v181
    v_mfma_f32_16x16x32_bf16 v[88:91], v[248:251], a[32:35], v[88:91]
    ds_read_b128 a[60:63], v243 offset:20480
    v_add_u32 v178, s23, v178
    v_mfma_f32_16x16x32_bf16 v[32:35], v[112:115], a[0:3], v[32:35]
    buffer_load_dwordx4 v146, s[24:27], s82 offen offset:2048 lds
    v_mfma_f32_16x16x32_bf16 v[52:55], v[120:123], a[0:3], v[52:55]
    s_add_u32 s22, s100, 96
    s_xor_b32 s23, s22, s101
    ds_read_b128 a[68:71], v243 offset:21504
    v_mfma_f32_16x16x32_bf16 v[36:39], v[112:115], a[8:11], v[36:39]
    s_lshr_b32 s23, s23, 4
    s_and_b32 s23, s23, 0x18
    ds_read_b128 a[76:79], v243 offset:22528
    v_mfma_f32_16x16x32_bf16 v[56:59], v[120:123], a[8:11], v[56:59]
    buffer_load_dwordx4 v147, s[24:27], s82 offen offset:3072 lds
    v_mfma_f32_16x16x32_bf16 v[40:43], v[112:115], a[16:19], v[40:43]
    s_add_u32 m0, s46, 36864
    v_mfma_f32_16x16x32_bf16 v[60:63], v[120:123], a[16:19], v[60:63]
    s_add_u32 s82, s54, s91
    v_mfma_f32_16x16x32_bf16 v[44:47], v[112:115], a[24:27], v[44:47]
    buffer_load_dwordx4 v144, s[24:27], s82 offen offset:0 lds
    v_mfma_f32_16x16x32_bf16 v[64:67], v[120:123], a[24:27], v[64:67]
    v_mfma_f32_16x16x32_bf16 v[48:51], v[112:115], a[32:35], v[48:51]
    v_mfma_f32_16x16x32_bf16 v[68:71], v[120:123], a[32:35], v[68:71]
    v_mfma_f32_16x16x32_bf16 v[96:99], v[116:119], v[116:119], v[96:99]
    buffer_load_dwordx4 v145, s[24:27], s82 offen offset:1024 lds
    v_mfma_f32_16x16x32_bf16 v[92:95], v[248:251], v[116:119], v[92:95]
    v_mfma_f32_16x16x32_bf16 v[104:107], v[124:127], v[124:127], v[104:107]
    v_mfma_f32_16x16x32_bf16 v[100:103], v[248:251], v[124:127], v[100:103]
    v_mfma_f32_16x16x32_bf16 v[32:35], v[116:119], a[4:7], v[32:35]
    s_waitcnt vmcnt(11)
    ds_read_b128 v[128:131], v238 offset:23552
    v_mfma_f32_16x16x32_bf16 v[52:55], v[124:127], a[4:7], v[52:55]
    ds_read_b128 v[136:139], v238 offset:25600
    v_mfma_f32_16x16x32_bf16 v[36:39], v[116:119], a[12:15], v[36:39]
    ds_read_b128 v[132:135], v239 offset:23552
    v_mfma_f32_16x16x32_bf16 v[56:59], v[124:127], a[12:15], v[56:59]
    ds_read_b128 v[140:143], v239 offset:25600
    v_mfma_f32_16x16x32_bf16 v[40:43], v[116:119], a[20:23], v[40:43]
    buffer_load_dwordx4 v146, s[24:27], s82 offen offset:2048 lds
    v_mfma_f32_16x16x32_bf16 v[60:63], v[124:127], a[20:23], v[60:63]
    v_mfma_f32_16x16x32_bf16 v[44:47], v[116:119], a[28:31], v[44:47]
    buffer_load_dwordx4 v147, s[24:27], s82 offen offset:3072 lds
    v_mfma_f32_16x16x32_bf16 v[64:67], v[124:127], a[28:31], v[64:67]
    s_add_u32 m0, s46, 0
    v_mfma_f32_16x16x32_bf16 v[48:51], v[116:119], a[36:39], v[48:51]
    s_add_u32 s42, s55, 0
    v_mfma_f32_16x16x32_bf16 v[68:71], v[124:127], a[36:39], v[68:71]
    s_waitcnt vmcnt(8) lgkmcnt(0)
    s_barrier
    v_mfma_f32_16x16x32_bf16 v[96:99], v[128:131], v[128:131], v[96:99]
    s_and_b32 s42, s42, 0x3ff
    s_lshr_b32 s23, 0x241b170e, s23
    ds_read_b128 a[0:3], v240 offset:31744
    v_mfma_f32_16x16x32_bf16 v[92:95], v[248:251], v[128:131], v[92:95]
    s_add_u32 s42, s42, s40
    s_and_b32 s23, s23, 0xff
    ds_read_b128 a[8:11], v240 offset:32768
    v_mfma_f32_16x16x32_bf16 v[104:107], v[136:139], v[136:139], v[104:107]
    s_lshl_b32 s23, s23, 10
    s_and_b32 s22, s22, 0x60
    ds_read_b128 a[16:19], v240 offset:33792
    v_mfma_f32_16x16x32_bf16 v[100:103], v[248:251], v[136:139], v[100:103]
    ds_read_b128 a[24:27], v240 offset:34816
    v_xor_b32 v179, s22, v181
    v_mfma_f32_16x16x32_bf16 v[32:35], v[128:131], a[40:43], v[32:35]
    buffer_load_dwordx4 v16, s[56:59], s42 offen offset:0 lds
    v_mfma_f32_16x16x32_bf16 v[52:55], v[136:139], a[40:43], v[52:55]
    ds_read_b128 a[32:35], v240 offset:35840
    v_add_u32 v179, s23, v179
    v_mfma_f32_16x16x32_bf16 v[36:39], v[128:131], a[48:51], v[36:39]
    s_add_u32 s22, s100, 128
    s_xor_b32 s23, s22, s101
    ds_read_b128 a[4:7], v241 offset:31744
    v_mfma_f32_16x16x32_bf16 v[56:59], v[136:139], a[48:51], v[56:59]
    s_lshr_b32 s23, s23, 4
    s_and_b32 s23, s23, 0x18
    ds_read_b128 a[12:15], v241 offset:32768
    v_mfma_f32_16x16x32_bf16 v[40:43], v[128:131], a[56:59], v[40:43]
    s_lshr_b32 s23, 0x241b170e, s23
    s_and_b32 s23, s23, 0xff
    ds_read_b128 a[20:23], v241 offset:33792
    v_mfma_f32_16x16x32_bf16 v[60:63], v[136:139], a[56:59], v[60:63]
    buffer_load_dwordx4 v17, s[56:59], s42 offen offset:1024 lds
    v_mfma_f32_16x16x32_bf16 v[44:47], v[128:131], a[64:67], v[44:47]
    s_lshl_b32 s23, s23, 10
    s_and_b32 s22, s22, 0x60
    ds_read_b128 a[28:31], v241 offset:34816
    v_mfma_f32_16x16x32_bf16 v[64:67], v[136:139], a[64:67], v[64:67]
    ds_read_b128 a[36:39], v241 offset:35840
    v_xor_b32 v180, s22, v181
    v_mfma_f32_16x16x32_bf16 v[48:51], v[128:131], a[72:75], v[48:51]
    buffer_load_dwordx4 v18, s[56:59], s42 offen offset:2048 lds
    v_mfma_f32_16x16x32_bf16 v[68:71], v[136:139], a[72:75], v[68:71]
    v_add_u32 v180, s23, v180
    v_mfma_f32_16x16x32_bf16 v[96:99], v[132:135], v[132:135], v[96:99]
    v_mfma_f32_16x16x32_bf16 v[92:95], v[248:251], v[132:135], v[92:95]
    v_mfma_f32_16x16x32_bf16 v[104:107], v[140:143], v[140:143], v[104:107]
    buffer_load_dwordx4 v19, s[56:59], s42 offen offset:3072 lds
    v_mfma_f32_16x16x32_bf16 v[100:103], v[248:251], v[140:143], v[100:103]
    v_mfma_f32_16x16x32_bf16 v[32:35], v[132:135], a[44:47], v[32:35]
    s_waitcnt vmcnt(8)
    ds_read_b128 v[112:115], v238 offset:27648
    v_mfma_f32_16x16x32_bf16 v[52:55], v[140:143], a[44:47], v[52:55]
    ds_read_b128 v[120:123], v238 offset:29696
    v_mfma_f32_16x16x32_bf16 v[36:39], v[132:135], a[52:55], v[36:39]
    s_add_u32 m0, s46, 4096
    ds_read_b128 v[116:119], v239 offset:27648
    v_mfma_f32_16x16x32_bf16 v[56:59], v[140:143], a[52:55], v[56:59]
    ds_read_b128 v[124:127], v239 offset:29696
    v_mfma_f32_16x16x32_bf16 v[40:43], v[132:135], a[60:63], v[40:43]
    buffer_load_dwordx4 v20, s[56:59], s42 offen offset:0 lds
    v_mfma_f32_16x16x32_bf16 v[60:63], v[140:143], a[60:63], v[60:63]
    v_mfma_f32_16x16x32_bf16 v[44:47], v[132:135], a[68:71], v[44:47]
    v_mfma_f32_16x16x32_bf16 v[64:67], v[140:143], a[68:71], v[64:67]
    v_mfma_f32_16x16x32_bf16 v[48:51], v[132:135], a[76:79], v[48:51]
    buffer_load_dwordx4 v21, s[56:59], s42 offen offset:1024 lds
    v_mfma_f32_16x16x32_bf16 v[68:71], v[140:143], a[76:79], v[68:71]
    s_waitcnt lgkmcnt(0)
    v_mfma_f32_16x16x32_bf16 v[96:99], v[112:115], v[112:115], v[96:99]
    ds_read_b128 a[40:43], v242 offset:31744
    v_mfma_f32_16x16x32_bf16 v[92:95], v[248:251], v[112:115], v[92:95]
    ds_read_b128 a[48:51], v242 offset:32768
    v_mfma_f32_16x16x32_bf16 v[104:107], v[120:123], v[120:123], v[104:107]
    ds_read_b128 a[56:59], v242 offset:33792
    v_mfma_f32_16x16x32_bf16 v[100:103], v[248:251], v[120:123], v[100:103]
    ds_read_b128 a[64:67], v242 offset:34816
    v_mfma_f32_16x16x32_bf16 v[72:75], v[248:251], a[0:3], v[72:75]
    buffer_load_dwordx4 v22, s[56:59], s42 offen offset:2048 lds
    v_mfma_f32_16x16x32_bf16 v[76:79], v[248:251], a[8:11], v[76:79]
    ds_read_b128 a[72:75], v242 offset:35840
    v_mfma_f32_16x16x32_bf16 v[80:83], v[248:251], a[16:19], v[80:83]
    ds_read_b128 a[44:47], v243 offset:31744
    v_mfma_f32_16x16x32_bf16 v[84:87], v[248:251], a[24:27], v[84:87]
    ds_read_b128 a[52:55], v243 offset:32768
    v_mfma_f32_16x16x32_bf16 v[88:91], v[248:251], a[32:35], v[88:91]
    ds_read_b128 a[60:63], v243 offset:33792
    v_mfma_f32_16x16x32_bf16 v[32:35], v[112:115], a[0:3], v[32:35]
    buffer_load_dwordx4 v23, s[56:59], s42 offen offset:3072 lds
    v_mfma_f32_16x16x32_bf16 v[52:55], v[120:123], a[0:3], v[52:55]
    ds_read_b128 a[68:71], v243 offset:34816
    v_mfma_f32_16x16x32_bf16 v[36:39], v[112:115], a[8:11], v[36:39]
    ds_read_b128 a[76:79], v243 offset:35840
    v_mfma_f32_16x16x32_bf16 v[56:59], v[120:123], a[8:11], v[56:59]
    v_mfma_f32_16x16x32_bf16 v[40:43], v[112:115], a[16:19], v[40:43]
    ds_write_b32 v244, v72 offset:10240
    v_mfma_f32_16x16x32_bf16 v[60:63], v[120:123], a[16:19], v[60:63]
    ds_write_b32 v244, v76 offset:10496
    v_mfma_f32_16x16x32_bf16 v[44:47], v[112:115], a[24:27], v[44:47]
    ds_write_b32 v244, v80 offset:10752
    v_mfma_f32_16x16x32_bf16 v[64:67], v[120:123], a[24:27], v[64:67]
    ds_write_b32 v244, v84 offset:11008
    v_mfma_f32_16x16x32_bf16 v[48:51], v[112:115], a[32:35], v[48:51]
    ds_write_b32 v244, v88 offset:11264
    v_mfma_f32_16x16x32_bf16 v[68:71], v[120:123], a[32:35], v[68:71]
    v_mfma_f32_16x16x32_bf16 v[96:99], v[116:119], v[116:119], v[96:99]
    v_mfma_f32_16x16x32_bf16 v[92:95], v[248:251], v[116:119], v[92:95]
    s_waitcnt lgkmcnt(0)
    s_barrier
    v_mfma_f32_16x16x32_bf16 v[104:107], v[124:127], v[124:127], v[104:107]
    ds_read_b128 v[72:75], v245 offset:10240
    ds_read_b128 v[76:79], v245 offset:10496
    v_mfma_f32_16x16x32_bf16 v[100:103], v[248:251], v[124:127], v[100:103]
    ds_read_b128 v[80:83], v245 offset:10752
    ds_read_b128 v[84:87], v245 offset:11008
    v_mfma_f32_16x16x32_bf16 v[32:35], v[116:119], a[4:7], v[32:35]
    ds_read_b128 v[88:91], v245 offset:11264
    v_mfma_f32_16x16x32_bf16 v[52:55], v[124:127], a[4:7], v[52:55]
    v_mfma_f32_16x16x32_bf16 v[36:39], v[116:119], a[12:15], v[36:39]
    v_mfma_f32_16x16x32_bf16 v[56:59], v[124:127], a[12:15], v[56:59]
    v_mfma_f32_16x16x32_bf16 v[40:43], v[116:119], a[20:23], v[40:43]
    v_mfma_f32_16x16x32_bf16 v[60:63], v[124:127], a[20:23], v[60:63]
    s_waitcnt vmcnt(8)
    ds_read_b128 v[128:131], v238 offset:36864
    ds_read_b128 v[136:139], v238 offset:38912
    v_mfma_f32_16x16x32_bf16 v[44:47], v[116:119], a[28:31], v[44:47]
    ds_read_b128 v[132:135], v239 offset:36864
    ds_read_b128 v[140:143], v239 offset:38912
    v_mfma_f32_16x16x32_bf16 v[64:67], v[124:127], a[28:31], v[64:67]
    v_mfma_f32_16x16x32_bf16 v[48:51], v[116:119], a[36:39], v[48:51]
    v_mfma_f32_16x16x32_bf16 v[68:71], v[124:127], a[36:39], v[68:71]
    s_waitcnt lgkmcnt(0)
    v_mfma_f32_16x16x32_bf16 v[96:99], v[128:131], v[128:131], v[96:99]
    s_mov_b32 s50, 0
    s_mov_b32 s51, -1
    v_add_f32 v72, v72, v73
    v_mfma_f32_16x16x32_bf16 v[92:95], v[248:251], v[128:131], v[92:95]
    v_add_f32 v74, v74, v75
    v_add_f32 v76, v76, v77
    v_mfma_f32_16x16x32_bf16 v[104:107], v[136:139], v[136:139], v[104:107]
    v_add_f32 v78, v78, v79
    v_add_f32 v80, v80, v81
    v_mfma_f32_16x16x32_bf16 v[100:103], v[248:251], v[136:139], v[100:103]
    v_add_f32 v82, v82, v83
    v_add_f32 v84, v84, v85
    v_mfma_f32_16x16x32_bf16 v[96:99], v[132:135], v[132:135], v[96:99]
    v_add_f32 v86, v86, v87
    v_add_f32 v88, v88, v89
    v_mfma_f32_16x16x32_bf16 v[92:95], v[248:251], v[132:135], v[92:95]
    v_add_f32 v90, v90, v91
    v_add_f32 v72, v72, v74
    v_mfma_f32_16x16x32_bf16 v[104:107], v[140:143], v[140:143], v[104:107]
    v_add_f32 v76, v76, v78
    v_add_f32 v80, v80, v82
    v_mfma_f32_16x16x32_bf16 v[100:103], v[248:251], v[140:143], v[100:103]
    v_add_f32 v84, v84, v86
    v_add_f32 v88, v88, v90
    v_mfma_f32_16x16x32_bf16 v[32:35], v[128:131], a[40:43], v[32:35]
    v_mfma_f32_16x16x32_bf16 v[52:55], v[136:139], a[40:43], v[52:55]
    v_mfma_f32_16x16x32_bf16 v[32:35], v[132:135], a[44:47], v[32:35]
    v_cndmask_b32 v96, v96, v97, vcc
    v_cndmask_b32 v98, v98, v99, vcc
    v_mfma_f32_16x16x32_bf16 v[52:55], v[140:143], a[44:47], v[52:55]
    v_cndmask_b32 v104, v104, v105, vcc
    v_cndmask_b32 v106, v106, v107, vcc
    v_cndmask_b32 v96, v96, v98, s[4:5]
    v_mfma_f32_16x16x32_bf16 v[36:39], v[128:131], a[48:51], v[36:39]
    v_cndmask_b32 v104, v104, v106, s[4:5]
    v_cndmask_b32 v92, v92, v100, s[50:51]
    v_mfma_f32_16x16x32_bf16 v[56:59], v[136:139], a[48:51], v[56:59]
    v_permlane32_swap_b32 v96, v104
    s_nop 1
    v_cndmask_b32 v96, v96, v104, s[12:13]
    v_mul_f32 v93, 986500301, v92
    v_mfma_f32_16x16x32_bf16 v[36:39], v[132:135], a[52:55], v[36:39]
    v_mul_f32 v95, 986500301, v96
    v_fma_f32 v95, -v93, v93, v95
    v_mfma_f32_16x16x32_bf16 v[56:59], v[140:143], a[52:55], v[56:59]
    v_max_f32 v95, 0, v95
    v_cvt_pk_bf16_f32 v93, v93, v93
    v_lshlrev_b32 v93, 16, v93
    v_mfma_f32_16x16x32_bf16 v[40:43], v[128:131], a[56:59], v[40:43]
    v_cvt_pk_bf16_f32 v95, v95, v95
    v_lshlrev_b32 v95, 16, v95
    v_add_f32 v95, 925353388, v95
    v_mfma_f32_16x16x32_bf16 v[60:63], v[136:139], a[56:59], v[60:63]
    v_cvt_pk_bf16_f32 v95, v95, v95
    v_lshlrev_b32 v95, 16, v95
    v_mfma_f32_16x16x32_bf16 v[40:43], v[132:135], a[60:63], v[40:43]
    v_sqrt_f32 v95, v95
    s_nop 0
    v_cvt_pk_bf16_f32 v95, v95, v95
    v_mfma_f32_16x16x32_bf16 v[60:63], v[140:143], a[60:63], v[60:63]
    v_lshlrev_b32 v95, 16, v95
    v_rcp_f32 v94, v95
    v_mfma_f32_16x16x32_bf16 v[44:47], v[128:131], a[64:67], v[44:47]
    ds_write2_b32 v246, v93, v94 offset0:0 offset1:16
    ds_read_b128 v[96:99], v247 offset:11520
    v_mfma_f32_16x16x32_bf16 v[64:67], v[136:139], a[64:67], v[64:67]
    ds_read_b128 v[100:103], v247 offset:11584
    ds_read_b128 v[104:107], v247 offset:11648
    ds_read_b128 v[108:111], v247 offset:11712
    v_mfma_f32_16x16x32_bf16 v[44:47], v[132:135], a[68:71], v[44:47]
    ds_read_b64 a[240:241], v176
    v_mfma_f32_16x16x32_bf16 v[64:67], v[140:143], a[68:71], v[64:67]
    ds_read_b64 a[242:243], v177
    v_mfma_f32_16x16x32_bf16 v[48:51], v[128:131], a[72:75], v[48:51]
    ds_read_b64 a[244:245], v178
    v_mfma_f32_16x16x32_bf16 v[68:71], v[136:139], a[72:75], v[68:71]
    ds_read_b64 a[246:247], v179
    v_mfma_f32_16x16x32_bf16 v[48:51], v[132:135], a[76:79], v[48:51]
    ds_read_b64 a[248:249], v180
    v_mfma_f32_16x16x32_bf16 v[68:71], v[140:143], a[76:79], v[68:71]
    s_waitcnt lgkmcnt(0)
    v_pk_fma_f32 v[32:33], v[96:97], v[72:73], v[32:33] op_sel_hi:[1,0,1] neg_lo:[1,0,0] neg_hi:[1,0,0]
    v_pk_fma_f32 v[34:35], v[98:99], v[72:73], v[34:35] op_sel_hi:[1,0,1] neg_lo:[1,0,0] neg_hi:[1,0,0]
    v_pk_fma_f32 v[52:53], v[104:105], v[72:73], v[52:53] op_sel_hi:[1,0,1] neg_lo:[1,0,0] neg_hi:[1,0,0]
    v_pk_fma_f32 v[54:55], v[106:107], v[72:73], v[54:55] op_sel_hi:[1,0,1] neg_lo:[1,0,0] neg_hi:[1,0,0]
    v_pk_mul_f32 v[32:33], v[32:33], v[100:101]
    v_pk_mul_f32 v[34:35], v[34:35], v[102:103]
    v_pk_mul_f32 v[52:53], v[52:53], v[108:109]
    v_pk_mul_f32 v[54:55], v[54:55], v[110:111]
    v_cvt_pk_bf16_f32 v32, v32, v33
    v_cvt_pk_bf16_f32 v33, v34, v35
    v_cvt_pk_bf16_f32 v34, v52, v53
    v_cvt_pk_bf16_f32 v35, v54, v55
    s_add_u32 s50, s49, 0
    v_permlane16_swap_b32 v32, v34
    v_permlane16_swap_b32 v33, v35
    s_nop 1
    buffer_store_dwordx4 v[32:35], v252, s[64:67], s50 offen sc1
    v_pk_fma_f32 v[36:37], v[96:97], v[76:77], v[36:37] op_sel_hi:[1,0,1] neg_lo:[1,0,0] neg_hi:[1,0,0]
    v_pk_fma_f32 v[38:39], v[98:99], v[76:77], v[38:39] op_sel_hi:[1,0,1] neg_lo:[1,0,0] neg_hi:[1,0,0]
    v_pk_fma_f32 v[56:57], v[104:105], v[76:77], v[56:57] op_sel_hi:[1,0,1] neg_lo:[1,0,0] neg_hi:[1,0,0]
    v_pk_fma_f32 v[58:59], v[106:107], v[76:77], v[58:59] op_sel_hi:[1,0,1] neg_lo:[1,0,0] neg_hi:[1,0,0]
    v_pk_mul_f32 v[36:37], v[36:37], v[100:101]
    v_pk_mul_f32 v[38:39], v[38:39], v[102:103]
    v_pk_mul_f32 v[56:57], v[56:57], v[108:109]
    v_pk_mul_f32 v[58:59], v[58:59], v[110:111]
    v_cvt_pk_bf16_f32 v36, v36, v37
    v_cvt_pk_bf16_f32 v37, v38, v39
    v_cvt_pk_bf16_f32 v38, v56, v57
    v_cvt_pk_bf16_f32 v39, v58, v59
    s_add_u32 s50, s49, 65536
    v_permlane16_swap_b32 v36, v38
    v_permlane16_swap_b32 v37, v39
    s_nop 1
    buffer_store_dwordx4 v[36:39], v252, s[64:67], s50 offen sc1
    v_pk_fma_f32 v[40:41], v[96:97], v[80:81], v[40:41] op_sel_hi:[1,0,1] neg_lo:[1,0,0] neg_hi:[1,0,0]
    v_pk_fma_f32 v[42:43], v[98:99], v[80:81], v[42:43] op_sel_hi:[1,0,1] neg_lo:[1,0,0] neg_hi:[1,0,0]
    v_pk_fma_f32 v[60:61], v[104:105], v[80:81], v[60:61] op_sel_hi:[1,0,1] neg_lo:[1,0,0] neg_hi:[1,0,0]
    v_pk_fma_f32 v[62:63], v[106:107], v[80:81], v[62:63] op_sel_hi:[1,0,1] neg_lo:[1,0,0] neg_hi:[1,0,0]
    v_pk_mul_f32 v[40:41], v[40:41], v[100:101]
    v_pk_mul_f32 v[42:43], v[42:43], v[102:103]
    v_pk_mul_f32 v[60:61], v[60:61], v[108:109]
    v_pk_mul_f32 v[62:63], v[62:63], v[110:111]
    v_cvt_pk_bf16_f32 v40, v40, v41
    v_cvt_pk_bf16_f32 v41, v42, v43
    v_cvt_pk_bf16_f32 v42, v60, v61
    v_cvt_pk_bf16_f32 v43, v62, v63
    s_add_u32 s50, s49, 131072
    v_permlane16_swap_b32 v40, v42
    v_permlane16_swap_b32 v41, v43
    s_nop 1
    buffer_store_dwordx4 v[40:43], v252, s[64:67], s50 offen sc1
    v_pk_fma_f32 v[44:45], v[96:97], v[84:85], v[44:45] op_sel_hi:[1,0,1] neg_lo:[1,0,0] neg_hi:[1,0,0]
    v_pk_fma_f32 v[46:47], v[98:99], v[84:85], v[46:47] op_sel_hi:[1,0,1] neg_lo:[1,0,0] neg_hi:[1,0,0]
    v_pk_fma_f32 v[64:65], v[104:105], v[84:85], v[64:65] op_sel_hi:[1,0,1] neg_lo:[1,0,0] neg_hi:[1,0,0]
    v_pk_fma_f32 v[66:67], v[106:107], v[84:85], v[66:67] op_sel_hi:[1,0,1] neg_lo:[1,0,0] neg_hi:[1,0,0]
    v_pk_mul_f32 v[44:45], v[44:45], v[100:101]
    v_pk_mul_f32 v[46:47], v[46:47], v[102:103]
    v_pk_mul_f32 v[64:65], v[64:65], v[108:109]
    v_pk_mul_f32 v[66:67], v[66:67], v[110:111]
    v_cvt_pk_bf16_f32 v44, v44, v45
    v_cvt_pk_bf16_f32 v45, v46, v47
    v_cvt_pk_bf16_f32 v46, v64, v65
    v_cvt_pk_bf16_f32 v47, v66, v67
    s_add_u32 s50, s49, 196608
    v_permlane16_swap_b32 v44, v46
    v_permlane16_swap_b32 v45, v47
    s_nop 1
    buffer_store_dwordx4 v[44:47], v252, s[64:67], s50 offen sc1
    v_pk_fma_f32 v[48:49], v[96:97], v[88:89], v[48:49] op_sel_hi:[1,0,1] neg_lo:[1,0,0] neg_hi:[1,0,0]
    v_pk_fma_f32 v[50:51], v[98:99], v[88:89], v[50:51] op_sel_hi:[1,0,1] neg_lo:[1,0,0] neg_hi:[1,0,0]
    v_pk_fma_f32 v[68:69], v[104:105], v[88:89], v[68:69] op_sel_hi:[1,0,1] neg_lo:[1,0,0] neg_hi:[1,0,0]
    v_pk_fma_f32 v[70:71], v[106:107], v[88:89], v[70:71] op_sel_hi:[1,0,1] neg_lo:[1,0,0] neg_hi:[1,0,0]
    v_pk_mul_f32 v[48:49], v[48:49], v[100:101]
    v_pk_mul_f32 v[50:51], v[50:51], v[102:103]
    v_pk_mul_f32 v[68:69], v[68:69], v[108:109]
    v_pk_mul_f32 v[70:71], v[70:71], v[110:111]
    v_cvt_pk_bf16_f32 v48, v48, v49
    v_cvt_pk_bf16_f32 v49, v50, v51
    v_cvt_pk_bf16_f32 v50, v68, v69
    v_cvt_pk_bf16_f32 v51, v70, v71
    s_add_u32 s50, s49, 262144
    v_permlane16_swap_b32 v48, v50
    v_permlane16_swap_b32 v49, v51
    s_nop 1
    buffer_store_dwordx4 v[48:51], v252, s[64:67], s50 offen sc1
    s_add_u32 m0, s46, 8192
    s_add_u32 s42, s55, 0
    s_and_b32 s42, s42, 0x3ff
    s_add_u32 s42, s42, s41
    buffer_load_dwordx4 v16, s[56:59], s42 offen offset:0 lds
    buffer_load_dwordx4 v17, s[56:59], s42 offen offset:1024 lds
    buffer_load_dwordx4 v18, s[56:59], s42 offen offset:2048 lds
    buffer_load_dwordx4 v19, s[56:59], s42 offen offset:3072 lds
    s_add_u32 m0, s46, 12288
    s_nop 0
    buffer_load_dwordx4 v20, s[56:59], s42 offen offset:0 lds
    buffer_load_dwordx4 v21, s[56:59], s42 offen offset:1024 lds
    buffer_load_dwordx4 v22, s[56:59], s42 offen offset:2048 lds
    buffer_load_dwordx4 v23, s[56:59], s42 offen offset:3072 lds
    s_add_u32 m0, s46, 16384
    s_add_u32 s42, s93, 0
    s_and_b32 s42, s42, 0x3ff
    s_add_u32 s42, s42, s40
    buffer_load_dwordx4 v16, s[56:59], s42 offen offset:0 lds
    buffer_load_dwordx4 v17, s[56:59], s42 offen offset:1024 lds
    buffer_load_dwordx4 v18, s[56:59], s42 offen offset:2048 lds
    buffer_load_dwordx4 v19, s[56:59], s42 offen offset:3072 lds
    s_waitcnt vmcnt(12)
    v_mov_b32 v13, 1
    s_mov_b64 exec, 0xffff
    buffer_store_dword v13, v12, s[64:67], s48 offen sc1
    s_mov_b64 exec, -1
    s_add_u32 m0, s46, 20480
    s_nop 0
    buffer_load_dwordx4 v20, s[56:59], s42 offen offset:0 lds
    buffer_load_dwordx4 v21, s[56:59], s42 offen offset:1024 lds
    buffer_load_dwordx4 v22, s[56:59], s42 offen offset:2048 lds
    buffer_load_dwordx4 v23, s[56:59], s42 offen offset:3072 lds
    s_add_u32 m0, s46, 24576
    s_add_u32 s42, s93, 0
    s_and_b32 s42, s42, 0x3ff
    s_add_u32 s42, s42, s41
    buffer_load_dwordx4 v16, s[56:59], s42 offen offset:0 lds
    buffer_load_dwordx4 v17, s[56:59], s42 offen offset:1024 lds
    buffer_load_dwordx4 v18, s[56:59], s42 offen offset:2048 lds
    buffer_load_dwordx4 v19, s[56:59], s42 offen offset:3072 lds
    s_add_u32 m0, s46, 28672
    s_nop 0
    buffer_load_dwordx4 v20, s[56:59], s42 offen offset:0 lds
    buffer_load_dwordx4 v21, s[56:59], s42 offen offset:1024 lds
    buffer_load_dwordx4 v22, s[56:59], s42 offen offset:2048 lds
    buffer_load_dwordx4 v23, s[56:59], s42 offen offset:3072 lds
    buffer_load_dword v31, v14, s[64:67], s60 offen sc1
    s_cmp_lg_u32 s70, 0
    s_cbranch_scc1 k1_priv
    s_waitcnt vmcnt(0)
cp1_l:
    v_cmp_gt_i32 vcc, 1, v31
    s_and_b32 s82, vcc_lo, 15
    s_cbranch_scc0 cp1_ok
cp1_r:
    s_cmp_eq_u32 s69, 0
    s_cbranch_scc1 cp1_f
    s_sub_u32 s69, s69, 1
    s_and_b32 s82, s69, 7
    s_cbranch_scc1 cp1_p
    s_mov_b64 exec, 0xffff
    buffer_store_dword v13, v12, s[64:67], s48 offen sc1
    s_mov_b64 exec, -1
    cp1_p:
    buffer_load_dword v31, v14, s[64:67], s60 offen sc1
    s_waitcnt vmcnt(0)
    s_branch cp1_l
cp1_ok:
    s_add_u32 s43, s55, 0
    s_and_b32 s43, s43, 0x3ff
    s_lshl4_add_u32 s43, s43, s47
    buffer_load_dwordx4 v[32:35], v24, s[64:67], s43 offen offset:0
    buffer_load_dwordx4 v[36:39], v25, s[64:67], s43 offen offset:0
    buffer_load_dwordx4 v[40:43], v26, s[64:67], s43 offen offset:0
    buffer_load_dwordx4 v[44:47], v27, s[64:67], s43 offen offset:0
    buffer_load_dwordx4 v[48:51], v28, s[64:67], s43 offen offset:0
    s_add_u32 s43, s55, 0
    s_and_b32 s43, s43, 0x3ff
    s_lshl4_add_u32 s43, s43, s47
    buffer_load_dwordx4 v[52:55], v24, s[64:67], s43 offen offset:1024
    buffer_load_dwordx4 v[56:59], v25, s[64:67], s43 offen offset:1024
    buffer_load_dwordx4 v[60:63], v26, s[64:67], s43 offen offset:1024
    buffer_load_dwordx4 v[64:67], v27, s[64:67], s43 offen offset:1024
    buffer_load_dwordx4 v[68:71], v28, s[64:67], s43 offen offset:1024
    buffer_load_dword v31, v14, s[64:67], s60 offen sc1
    s_add_u32 s43, s93, 0
    s_and_b32 s43, s43, 0x3ff
    s_lshl4_add_u32 s43, s43, s47
    buffer_load_dwordx4 v[72:75], v24, s[64:67], s43 offen offset:0
    buffer_load_dwordx4 v[76:79], v25, s[64:67], s43 offen offset:0
    buffer_load_dwordx4 v[80:83], v26, s[64:67], s43 offen offset:0
    buffer_load_dwordx4 v[84:87], v27, s[64:67], s43 offen offset:0
    buffer_load_dwordx4 v[88:91], v28, s[64:67], s43 offen offset:0
    s_add_u32 s43, s93, 0
    s_and_b32 s43, s43, 0x3ff
    s_lshl4_add_u32 s43, s43, s47
    buffer_load_dwordx4 v[92:95], v24, s[64:67], s43 offen offset:1024
    buffer_load_dwordx4 v[96:99], v25, s[64:67], s43 offen offset:1024
    buffer_load_dwordx4 v[100:103], v26, s[64:67], s43 offen offset:1024
    buffer_load_dwordx4 v[104:107], v27, s[64:67], s43 offen offset:1024
    buffer_load_dwordx4 v[108:111], v28, s[64:67], s43 offen offset:1024
    s_waitcnt vmcnt(63)
    v_xor_b32 v169, 32, v9
    v_xor_b32 v170, 64, v9
    v_xor_b32 v171, 96, v9
    v_xor_b32 v172, 128, v9
    v_xor_b32 v173, 160, v9
    v_xor_b32 v174, 192, v9
    v_xor_b32 v175, 224, v9
    s_mov_b64 s[36:37], s[6:7]
    s_and_b32 s38, s95, 0x10000000
    v_perm_b32 v224, v196, v192, s89
    v_perm_b32 v225, v204, v200, s89
    ds_write_b64 v160, v[224:225] offset:0
    v_perm_b32 v226, v196, v192, s90
    v_perm_b32 v227, v204, v200, s90
    ds_write_b64 v160, v[226:227] offset:16
    v_perm_b32 v228, v197, v193, s89
    v_perm_b32 v229, v205, v201, s89
    ds_write_b64 v161, v[228:229] offset:0
    v_perm_b32 v230, v197, v193, s90
    v_perm_b32 v231, v205, v201, s90
    ds_write_b64 v161, v[230:231] offset:16
    v_perm_b32 v232, v198, v194, s89
    v_perm_b32 v233, v206, v202, s89
    ds_write_b64 v162, v[232:233] offset:0
    v_perm_b32 v234, v198, v194, s90
    v_perm_b32 v235, v206, v202, s90
    ds_write_b64 v162, v[234:235] offset:16
    v_perm_b32 v236, v199, v195, s89
    v_perm_b32 v237, v207, v203, s89
    ds_write_b64 v163, v[236:237] offset:0
    v_perm_b32 v238, v199, v195, s90
    v_perm_b32 v239, v207, v203, s90
    ds_write_b64 v163, v[238:239] offset:16
    v_perm_b32 v240, v212, v208, s89
    v_perm_b32 v241, v220, v216, s89
    ds_write_b64 v164, v[240:241] offset:0
    v_perm_b32 v242, v212, v208, s90
    v_perm_b32 v243, v220, v216, s90
    ds_write_b64 v164, v[242:243] offset:16
    v_perm_b32 v244, v213, v209, s89
    v_perm_b32 v245, v221, v217, s89
    ds_write_b64 v165, v[244:245] offset:0
    v_perm_b32 v246, v213, v209, s90
    v_perm_b32 v247, v221, v217, s90
    ds_write_b64 v165, v[246:247] offset:16
    v_perm_b32 v248, v214, v210, s89
    v_perm_b32 v249, v222, v218, s89
    ds_write_b64 v166, v[248:249] offset:0
    v_perm_b32 v250, v214, v210, s90
    v_perm_b32 v251, v222, v218, s90
    ds_write_b64 v166, v[250:251] offset:16
    v_perm_b32 v252, v215, v211, s89
    v_perm_b32 v253, v223, v219, s89
    ds_write_b64 v167, v[252:253] offset:0
    v_perm_b32 v254, v215, v211, s90
    v_perm_b32 v255, v223, v219, s90
    ds_write_b64 v167, v[254:255] offset:16
    ds_read_b128 v[192:195], v9 offset:32768
    ds_read_b128 v[196:199], v169 offset:33792
    ds_read_b128 v[200:203], v170 offset:34816
    ds_read_b128 v[204:207], v171 offset:35840
    ds_read_b128 v[208:211], v172 offset:36864
    ds_read_b128 v[212:215], v173 offset:37888
    ds_read_b128 v[216:219], v174 offset:38912
    ds_read_b128 v[220:223], v175 offset:39936
    s_waitcnt lgkmcnt(7)
    buffer_store_dwordx4 v[192:195], v8, s[36:39], s87 offen sc1
    s_add_u32 s87, s87, s88
    s_waitcnt lgkmcnt(6)
    buffer_store_dwordx4 v[196:199], v8, s[36:39], s87 offen sc1
    s_add_u32 s87, s87, s88
    s_waitcnt lgkmcnt(5)
    buffer_store_dwordx4 v[200:203], v8, s[36:39], s87 offen sc1
    s_add_u32 s87, s87, s88
    s_waitcnt lgkmcnt(4)
    buffer_store_dwordx4 v[204:207], v8, s[36:39], s87 offen sc1
    s_add_u32 s87, s87, s92
    s_waitcnt lgkmcnt(3)
    buffer_store_dwordx4 v[208:211], v8, s[36:39], s87 offen sc1
    s_add_u32 s87, s87, s88
    s_waitcnt lgkmcnt(2)
    buffer_store_dwordx4 v[212:215], v8, s[36:39], s87 offen sc1
    s_add_u32 s87, s87, s88
    s_waitcnt lgkmcnt(1)
    buffer_store_dwordx4 v[216:219], v8, s[36:39], s87 offen sc1
    s_add_u32 s87, s87, s88
    s_waitcnt lgkmcnt(0)
    buffer_store_dwordx4 v[220:223], v8, s[36:39], s87 offen sc1
    s_cmp_lg_u32 s70, 0
    s_cbranch_scc1 k1_priv2
k1_go:
    s_waitcnt vmcnt(60)
    ds_read_b128 v[192:195], v29 offset:0
    ds_read_b128 v[196:199], v29 offset:2048
    ds_read_b128 v[200:203], v29 offset:4096
    ds_read_b128 v[204:207], v29 offset:6144
    ds_read_b128 v[208:211], v30 offset:0
    ds_read_b128 v[212:215], v30 offset:2048
    ds_read_b128 v[216:219], v30 offset:4096
    ds_read_b128 v[220:223], v30 offset:6144
    s_waitcnt vmcnt(19) lgkmcnt(0)
    v_mfma_f32_16x16x32_bf16 a[0:3], v[32:35], v[192:195], 0
    s_add_u32 m0, s46, 0
    v_mfma_f32_16x16x32_bf16 a[4:7], v[32:35], v[196:199], 0
    s_add_u32 s42, s55, 256
    ds_read_b128 v[224:227], v29 offset:8192
    ds_read_b128 v[228:231], v29 offset:10240
    v_mfma_f32_16x16x32_bf16 a[8:11], v[32:35], v[200:203], 0
    s_and_b32 s42, s42, 0x3ff
    v_mfma_f32_16x16x32_bf16 a[12:15], v[32:35], v[204:207], 0
    s_add_u32 s42, s42, s40
    ds_read_b128 v[232:235], v29 offset:12288
    ds_read_b128 v[236:239], v29 offset:14336
    v_mfma_f32_16x16x32_bf16 a[16:19], v[36:39], v[192:195], 0
    buffer_load_dwordx4 v16, s[56:59], s42 offen offset:0 lds
    v_mfma_f32_16x16x32_bf16 a[20:23], v[36:39], v[196:199], 0
    ds_read_b128 v[240:243], v30 offset:8192
    ds_read_b128 v[244:247], v30 offset:10240
    v_mfma_f32_16x16x32_bf16 a[24:27], v[36:39], v[200:203], 0
    buffer_load_dwordx4 v17, s[56:59], s42 offen offset:1024 lds
    v_mfma_f32_16x16x32_bf16 a[28:31], v[36:39], v[204:207], 0
    ds_read_b128 v[248:251], v30 offset:12288
    ds_read_b128 v[252:255], v30 offset:14336
    v_mfma_f32_16x16x32_bf16 a[32:35], v[40:43], v[192:195], 0
    buffer_load_dwordx4 v18, s[56:59], s42 offen offset:2048 lds
    v_mfma_f32_16x16x32_bf16 a[36:39], v[40:43], v[196:199], 0
    buffer_load_dwordx4 v19, s[56:59], s42 offen offset:3072 lds
    v_mfma_f32_16x16x32_bf16 a[40:43], v[40:43], v[200:203], 0
    s_add_u32 m0, s46, 4096
    v_mfma_f32_16x16x32_bf16 a[44:47], v[40:43], v[204:207], 0
    buffer_load_dwordx4 v20, s[56:59], s42 offen offset:0 lds
    v_mfma_f32_16x16x32_bf16 a[48:51], v[44:47], v[192:195], 0
    s_waitcnt vmcnt(23)
    v_cmp_gt_i32 vcc, 1, v31
    v_mfma_f32_16x16x32_bf16 a[52:55], v[44:47], v[196:199], 0
    v_mfma_f32_16x16x32_bf16 a[56:59], v[44:47], v[200:203], 0
    s_and_b32 s82, vcc_lo, 240
    s_cbranch_scc1 cp2_r
cp2_ok:
    v_mfma_f32_16x16x32_bf16 a[60:63], v[44:47], v[204:207], 0
    buffer_load_dwordx4 v21, s[56:59], s42 offen offset:1024 lds
    v_mfma_f32_16x16x32_bf16 a[64:67], v[48:51], v[192:195], 0
    v_mfma_f32_16x16x32_bf16 a[68:71], v[48:51], v[196:199], 0
    buffer_load_dwordx4 v22, s[56:59], s42 offen offset:2048 lds
    v_mfma_f32_16x16x32_bf16 a[72:75], v[48:51], v[200:203], 0
    v_mfma_f32_16x16x32_bf16 a[76:79], v[48:51], v[204:207], 0
    v_mfma_f32_16x16x32_bf16 a[0:3], v[52:55], v[208:211], a[0:3]
    buffer_load_dwordx4 v23, s[56:59], s42 offen offset:3072 lds
    v_mfma_f32_16x16x32_bf16 a[4:7], v[52:55], v[212:215], a[4:7]
    s_add_u32 s43, s55, 256
    v_mfma_f32_16x16x32_bf16 a[8:11], v[52:55], v[216:219], a[8:11]
    s_and_b32 s43, s43, 0x3ff
    v_mfma_f32_16x16x32_bf16 a[12:15], v[52:55], v[220:223], a[12:15]
    s_lshl4_add_u32 s43, s43, s47
    v_mfma_f32_16x16x32_bf16 a[16:19], v[56:59], v[208:211], a[16:19]
    buffer_load_dwordx4 a[160:163], v24, s[64:67], s43 offen offset:0
    v_mfma_f32_16x16x32_bf16 a[20:23], v[56:59], v[212:215], a[20:23]
    v_mfma_f32_16x16x32_bf16 a[24:27], v[56:59], v[216:219], a[24:27]
    buffer_load_dwordx4 a[164:167], v25, s[64:67], s43 offen offset:0
    v_mfma_f32_16x16x32_bf16 a[28:31], v[56:59], v[220:223], a[28:31]
    v_mfma_f32_16x16x32_bf16 a[32:35], v[60:63], v[208:211], a[32:35]
    v_mfma_f32_16x16x32_bf16 a[36:39], v[60:63], v[212:215], a[36:39]
    buffer_load_dwordx4 a[168:171], v26, s[64:67], s43 offen offset:0
    v_mfma_f32_16x16x32_bf16 a[40:43], v[60:63], v[216:219], a[40:43]
    v_mfma_f32_16x16x32_bf16 a[44:47], v[60:63], v[220:223], a[44:47]
    v_mfma_f32_16x16x32_bf16 a[48:51], v[64:67], v[208:211], a[48:51]
    buffer_load_dwordx4 a[172:175], v27, s[64:67], s43 offen offset:0
    v_mfma_f32_16x16x32_bf16 a[52:55], v[64:67], v[212:215], a[52:55]
    v_mfma_f32_16x16x32_bf16 a[56:59], v[64:67], v[216:219], a[56:59]
    v_mfma_f32_16x16x32_bf16 a[60:63], v[64:67], v[220:223], a[60:63]
    buffer_load_dwordx4 a[176:179], v28, s[64:67], s43 offen offset:0
    v_mfma_f32_16x16x32_bf16 a[64:67], v[68:71], v[208:211], a[64:67]
    v_mfma_f32_16x16x32_bf16 a[68:71], v[68:71], v[212:215], a[68:71]
    v_mfma_f32_16x16x32_bf16 a[72:75], v[68:71], v[216:219], a[72:75]
    v_mfma_f32_16x16x32_bf16 a[76:79], v[68:71], v[220:223], a[76:79]
    s_waitcnt vmcnt(51) lgkmcnt(0)
    v_mfma_f32_16x16x32_bf16 a[80:83], v[32:35], v[224:227], 0
    s_add_u32 s43, s55, 256
    v_mfma_f32_16x16x32_bf16 a[84:87], v[32:35], v[228:231], 0
    s_and_b32 s43, s43, 0x3ff
    ds_read_b128 v[192:195], v29 offset:16384
    ds_read_b128 v[196:199], v29 offset:18432
    v_mfma_f32_16x16x32_bf16 a[88:91], v[32:35], v[232:235], 0
    s_lshl4_add_u32 s43, s43, s47
    v_mfma_f32_16x16x32_bf16 a[92:95], v[32:35], v[236:239], 0
    ds_read_b128 v[200:203], v29 offset:20480
    ds_read_b128 v[204:207], v29 offset:22528
    v_mfma_f32_16x16x32_bf16 a[96:99], v[36:39], v[224:227], 0
    buffer_load_dwordx4 a[180:183], v24, s[64:67], s43 offen offset:1024
    v_mfma_f32_16x16x32_bf16 a[100:103], v[36:39], v[228:231], 0
    ds_read_b128 v[208:211], v30 offset:16384
    ds_read_b128 v[212:215], v30 offset:18432
    v_mfma_f32_16x16x32_bf16 a[104:107], v[36:39], v[232:235], 0
    buffer_load_dwordx4 a[184:187], v25, s[64:67], s43 offen offset:1024
    v_mfma_f32_16x16x32_bf16 a[108:111], v[36:39], v[236:239], 0
    ds_read_b128 v[216:219], v30 offset:20480
    ds_read_b128 v[220:223], v30 offset:22528
    v_mfma_f32_16x16x32_bf16 a[112:115], v[40:43], v[224:227], 0
    buffer_load_dwordx4 a[188:191], v26, s[64:67], s43 offen offset:1024
    v_mfma_f32_16x16x32_bf16 a[116:119], v[40:43], v[228:231], 0
    buffer_load_dwordx4 a[192:195], v27, s[64:67], s43 offen offset:1024
    v_mfma_f32_16x16x32_bf16 a[120:123], v[40:43], v[232:235], 0
    s_add_u32 m0, s46, 8192
    v_mfma_f32_16x16x32_bf16 a[124:127], v[40:43], v[236:239], 0
    s_add_u32 s42, s55, 256
    v_mfma_f32_16x16x32_bf16 a[128:131], v[44:47], v[224:227], 0
    s_waitcnt vmcnt(17)
    v_mfma_f32_16x16x32_bf16 a[132:135], v[44:47], v[228:231], 0
    v_mov_b32 v13, 2
    s_mov_b64 exec, 0xffff
    buffer_store_dword v13, v12, s[64:67], s48 offen sc1
    s_mov_b64 exec, -1
    s_nop 0
    v_mfma_f32_16x16x32_bf16 a[136:139], v[44:47], v[232:235], 0
    s_and_b32 s42, s42, 0x3ff
    v_mfma_f32_16x16x32_bf16 a[140:143], v[44:47], v[236:239], 0
    s_add_u32 s42, s42, s41
    v_mfma_f32_16x16x32_bf16 a[144:147], v[48:51], v[224:227], 0
    buffer_load_dwordx4 v16, s[56:59], s42 offen offset:0 lds
    v_mfma_f32_16x16x32_bf16 a[148:151], v[48:51], v[228:231], 0
    buffer_load_dwordx4 a[196:199], v28, s[64:67], s43 offen offset:1024
    v_mfma_f32_16x16x32_bf16 a[152:155], v[48:51], v[232:235], 0
    buffer_load_dwordx4 v17, s[56:59], s42 offen offset:1024 lds
    v_mfma_f32_16x16x32_bf16 a[156:159], v[48:51], v[236:239], 0
    v_mfma_f32_16x16x32_bf16 a[80:83], v[52:55], v[240:243], a[80:83]
    buffer_load_dwordx4 v18, s[56:59], s42 offen offset:2048 lds
    v_mfma_f32_16x16x32_bf16 a[84:87], v[52:55], v[244:247], a[84:87]
    v_mfma_f32_16x16x32_bf16 a[88:91], v[52:55], v[248:251], a[88:91]
    v_mfma_f32_16x16x32_bf16 a[92:95], v[52:55], v[252:255], a[92:95]
    buffer_load_dwordx4 v19, s[56:59], s42 offen offset:3072 lds
    v_mfma_f32_16x16x32_bf16 a[96:99], v[56:59], v[240:243], a[96:99]
    v_mfma_f32_16x16x32_bf16 a[100:103], v[56:59], v[244:247], a[100:103]
    s_add_u32 m0, s46, 12288
    v_mfma_f32_16x16x32_bf16 a[104:107], v[56:59], v[248:251], a[104:107]
    buffer_load_dwordx4 v20, s[56:59], s42 offen offset:0 lds
    v_mfma_f32_16x16x32_bf16 a[108:111], v[56:59], v[252:255], a[108:111]
    v_mfma_f32_16x16x32_bf16 a[112:115], v[60:63], v[240:243], a[112:115]
    v_mfma_f32_16x16x32_bf16 a[116:119], v[60:63], v[244:247], a[116:119]
    buffer_load_dwordx4 v21, s[56:59], s42 offen offset:1024 lds
    v_mfma_f32_16x16x32_bf16 a[120:123], v[60:63], v[248:251], a[120:123]
    v_mfma_f32_16x16x32_bf16 a[124:127], v[60:63], v[252:255], a[124:127]
    v_mfma_f32_16x16x32_bf16 a[128:131], v[64:67], v[240:243], a[128:131]
    buffer_load_dwordx4 v22, s[56:59], s42 offen offset:2048 lds
    v_mfma_f32_16x16x32_bf16 a[132:135], v[64:67], v[244:247], a[132:135]
    v_mfma_f32_16x16x32_bf16 a[136:139], v[64:67], v[248:251], a[136:139]
    v_mfma_f32_16x16x32_bf16 a[140:143], v[64:67], v[252:255], a[140:143]
    buffer_load_dwordx4 v23, s[56:59], s42 offen offset:3072 lds
    v_mfma_f32_16x16x32_bf16 a[144:147], v[68:71], v[240:243], a[144:147]
    v_mfma_f32_16x16x32_bf16 a[148:151], v[68:71], v[244:247], a[148:151]
    v_mfma_f32_16x16x32_bf16 a[152:155], v[68:71], v[248:251], a[152:155]
    v_mfma_f32_16x16x32_bf16 a[156:159], v[68:71], v[252:255], a[156:159]
    s_waitcnt vmcnt(35) lgkmcnt(0)
    v_mfma_f32_16x16x32_bf16 a[0:3], v[72:75], v[192:195], a[0:3]
    s_add_u32 m0, s46, 16384
    v_mfma_f32_16x16x32_bf16 a[4:7], v[72:75], v[196:199], a[4:7]
    s_add_u32 s42, s93, 256
    ds_read_b128 v[224:227], v29 offset:24576
    ds_read_b128 v[228:231], v29 offset:26624
    v_mfma_f32_16x16x32_bf16 a[8:11], v[72:75], v[200:203], a[8:11]
    s_and_b32 s42, s42, 0x3ff
    v_mfma_f32_16x16x32_bf16 a[12:15], v[72:75], v[204:207], a[12:15]
    s_add_u32 s42, s42, s40
    ds_read_b128 v[232:235], v29 offset:28672
    ds_read_b128 v[236:239], v29 offset:30720
    v_mfma_f32_16x16x32_bf16 a[16:19], v[76:79], v[192:195], a[16:19]
    buffer_load_dwordx4 v16, s[56:59], s42 offen offset:0 lds
    v_mfma_f32_16x16x32_bf16 a[20:23], v[76:79], v[196:199], a[20:23]
    ds_read_b128 v[240:243], v30 offset:24576
    ds_read_b128 v[244:247], v30 offset:26624
    v_mfma_f32_16x16x32_bf16 a[24:27], v[76:79], v[200:203], a[24:27]
    buffer_load_dwordx4 v17, s[56:59], s42 offen offset:1024 lds
    v_mfma_f32_16x16x32_bf16 a[28:31], v[76:79], v[204:207], a[28:31]
    ds_read_b128 v[248:251], v30 offset:28672
    ds_read_b128 v[252:255], v30 offset:30720
    v_mfma_f32_16x16x32_bf16 a[32:35], v[80:83], v[192:195], a[32:35]
    buffer_load_dwordx4 v18, s[56:59], s42 offen offset:2048 lds
    v_mfma_f32_16x16x32_bf16 a[36:39], v[80:83], v[196:199], a[36:39]
    buffer_load_dwordx4 v19, s[56:59], s42 offen offset:3072 lds
    v_mfma_f32_16x16x32_bf16 a[40:43], v[80:83], v[200:203], a[40:43]
    s_add_u32 m0, s46, 20480
    v_mfma_f32_16x16x32_bf16 a[44:47], v[80:83], v[204:207], a[44:47]
    buffer_load_dwordx4 v20, s[56:59], s42 offen offset:0 lds
    v_mfma_f32_16x16x32_bf16 a[48:51], v[84:87], v[192:195], a[48:51]
    v_mfma_f32_16x16x32_bf16 a[52:55], v[84:87], v[196:199], a[52:55]
    v_mfma_f32_16x16x32_bf16 a[56:59], v[84:87], v[200:203], a[56:59]
    buffer_load_dwordx4 v21, s[56:59], s42 offen offset:1024 lds
    v_mfma_f32_16x16x32_bf16 a[60:63], v[84:87], v[204:207], a[60:63]
    v_mfma_f32_16x16x32_bf16 a[64:67], v[88:91], v[192:195], a[64:67]
    v_mfma_f32_16x16x32_bf16 a[68:71], v[88:91], v[196:199], a[68:71]
    buffer_load_dwordx4 v22, s[56:59], s42 offen offset:2048 lds
    v_mfma_f32_16x16x32_bf16 a[72:75], v[88:91], v[200:203], a[72:75]
    v_mfma_f32_16x16x32_bf16 a[76:79], v[88:91], v[204:207], a[76:79]
    v_mfma_f32_16x16x32_bf16 a[0:3], v[92:95], v[208:211], a[0:3]
    buffer_load_dwordx4 v23, s[56:59], s42 offen offset:3072 lds
    v_mfma_f32_16x16x32_bf16 a[4:7], v[92:95], v[212:215], a[4:7]
    s_add_u32 s43, s93, 256
    v_mfma_f32_16x16x32_bf16 a[8:11], v[92:95], v[216:219], a[8:11]
    s_and_b32 s43, s43, 0x3ff
    v_mfma_f32_16x16x32_bf16 a[12:15], v[92:95], v[220:223], a[12:15]
    s_lshl4_add_u32 s43, s43, s47
    v_mfma_f32_16x16x32_bf16 a[16:19], v[96:99], v[208:211], a[16:19]
    buffer_load_dwordx4 a[200:203], v24, s[64:67], s43 offen offset:0
    v_mfma_f32_16x16x32_bf16 a[20:23], v[96:99], v[212:215], a[20:23]
    v_mfma_f32_16x16x32_bf16 a[24:27], v[96:99], v[216:219], a[24:27]
    buffer_load_dwordx4 a[204:207], v25, s[64:67], s43 offen offset:0
    v_mfma_f32_16x16x32_bf16 a[28:31], v[96:99], v[220:223], a[28:31]
    v_mfma_f32_16x16x32_bf16 a[32:35], v[100:103], v[208:211], a[32:35]
    v_mfma_f32_16x16x32_bf16 a[36:39], v[100:103], v[212:215], a[36:39]
    buffer_load_dwordx4 a[208:211], v26, s[64:67], s43 offen offset:0
    v_mfma_f32_16x16x32_bf16 a[40:43], v[100:103], v[216:219], a[40:43]
    v_mfma_f32_16x16x32_bf16 a[44:47], v[100:103], v[220:223], a[44:47]
    v_mfma_f32_16x16x32_bf16 a[48:51], v[104:107], v[208:211], a[48:51]
    buffer_load_dwordx4 a[212:215], v27, s[64:67], s43 offen offset:0
    v_mfma_f32_16x16x32_bf16 a[52:55], v[104:107], v[212:215], a[52:55]
    v_mfma_f32_16x16x32_bf16 a[56:59], v[104:107], v[216:219], a[56:59]
    v_mfma_f32_16x16x32_bf16 a[60:63], v[104:107], v[220:223], a[60:63]
    buffer_load_dwordx4 a[216:219], v28, s[64:67], s43 offen offset:0
    v_mfma_f32_16x16x32_bf16 a[64:67], v[108:111], v[208:211], a[64:67]
    v_mfma_f32_16x16x32_bf16 a[68:71], v[108:111], v[212:215], a[68:71]
    v_mfma_f32_16x16x32_bf16 a[72:75], v[108:111], v[216:219], a[72:75]
    v_mfma_f32_16x16x32_bf16 a[76:79], v[108:111], v[220:223], a[76:79]
    s_waitcnt vmcnt(32) lgkmcnt(0)
    v_mfma_f32_16x16x32_bf16 a[80:83], v[72:75], v[224:227], a[80:83]
    s_add_u32 s43, s93, 256
    v_mfma_f32_16x16x32_bf16 a[84:87], v[72:75], v[228:231], a[84:87]
    s_and_b32 s43, s43, 0x3ff
    ds_read_b128 v[192:195], v29 offset:0
    ds_read_b128 v[196:199], v29 offset:2048
    v_mfma_f32_16x16x32_bf16 a[88:91], v[72:75], v[232:235], a[88:91]
    s_lshl4_add_u32 s43, s43, s47
    v_mfma_f32_16x16x32_bf16 a[92:95], v[72:75], v[236:239], a[92:95]
    ds_read_b128 v[200:203], v29 offset:4096
    ds_read_b128 v[204:207], v29 offset:6144
    v_mfma_f32_16x16x32_bf16 a[96:99], v[76:79], v[224:227], a[96:99]
    buffer_load_dwordx4 a[220:223], v24, s[64:67], s43 offen offset:1024
    v_mfma_f32_16x16x32_bf16 a[100:103], v[76:79], v[228:231], a[100:103]
    ds_read_b128 v[208:211], v30 offset:0
    ds_read_b128 v[212:215], v30 offset:2048
    v_mfma_f32_16x16x32_bf16 a[104:107], v[76:79], v[232:235], a[104:107]
    buffer_load_dwordx4 a[224:227], v25, s[64:67], s43 offen offset:1024
    v_mfma_f32_16x16x32_bf16 a[108:111], v[76:79], v[236:239], a[108:111]
    ds_read_b128 v[216:219], v30 offset:4096
    ds_read_b128 v[220:223], v30 offset:6144
    v_mfma_f32_16x16x32_bf16 a[112:115], v[80:83], v[224:227], a[112:115]
    buffer_load_dwordx4 a[228:231], v26, s[64:67], s43 offen offset:1024
    v_mfma_f32_16x16x32_bf16 a[116:119], v[80:83], v[228:231], a[116:119]
    buffer_load_dwordx4 a[232:235], v27, s[64:67], s43 offen offset:1024
    v_mfma_f32_16x16x32_bf16 a[120:123], v[80:83], v[232:235], a[120:123]
    s_add_u32 m0, s46, 24576
    v_mfma_f32_16x16x32_bf16 a[124:127], v[80:83], v[236:239], a[124:127]
    s_add_u32 s42, s93, 256
    v_mfma_f32_16x16x32_bf16 a[128:131], v[84:87], v[224:227], a[128:131]
    s_and_b32 s42, s42, 0x3ff
    v_mfma_f32_16x16x32_bf16 a[132:135], v[84:87], v[228:231], a[132:135]
    s_add_u32 s42, s42, s41
    v_mfma_f32_16x16x32_bf16 a[136:139], v[84:87], v[232:235], a[136:139]
    buffer_load_dwordx4 v16, s[56:59], s42 offen offset:0 lds
    v_mfma_f32_16x16x32_bf16 a[140:143], v[84:87], v[236:239], a[140:143]
    buffer_load_dword v31, v14, s[64:67], s60 offen sc1
    v_mfma_f32_16x16x32_bf16 a[144:147], v[88:91], v[224:227], a[144:147]
    buffer_load_dwordx4 a[236:239], v28, s[64:67], s43 offen offset:1024
    v_mfma_f32_16x16x32_bf16 a[148:151], v[88:91], v[228:231], a[148:151]
    buffer_load_dwordx4 v17, s[56:59], s42 offen offset:1024 lds
    v_mfma_f32_16x16x32_bf16 a[152:155], v[88:91], v[232:235], a[152:155]
    v_mfma_f32_16x16x32_bf16 a[156:159], v[88:91], v[236:239], a[156:159]
    v_mfma_f32_16x16x32_bf16 a[80:83], v[92:95], v[240:243], a[80:83]
    buffer_load_dwordx4 v18, s[56:59], s42 offen offset:2048 lds
    v_mfma_f32_16x16x32_bf16 a[84:87], v[92:95], v[244:247], a[84:87]
    v_mfma_f32_16x16x32_bf16 a[88:91], v[92:95], v[248:251], a[88:91]
    v_mfma_f32_16x16x32_bf16 a[92:95], v[92:95], v[252:255], a[92:95]
    buffer_load_dwordx4 v19, s[56:59], s42 offen offset:3072 lds
    v_mfma_f32_16x16x32_bf16 a[96:99], v[96:99], v[240:243], a[96:99]
    v_mfma_f32_16x16x32_bf16 a[100:103], v[96:99], v[244:247], a[100:103]
    s_add_u32 m0, s46, 28672
    v_mfma_f32_16x16x32_bf16 a[104:107], v[96:99], v[248:251], a[104:107]
    buffer_load_dwordx4 v20, s[56:59], s42 offen offset:0 lds
    v_mfma_f32_16x16x32_bf16 a[108:111], v[96:99], v[252:255], a[108:111]
    v_mfma_f32_16x16x32_bf16 a[112:115], v[100:103], v[240:243], a[112:115]
    v_mfma_f32_16x16x32_bf16 a[116:119], v[100:103], v[244:247], a[116:119]
    buffer_load_dwordx4 v21, s[56:59], s42 offen offset:1024 lds
    v_mfma_f32_16x16x32_bf16 a[120:123], v[100:103], v[248:251], a[120:123]
    v_mfma_f32_16x16x32_bf16 a[124:127], v[100:103], v[252:255], a[124:127]
    v_mfma_f32_16x16x32_bf16 a[128:131], v[104:107], v[240:243], a[128:131]
    buffer_load_dwordx4 v22, s[56:59], s42 offen offset:2048 lds
    v_mfma_f32_16x16x32_bf16 a[132:135], v[104:107], v[244:247], a[132:135]
    v_mfma_f32_16x16x32_bf16 a[136:139], v[104:107], v[248:251], a[136:139]
    v_mfma_f32_16x16x32_bf16 a[140:143], v[104:107], v[252:255], a[140:143]
    buffer_load_dwordx4 v23, s[56:59], s42 offen offset:3072 lds
    v_mfma_f32_16x16x32_bf16 a[144:147], v[108:111], v[240:243], a[144:147]
    v_mfma_f32_16x16x32_bf16 a[148:151], v[108:111], v[244:247], a[148:151]
    v_mfma_f32_16x16x32_bf16 a[152:155], v[108:111], v[248:251], a[152:155]
    v_mfma_f32_16x16x32_bf16 a[156:159], v[108:111], v[252:255], a[156:159]
    s_waitcnt vmcnt(27) lgkmcnt(0)
    v_mfma_f32_16x16x32_bf16 a[0:3], a[160:163], v[192:195], a[0:3]
    s_add_u32 m0, s46, 0
    v_mfma_f32_16x16x32_bf16 a[4:7], a[160:163], v[196:199], a[4:7]
    s_add_u32 s42, s55, 512
    ds_read_b128 v[224:227], v29 offset:8192
    ds_read_b128 v[228:231], v29 offset:10240
    v_mfma_f32_16x16x32_bf16 a[8:11], a[160:163], v[200:203], a[8:11]
    s_and_b32 s42, s42, 0x3ff
    v_mfma_f32_16x16x32_bf16 a[12:15], a[160:163], v[204:207], a[12:15]
    s_add_u32 s42, s42, s40
    ds_read_b128 v[232:235], v29 offset:12288
    ds_read_b128 v[236:239], v29 offset:14336
    v_mfma_f32_16x16x32_bf16 a[16:19], a[164:167], v[192:195], a[16:19]
    buffer_load_dwordx4 v16, s[56:59], s42 offen offset:0 lds
    v_mfma_f32_16x16x32_bf16 a[20:23], a[164:167], v[196:199], a[20:23]
    ds_read_b128 v[240:243], v30 offset:8192
    ds_read_b128 v[244:247], v30 offset:10240
    v_mfma_f32_16x16x32_bf16 a[24:27], a[164:167], v[200:203], a[24:27]
    buffer_load_dwordx4 v17, s[56:59], s42 offen offset:1024 lds
    v_mfma_f32_16x16x32_bf16 a[28:31], a[164:167], v[204:207], a[28:31]
    ds_read_b128 v[248:251], v30 offset:12288
    ds_read_b128 v[252:255], v30 offset:14336
    v_mfma_f32_16x16x32_bf16 a[32:35], a[168:171], v[192:195], a[32:35]
    buffer_load_dwordx4 v18, s[56:59], s42 offen offset:2048 lds
    v_mfma_f32_16x16x32_bf16 a[36:39], a[168:171], v[196:199], a[36:39]
    buffer_load_dwordx4 v19, s[56:59], s42 offen offset:3072 lds
    v_mfma_f32_16x16x32_bf16 a[40:43], a[168:171], v[200:203], a[40:43]
    s_add_u32 m0, s46, 4096
    v_mfma_f32_16x16x32_bf16 a[44:47], a[168:171], v[204:207], a[44:47]
    buffer_load_dwordx4 v20, s[56:59], s42 offen offset:0 lds
    v_mfma_f32_16x16x32_bf16 a[48:51], a[172:175], v[192:195], a[48:51]
    s_waitcnt vmcnt(13)
    v_cmp_gt_i32 vcc, 1, v31
    v_mfma_f32_16x16x32_bf16 a[52:55], a[172:175], v[196:199], a[52:55]
    v_mfma_f32_16x16x32_bf16 a[56:59], a[172:175], v[200:203], a[56:59]
    s_and_b32 s82, vcc_lo, 65280
    s_cbranch_scc1 cp3_r
cp3_ok:
    v_mfma_f32_16x16x32_bf16 a[60:63], a[172:175], v[204:207], a[60:63]
    buffer_load_dwordx4 v21, s[56:59], s42 offen offset:1024 lds
    v_mfma_f32_16x16x32_bf16 a[64:67], a[176:179], v[192:195], a[64:67]
    v_lshlrev_b32 v14, 6, v1
    v_mfma_f32_16x16x32_bf16 a[68:71], a[176:179], v[196:199], a[68:71]
    buffer_store_dwordx4 v[156:159], v8, s[64:67], s75 offen offset:0 sc1
    v_mfma_f32_16x16x32_bf16 a[72:75], a[176:179], v[200:203], a[72:75]
    buffer_load_dwordx4 v22, s[56:59], s42 offen offset:2048 lds
    v_mfma_f32_16x16x32_bf16 a[76:79], a[176:179], v[204:207], a[76:79]
    v_mfma_f32_16x16x32_bf16 a[0:3], a[180:183], v[208:211], a[0:3]
    buffer_load_dwordx4 v23, s[56:59], s42 offen offset:3072 lds
    v_mfma_f32_16x16x32_bf16 a[4:7], a[180:183], v[212:215], a[4:7]
    s_add_u32 s43, s55, 512
    v_mfma_f32_16x16x32_bf16 a[8:11], a[180:183], v[216:219], a[8:11]
    s_and_b32 s43, s43, 0x3ff
    v_mfma_f32_16x16x32_bf16 a[12:15], a[180:183], v[220:223], a[12:15]
    s_lshl4_add_u32 s43, s43, s47
    v_mfma_f32_16x16x32_bf16 a[16:19], a[184:187], v[208:211], a[16:19]
    buffer_load_dwordx4 v[32:35], v24, s[64:67], s43 offen offset:0
    v_mfma_f32_16x16x32_bf16 a[20:23], a[184:187], v[212:215], a[20:23]
    v_mfma_f32_16x16x32_bf16 a[24:27], a[184:187], v[216:219], a[24:27]
    buffer_load_dwordx4 v[36:39], v25, s[64:67], s43 offen offset:0
    v_mfma_f32_16x16x32_bf16 a[28:31], a[184:187], v[220:223], a[28:31]
    v_mfma_f32_16x16x32_bf16 a[32:35], a[188:191], v[208:211], a[32:35]
    v_mfma_f32_16x16x32_bf16 a[36:39], a[188:191], v[212:215], a[36:39]
    buffer_load_dwordx4 v[40:43], v26, s[64:67], s43 offen offset:0
    v_mfma_f32_16x16x32_bf16 a[40:43], a[188:191], v[216:219], a[40:43]
    v_mfma_f32_16x16x32_bf16 a[44:47], a[188:191], v[220:223], a[44:47]
    v_mfma_f32_16x16x32_bf16 a[48:51], a[192:195], v[208:211], a[48:51]
    buffer_load_dwordx4 v[44:47], v27, s[64:67], s43 offen offset:0
    v_mfma_f32_16x16x32_bf16 a[52:55], a[192:195], v[212:215], a[52:55]
    v_mfma_f32_16x16x32_bf16 a[56:59], a[192:195], v[216:219], a[56:59]
    v_mfma_f32_16x16x32_bf16 a[60:63], a[192:195], v[220:223], a[60:63]
    buffer_load_dwordx4 v[48:51], v28, s[64:67], s43 offen offset:0
    v_mfma_f32_16x16x32_bf16 a[64:67], a[196:199], v[208:211], a[64:67]
    v_mfma_f32_16x16x32_bf16 a[68:71], a[196:199], v[212:215], a[68:71]
    v_mfma_f32_16x16x32_bf16 a[72:75], a[196:199], v[216:219], a[72:75]
    v_mfma_f32_16x16x32_bf16 a[76:79], a[196:199], v[220:223], a[76:79]
    s_waitcnt vmcnt(33) lgkmcnt(0)
    v_mfma_f32_16x16x32_bf16 a[80:83], a[160:163], v[224:227], a[80:83]
    s_add_u32 s43, s55, 512
    v_mfma_f32_16x16x32_bf16 a[84:87], a[160:163], v[228:231], a[84:87]
    s_and_b32 s43, s43, 0x3ff
    ds_read_b128 v[192:195], v29 offset:16384
    ds_read_b128 v[196:199], v29 offset:18432
    v_mfma_f32_16x16x32_bf16 a[88:91], a[160:163], v[232:235], a[88:91]
    s_lshl4_add_u32 s43, s43, s47
    v_mfma_f32_16x16x32_bf16 a[92:95], a[160:163], v[236:239], a[92:95]
    ds_read_b128 v[200:203], v29 offset:20480
    ds_read_b128 v[204:207], v29 offset:22528
    v_mfma_f32_16x16x32_bf16 a[96:99], a[164:167], v[224:227], a[96:99]
    buffer_load_dwordx4 v[52:55], v24, s[64:67], s43 offen offset:1024
    v_mfma_f32_16x16x32_bf16 a[100:103], a[164:167], v[228:231], a[100:103]
    ds_read_b128 v[208:211], v30 offset:16384
    ds_read_b128 v[212:215], v30 offset:18432
    v_mfma_f32_16x16x32_bf16 a[104:107], a[164:167], v[232:235], a[104:107]
    buffer_load_dwordx4 v[56:59], v25, s[64:67], s43 offen offset:1024
    v_mfma_f32_16x16x32_bf16 a[108:111], a[164:167], v[236:239], a[108:111]
    ds_read_b128 v[216:219], v30 offset:20480
    ds_read_b128 v[220:223], v30 offset:22528
    v_mfma_f32_16x16x32_bf16 a[112:115], a[168:171], v[224:227], a[112:115]
    buffer_load_dwordx4 v[60:63], v26, s[64:67], s43 offen offset:1024
    v_mfma_f32_16x16x32_bf16 a[116:119], a[168:171], v[228:231], a[116:119]
    buffer_store_dwordx4 v[156:159], v8, s[64:67], s75 offen offset:1024 sc1
    v_mfma_f32_16x16x32_bf16 a[120:123], a[168:171], v[232:235], a[120:123]
    buffer_load_dwordx4 v[64:67], v27, s[64:67], s43 offen offset:1024
    v_mfma_f32_16x16x32_bf16 a[124:127], a[168:171], v[236:239], a[124:127]
    s_add_u32 m0, s46, 8192
    v_mfma_f32_16x16x32_bf16 a[128:131], a[172:175], v[224:227], a[128:131]
    s_add_u32 s42, s55, 512
    v_mfma_f32_16x16x32_bf16 a[132:135], a[172:175], v[228:231], a[132:135]
    s_and_b32 s42, s42, 0x3ff
    v_mfma_f32_16x16x32_bf16 a[136:139], a[172:175], v[232:235], a[136:139]
    s_add_u32 s42, s42, s41
    v_mfma_f32_16x16x32_bf16 a[140:143], a[172:175], v[236:239], a[140:143]
    buffer_load_dwordx4 v16, s[56:59], s42 offen offset:0 lds
    v_mfma_f32_16x16x32_bf16 a[144:147], a[176:179], v[224:227], a[144:147]
    buffer_load_dwordx4 v[68:71], v28, s[64:67], s43 offen offset:1024
    v_mfma_f32_16x16x32_bf16 a[148:151], a[176:179], v[228:231], a[148:151]
    buffer_load_dwordx4 v17, s[56:59], s42 offen offset:1024 lds
    v_mfma_f32_16x16x32_bf16 a[152:155], a[176:179], v[232:235], a[152:155]
    v_mfma_f32_16x16x32_bf16 a[156:159], a[176:179], v[236:239], a[156:159]
    v_mfma_f32_16x16x32_bf16 a[80:83], a[180:183], v[240:243], a[80:83]
    buffer_load_dwordx4 v18, s[56:59], s42 offen offset:2048 lds
    v_mfma_f32_16x16x32_bf16 a[84:87], a[180:183], v[244:247], a[84:87]
    v_mfma_f32_16x16x32_bf16 a[88:91], a[180:183], v[248:251], a[88:91]
    v_mfma_f32_16x16x32_bf16 a[92:95], a[180:183], v[252:255], a[92:95]
    buffer_load_dwordx4 v19, s[56:59], s42 offen offset:3072 lds
    v_mfma_f32_16x16x32_bf16 a[96:99], a[184:187], v[240:243], a[96:99]
    v_mfma_f32_16x16x32_bf16 a[100:103], a[184:187], v[244:247], a[100:103]
    s_add_u32 m0, s46, 12288
    v_mfma_f32_16x16x32_bf16 a[104:107], a[184:187], v[248:251], a[104:107]
    buffer_load_dwordx4 v20, s[56:59], s42 offen offset:0 lds
    v_mfma_f32_16x16x32_bf16 a[108:111], a[184:187], v[252:255], a[108:111]
    v_mfma_f32_16x16x32_bf16 a[112:115], a[188:191], v[240:243], a[112:115]
    v_mfma_f32_16x16x32_bf16 a[116:119], a[188:191], v[244:247], a[116:119]
    buffer_load_dwordx4 v21, s[56:59], s42 offen offset:1024 lds
    v_mfma_f32_16x16x32_bf16 a[120:123], a[188:191], v[248:251], a[120:123]
    v_mfma_f32_16x16x32_bf16 a[124:127], a[188:191], v[252:255], a[124:127]
    v_mfma_f32_16x16x32_bf16 a[128:131], a[192:195], v[240:243], a[128:131]
    buffer_load_dwordx4 v22, s[56:59], s42 offen offset:2048 lds
    v_mfma_f32_16x16x32_bf16 a[132:135], a[192:195], v[244:247], a[132:135]
    v_mfma_f32_16x16x32_bf16 a[136:139], a[192:195], v[248:251], a[136:139]
    v_mfma_f32_16x16x32_bf16 a[140:143], a[192:195], v[252:255], a[140:143]
    buffer_load_dwordx4 v23, s[56:59], s42 offen offset:3072 lds
    v_mfma_f32_16x16x32_bf16 a[144:147], a[196:199], v[240:243], a[144:147]
    buffer_store_dwordx2 v[156:157], v7, s[64:67], s75 offen offset:2048 sc1
    v_mfma_f32_16x16x32_bf16 a[148:151], a[196:199], v[244:247], a[148:151]
    v_mfma_f32_16x16x32_bf16 a[152:155], a[196:199], v[248:251], a[152:155]
    v_mfma_f32_16x16x32_bf16 a[156:159], a[196:199], v[252:255], a[156:159]
    s_waitcnt vmcnt(29) lgkmcnt(0)
    v_mfma_f32_16x16x32_bf16 a[0:3], a[200:203], v[192:195], a[0:3]
    s_add_u32 m0, s46, 16384
    v_mfma_f32_16x16x32_bf16 a[4:7], a[200:203], v[196:199], a[4:7]
    s_add_u32 s42, s93, 512
    ds_read_b128 v[224:227], v29 offset:24576
    ds_read_b128 v[228:231], v29 offset:26624
    v_mfma_f32_16x16x32_bf16 a[8:11], a[200:203], v[200:203], a[8:11]
    s_and_b32 s42, s42, 0x3ff
    v_mfma_f32_16x16x32_bf16 a[12:15], a[200:203], v[204:207], a[12:15]
    s_add_u32 s42, s42, s40
    ds_read_b128 v[232:235], v29 offset:28672
    ds_read_b128 v[236:239], v29 offset:30720
    v_mfma_f32_16x16x32_bf16 a[16:19], a[204:207], v[192:195], a[16:19]
    buffer_load_dwordx4 v16, s[56:59], s42 offen offset:0 lds
    v_mfma_f32_16x16x32_bf16 a[20:23], a[204:207], v[196:199], a[20:23]
    ds_read_b128 v[240:243], v30 offset:24576
    ds_read_b128 v[244:247], v30 offset:26624
    v_mfma_f32_16x16x32_bf16 a[24:27], a[204:207], v[200:203], a[24:27]
    buffer_load_dwordx4 v17, s[56:59], s42 offen offset:1024 lds
    v_mfma_f32_16x16x32_bf16 a[28:31], a[204:207], v[204:207], a[28:31]
    ds_read_b128 v[248:251], v30 offset:28672
    ds_read_b128 v[252:255], v30 offset:30720
    v_mfma_f32_16x16x32_bf16 a[32:35], a[208:211], v[192:195], a[32:35]
    buffer_load_dwordx4 v18, s[56:59], s42 offen offset:2048 lds
    v_mfma_f32_16x16x32_bf16 a[36:39], a[208:211], v[196:199], a[36:39]
    buffer_load_dwordx4 v19, s[56:59], s42 offen offset:3072 lds
    v_mfma_f32_16x16x32_bf16 a[40:43], a[208:211], v[200:203], a[40:43]
    s_add_u32 m0, s46, 20480
    v_mfma_f32_16x16x32_bf16 a[44:47], a[208:211], v[204:207], a[44:47]
    buffer_load_dwordx4 v20, s[56:59], s42 offen offset:0 lds
    v_mfma_f32_16x16x32_bf16 a[48:51], a[212:215], v[192:195], a[48:51]
    v_mfma_f32_16x16x32_bf16 a[52:55], a[212:215], v[196:199], a[52:55]
    v_mfma_f32_16x16x32_bf16 a[56:59], a[212:215], v[200:203], a[56:59]
    buffer_load_dwordx4 v21, s[56:59], s42 offen offset:1024 lds
    v_mfma_f32_16x16x32_bf16 a[60:63], a[212:215], v[204:207], a[60:63]
    v_mfma_f32_16x16x32_bf16 a[64:67], a[216:219], v[192:195], a[64:67]
    v_mfma_f32_16x16x32_bf16 a[68:71], a[216:219], v[196:199], a[68:71]
    buffer_load_dwordx4 v22, s[56:59], s42 offen offset:2048 lds
    v_mfma_f32_16x16x32_bf16 a[72:75], a[216:219], v[200:203], a[72:75]
    v_mfma_f32_16x16x32_bf16 a[76:79], a[216:219], v[204:207], a[76:79]
    v_mfma_f32_16x16x32_bf16 a[0:3], a[220:223], v[208:211], a[0:3]
    buffer_load_dwordx4 v23, s[56:59], s42 offen offset:3072 lds
    v_mfma_f32_16x16x32_bf16 a[4:7], a[220:223], v[212:215], a[4:7]
    s_add_u32 s43, s93, 512
    v_mfma_f32_16x16x32_bf16 a[8:11], a[220:223], v[216:219], a[8:11]
    s_and_b32 s43, s43, 0x3ff
    v_mfma_f32_16x16x32_bf16 a[12:15], a[220:223], v[220:223], a[12:15]
    s_lshl4_add_u32 s43, s43, s47
    v_mfma_f32_16x16x32_bf16 a[16:19], a[224:227], v[208:211], a[16:19]
    buffer_load_dwordx4 v[72:75], v24, s[64:67], s43 offen offset:0
    v_mfma_f32_16x16x32_bf16 a[20:23], a[224:227], v[212:215], a[20:23]
    v_mfma_f32_16x16x32_bf16 a[24:27], a[224:227], v[216:219], a[24:27]
    buffer_load_dwordx4 v[76:79], v25, s[64:67], s43 offen offset:0
    v_mfma_f32_16x16x32_bf16 a[28:31], a[224:227], v[220:223], a[28:31]
    buffer_store_dwordx4 v[156:159], v8, s[64:67], s84 offen offset:0 sc1
    v_mfma_f32_16x16x32_bf16 a[32:35], a[228:231], v[208:211], a[32:35]
    v_mfma_f32_16x16x32_bf16 a[36:39], a[228:231], v[212:215], a[36:39]
    buffer_load_dwordx4 v[80:83], v26, s[64:67], s43 offen offset:0
    v_mfma_f32_16x16x32_bf16 a[40:43], a[228:231], v[216:219], a[40:43]
    v_mfma_f32_16x16x32_bf16 a[44:47], a[228:231], v[220:223], a[44:47]
    v_mfma_f32_16x16x32_bf16 a[48:51], a[232:235], v[208:211], a[48:51]
    buffer_load_dwordx4 v[84:87], v27, s[64:67], s43 offen offset:0
    v_mfma_f32_16x16x32_bf16 a[52:55], a[232:235], v[212:215], a[52:55]
    v_mfma_f32_16x16x32_bf16 a[56:59], a[232:235], v[216:219], a[56:59]
    v_mfma_f32_16x16x32_bf16 a[60:63], a[232:235], v[220:223], a[60:63]
    buffer_load_dwordx4 v[88:91], v28, s[64:67], s43 offen offset:0
    v_mfma_f32_16x16x32_bf16 a[64:67], a[236:239], v[208:211], a[64:67]
    v_mfma_f32_16x16x32_bf16 a[68:71], a[236:239], v[212:215], a[68:71]
    v_mfma_f32_16x16x32_bf16 a[72:75], a[236:239], v[216:219], a[72:75]
    v_mfma_f32_16x16x32_bf16 a[76:79], a[236:239], v[220:223], a[76:79]
    s_waitcnt vmcnt(34) lgkmcnt(0)
    v_mfma_f32_16x16x32_bf16 a[80:83], a[200:203], v[224:227], a[80:83]
    s_add_u32 s43, s93, 512
    v_mfma_f32_16x16x32_bf16 a[84:87], a[200:203], v[228:231], a[84:87]
    s_and_b32 s43, s43, 0x3ff
    ds_read_b128 v[192:195], v29 offset:0
    ds_read_b128 v[196:199], v29 offset:2048
    v_mfma_f32_16x16x32_bf16 a[88:91], a[200:203], v[232:235], a[88:91]
    s_lshl4_add_u32 s43, s43, s47
    v_mfma_f32_16x16x32_bf16 a[92:95], a[200:203], v[236:239], a[92:95]
    ds_read_b128 v[200:203], v29 offset:4096
    ds_read_b128 v[204:207], v29 offset:6144
    v_mfma_f32_16x16x32_bf16 a[96:99], a[204:207], v[224:227], a[96:99]
    buffer_load_dwordx4 v[92:95], v24, s[64:67], s43 offen offset:1024
    v_mfma_f32_16x16x32_bf16 a[100:103], a[204:207], v[228:231], a[100:103]
    ds_read_b128 v[208:211], v30 offset:0
    ds_read_b128 v[212:215], v30 offset:2048
    v_mfma_f32_16x16x32_bf16 a[104:107], a[204:207], v[232:235], a[104:107]
    buffer_load_dwordx4 v[96:99], v25, s[64:67], s43 offen offset:1024
    v_mfma_f32_16x16x32_bf16 a[108:111], a[204:207], v[236:239], a[108:111]
    ds_read_b128 v[216:219], v30 offset:4096
    ds_read_b128 v[220:223], v30 offset:6144
    v_mfma_f32_16x16x32_bf16 a[112:115], a[208:211], v[224:227], a[112:115]
    buffer_load_dwordx4 v[100:103], v26, s[64:67], s43 offen offset:1024
    v_mfma_f32_16x16x32_bf16 a[116:119], a[208:211], v[228:231], a[116:119]
    buffer_load_dwordx4 v[104:107], v27, s[64:67], s43 offen offset:1024
    v_mfma_f32_16x16x32_bf16 a[120:123], a[208:211], v[232:235], a[120:123]
    s_add_u32 m0, s46, 24576
    v_mfma_f32_16x16x32_bf16 a[124:127], a[208:211], v[236:239], a[124:127]
    s_add_u32 s42, s55, 768
    v_mfma_f32_16x16x32_bf16 a[128:131], a[212:215], v[224:227], a[128:131]
    s_and_b32 s42, s42, 0x3ff
    v_mfma_f32_16x16x32_bf16 a[132:135], a[212:215], v[228:231], a[132:135]
    s_add_u32 s42, s42, s40
    v_mfma_f32_16x16x32_bf16 a[136:139], a[212:215], v[232:235], a[136:139]
    buffer_load_dwordx4 v16, s[56:59], s42 offen offset:0 lds
    v_mfma_f32_16x16x32_bf16 a[140:143], a[212:215], v[236:239], a[140:143]
    buffer_load_dwordx4 v[108:111], v28, s[64:67], s43 offen offset:1024
    v_mfma_f32_16x16x32_bf16 a[144:147], a[216:219], v[224:227], a[144:147]
    buffer_load_dwordx4 v17, s[56:59], s42 offen offset:1024 lds
    v_mfma_f32_16x16x32_bf16 a[148:151], a[216:219], v[228:231], a[148:151]
    buffer_load_dwordx4 v18, s[56:59], s42 offen offset:2048 lds
    v_mfma_f32_16x16x32_bf16 a[152:155], a[216:219], v[232:235], a[152:155]
    buffer_load_dwordx4 v19, s[56:59], s42 offen offset:3072 lds
    v_mfma_f32_16x16x32_bf16 a[156:159], a[216:219], v[236:239], a[156:159]
    buffer_store_dwordx4 v[156:159], v8, s[64:67], s84 offen offset:1024 sc1
    v_mfma_f32_16x16x32_bf16 a[80:83], a[220:223], v[240:243], a[80:83]
    s_add_u32 m0, s46, 28672
    v_mfma_f32_16x16x32_bf16 a[84:87], a[220:223], v[244:247], a[84:87]
    buffer_load_dwordx4 v20, s[56:59], s42 offen offset:0 lds
    v_mfma_f32_16x16x32_bf16 a[88:91], a[220:223], v[248:251], a[88:91]
    buffer_load_dwordx4 v21, s[56:59], s42 offen offset:1024 lds
    v_mfma_f32_16x16x32_bf16 a[92:95], a[220:223], v[252:255], a[92:95]
    buffer_load_dwordx4 v22, s[56:59], s42 offen offset:2048 lds
    v_mfma_f32_16x16x32_bf16 a[96:99], a[224:227], v[240:243], a[96:99]
    s_add_u32 s43, s55, 768
    v_mfma_f32_16x16x32_bf16 a[100:103], a[224:227], v[244:247], a[100:103]
    s_and_b32 s43, s43, 0x3ff
    v_mfma_f32_16x16x32_bf16 a[104:107], a[224:227], v[248:251], a[104:107]
    s_lshl4_add_u32 s43, s43, s47
    v_mfma_f32_16x16x32_bf16 a[108:111], a[224:227], v[252:255], a[108:111]
    buffer_load_dwordx4 a[160:163], v24, s[64:67], s43 offen offset:0
    v_mfma_f32_16x16x32_bf16 a[112:115], a[228:231], v[240:243], a[112:115]
    buffer_load_dwordx4 v23, s[56:59], s42 offen offset:3072 lds
    v_mfma_f32_16x16x32_bf16 a[116:119], a[228:231], v[244:247], a[116:119]
    buffer_load_dwordx4 a[164:167], v25, s[64:67], s43 offen offset:0
    v_mfma_f32_16x16x32_bf16 a[120:123], a[228:231], v[248:251], a[120:123]
    v_mfma_f32_16x16x32_bf16 a[124:127], a[228:231], v[252:255], a[124:127]
    buffer_load_dwordx4 a[168:171], v26, s[64:67], s43 offen offset:0
    v_mfma_f32_16x16x32_bf16 a[128:131], a[232:235], v[240:243], a[128:131]
    v_mfma_f32_16x16x32_bf16 a[132:135], a[232:235], v[244:247], a[132:135]
    buffer_load_dwordx4 a[172:175], v27, s[64:67], s43 offen offset:0
    v_mfma_f32_16x16x32_bf16 a[136:139], a[232:235], v[248:251], a[136:139]
    v_mfma_f32_16x16x32_bf16 a[140:143], a[232:235], v[252:255], a[140:143]
    buffer_load_dwordx4 a[176:179], v28, s[64:67], s43 offen offset:0
    v_mfma_f32_16x16x32_bf16 a[144:147], a[236:239], v[240:243], a[144:147]
    v_mfma_f32_16x16x32_bf16 a[148:151], a[236:239], v[244:247], a[148:151]
    v_mfma_f32_16x16x32_bf16 a[152:155], a[236:239], v[248:251], a[152:155]
    v_mfma_f32_16x16x32_bf16 a[156:159], a[236:239], v[252:255], a[156:159]
    s_waitcnt vmcnt(34) lgkmcnt(0)
    v_mfma_f32_16x16x32_bf16 a[0:3], v[32:35], v[192:195], a[0:3]
    s_add_u32 s43, s55, 768
    v_mfma_f32_16x16x32_bf16 a[4:7], v[32:35], v[196:199], a[4:7]
    s_and_b32 s43, s43, 0x3ff
    ds_read_b128 v[224:227], v29 offset:8192
    ds_read_b128 v[228:231], v29 offset:10240
    v_mfma_f32_16x16x32_bf16 a[8:11], v[32:35], v[200:203], a[8:11]
    s_lshl4_add_u32 s43, s43, s47
    v_mfma_f32_16x16x32_bf16 a[12:15], v[32:35], v[204:207], a[12:15]
    ds_read_b128 v[232:235], v29 offset:12288
    ds_read_b128 v[236:239], v29 offset:14336
    v_mfma_f32_16x16x32_bf16 a[16:19], v[36:39], v[192:195], a[16:19]
    buffer_load_dwordx4 a[180:183], v24, s[64:67], s43 offen offset:1024
    v_mfma_f32_16x16x32_bf16 a[20:23], v[36:39], v[196:199], a[20:23]
    ds_read_b128 v[240:243], v30 offset:8192
    ds_read_b128 v[244:247], v30 offset:10240
    v_mfma_f32_16x16x32_bf16 a[24:27], v[36:39], v[200:203], a[24:27]
    buffer_load_dwordx4 a[184:187], v25, s[64:67], s43 offen offset:1024
    v_mfma_f32_16x16x32_bf16 a[28:31], v[36:39], v[204:207], a[28:31]
    ds_read_b128 v[248:251], v30 offset:12288
    ds_read_b128 v[252:255], v30 offset:14336
    v_mfma_f32_16x16x32_bf16 a[32:35], v[40:43], v[192:195], a[32:35]
    buffer_load_dwordx4 a[188:191], v26, s[64:67], s43 offen offset:1024
    v_mfma_f32_16x16x32_bf16 a[36:39], v[40:43], v[196:199], a[36:39]
    buffer_load_dwordx4 a[192:195], v27, s[64:67], s43 offen offset:1024
    v_mfma_f32_16x16x32_bf16 a[40:43], v[40:43], v[200:203], a[40:43]
    s_add_u32 m0, s46, 0
    v_mfma_f32_16x16x32_bf16 a[44:47], v[40:43], v[204:207], a[44:47]
    s_add_u32 s42, s93, 768
    v_mfma_f32_16x16x32_bf16 a[48:51], v[44:47], v[192:195], a[48:51]
    s_and_b32 s42, s42, 0x3ff
    v_mfma_f32_16x16x32_bf16 a[52:55], v[44:47], v[196:199], a[52:55]
    s_add_u32 s42, s42, s40
    v_mfma_f32_16x16x32_bf16 a[56:59], v[44:47], v[200:203], a[56:59]
    buffer_load_dwordx4 v16, s[56:59], s42 offen offset:0 lds
    v_mfma_f32_16x16x32_bf16 a[60:63], v[44:47], v[204:207], a[60:63]
    buffer_store_dwordx2 v[156:157], v7, s[64:67], s84 offen offset:2048 sc1
    v_mfma_f32_16x16x32_bf16 a[64:67], v[48:51], v[192:195], a[64:67]
    buffer_load_dwordx4 a[196:199], v28, s[64:67], s43 offen offset:1024
    v_mfma_f32_16x16x32_bf16 a[68:71], v[48:51], v[196:199], a[68:71]
    buffer_load_dword v31, v14, s[64:67], s60 offen sc1
    v_mfma_f32_16x16x32_bf16 a[72:75], v[48:51], v[200:203], a[72:75]
    buffer_load_dwordx4 v17, s[56:59], s42 offen offset:1024 lds
    v_mfma_f32_16x16x32_bf16 a[76:79], v[48:51], v[204:207], a[76:79]
    buffer_load_dwordx4 v18, s[56:59], s42 offen offset:2048 lds
    v_mfma_f32_16x16x32_bf16 a[0:3], v[52:55], v[208:211], a[0:3]
    buffer_load_dwordx4 v19, s[56:59], s42 offen offset:3072 lds
    v_mfma_f32_16x16x32_bf16 a[4:7], v[52:55], v[212:215], a[4:7]
    s_add_u32 m0, s46, 4096
    v_mfma_f32_16x16x32_bf16 a[8:11], v[52:55], v[216:219], a[8:11]
    buffer_load_dwordx4 v20, s[56:59], s42 offen offset:0 lds
    v_mfma_f32_16x16x32_bf16 a[12:15], v[52:55], v[220:223], a[12:15]
    buffer_load_dwordx4 v21, s[56:59], s42 offen offset:1024 lds
    v_mfma_f32_16x16x32_bf16 a[16:19], v[56:59], v[208:211], a[16:19]
    buffer_load_dwordx4 v22, s[56:59], s42 offen offset:2048 lds
    v_mfma_f32_16x16x32_bf16 a[20:23], v[56:59], v[212:215], a[20:23]
    s_add_u32 s43, s93, 768
    v_mfma_f32_16x16x32_bf16 a[24:27], v[56:59], v[216:219], a[24:27]
    s_and_b32 s43, s43, 0x3ff
    v_mfma_f32_16x16x32_bf16 a[28:31], v[56:59], v[220:223], a[28:31]
    s_lshl4_add_u32 s43, s43, s47
    v_mfma_f32_16x16x32_bf16 a[32:35], v[60:63], v[208:211], a[32:35]
    buffer_load_dwordx4 a[200:203], v24, s[64:67], s43 offen offset:0
    v_mfma_f32_16x16x32_bf16 a[36:39], v[60:63], v[212:215], a[36:39]
    buffer_load_dwordx4 v23, s[56:59], s42 offen offset:3072 lds
    v_mfma_f32_16x16x32_bf16 a[40:43], v[60:63], v[216:219], a[40:43]
    buffer_load_dwordx4 a[204:207], v25, s[64:67], s43 offen offset:0
    v_mfma_f32_16x16x32_bf16 a[44:47], v[60:63], v[220:223], a[44:47]
    buffer_load_dwordx4 a[208:211], v26, s[64:67], s43 offen offset:0
    v_mfma_f32_16x16x32_bf16 a[48:51], v[64:67], v[208:211], a[48:51]
    v_mfma_f32_16x16x32_bf16 a[52:55], v[64:67], v[212:215], a[52:55]
    buffer_load_dwordx4 a[212:215], v27, s[64:67], s43 offen offset:0
    v_mfma_f32_16x16x32_bf16 a[56:59], v[64:67], v[216:219], a[56:59]
    v_mfma_f32_16x16x32_bf16 a[60:63], v[64:67], v[220:223], a[60:63]
    buffer_load_dwordx4 a[216:219], v28, s[64:67], s43 offen offset:0
    v_mfma_f32_16x16x32_bf16 a[64:67], v[68:71], v[208:211], a[64:67]
    buffer_store_dwordx4 v[156:159], v8, s[64:67], s85 offen offset:0 sc1
    v_mfma_f32_16x16x32_bf16 a[68:71], v[68:71], v[212:215], a[68:71]
    v_mfma_f32_16x16x32_bf16 a[72:75], v[68:71], v[216:219], a[72:75]
    v_mfma_f32_16x16x32_bf16 a[76:79], v[68:71], v[220:223], a[76:79]
    s_waitcnt vmcnt(46) lgkmcnt(0)
    v_mfma_f32_16x16x32_bf16 a[80:83], v[32:35], v[224:227], a[80:83]
    s_add_u32 s43, s93, 768
    v_mfma_f32_16x16x32_bf16 a[84:87], v[32:35], v[228:231], a[84:87]
    s_and_b32 s43, s43, 0x3ff
    ds_read_b128 v[192:195], v29 offset:16384
    ds_read_b128 v[196:199], v29 offset:18432
    v_mfma_f32_16x16x32_bf16 a[88:91], v[32:35], v[232:235], a[88:91]
    s_lshl4_add_u32 s43, s43, s47
    v_mfma_f32_16x16x32_bf16 a[92:95], v[32:35], v[236:239], a[92:95]
    ds_read_b128 v[200:203], v29 offset:20480
    ds_read_b128 v[204:207], v29 offset:22528
    v_mfma_f32_16x16x32_bf16 a[96:99], v[36:39], v[224:227], a[96:99]
    buffer_load_dwordx4 a[220:223], v24, s[64:67], s43 offen offset:1024
    v_mfma_f32_16x16x32_bf16 a[100:103], v[36:39], v[228:231], a[100:103]
    ds_read_b128 v[208:211], v30 offset:16384
    ds_read_b128 v[212:215], v30 offset:18432
    v_mfma_f32_16x16x32_bf16 a[104:107], v[36:39], v[232:235], a[104:107]
    buffer_load_dwordx4 a[224:227], v25, s[64:67], s43 offen offset:1024
    v_mfma_f32_16x16x32_bf16 a[108:111], v[36:39], v[236:239], a[108:111]
    ds_read_b128 v[216:219], v30 offset:20480
    ds_read_b128 v[220:223], v30 offset:22528
    v_mfma_f32_16x16x32_bf16 a[112:115], v[40:43], v[224:227], a[112:115]
    buffer_load_dwordx4 a[228:231], v26, s[64:67], s43 offen offset:1024
    v_mfma_f32_16x16x32_bf16 a[116:119], v[40:43], v[228:231], a[116:119]
    buffer_load_dwordx4 a[232:235], v27, s[64:67], s43 offen offset:1024
    v_mfma_f32_16x16x32_bf16 a[120:123], v[40:43], v[232:235], a[120:123]
    s_add_u32 m0, s46, 8192
    v_mfma_f32_16x16x32_bf16 a[124:127], v[40:43], v[236:239], a[124:127]
    s_add_u32 s42, s93, 512
    v_mfma_f32_16x16x32_bf16 a[128:131], v[44:47], v[224:227], a[128:131]
    s_waitcnt vmcnt(17)
    v_cmp_gt_i32 vcc, 2, v31
    v_mfma_f32_16x16x32_bf16 a[132:135], v[44:47], v[228:231], a[132:135]
    s_and_b32 s42, s42, 0x3ff
    v_mfma_f32_16x16x32_bf16 a[136:139], v[44:47], v[232:235], a[136:139]
    s_cmp_lg_u64 vcc, 0
    s_cbranch_scc1 cp4_r
cp4_ok:
    v_mfma_f32_16x16x32_bf16 a[140:143], v[44:47], v[236:239], a[140:143]
    s_add_u32 s42, s42, s41
    v_mfma_f32_16x16x32_bf16 a[144:147], v[48:51], v[224:227], a[144:147]
    buffer_load_dwordx4 v16, s[56:59], s42 offen offset:0 lds
    v_mfma_f32_16x16x32_bf16 a[148:151], v[48:51], v[228:231], a[148:151]
    buffer_load_dwordx4 a[236:239], v28, s[64:67], s43 offen offset:1024
    v_mfma_f32_16x16x32_bf16 a[152:155], v[48:51], v[232:235], a[152:155]
    buffer_load_dwordx4 v17, s[56:59], s42 offen offset:1024 lds
    v_mfma_f32_16x16x32_bf16 a[156:159], v[48:51], v[236:239], a[156:159]
    v_mfma_f32_16x16x32_bf16 a[80:83], v[52:55], v[240:243], a[80:83]
    buffer_load_dwordx4 v18, s[56:59], s42 offen offset:2048 lds
    v_mfma_f32_16x16x32_bf16 a[84:87], v[52:55], v[244:247], a[84:87]
    v_mfma_f32_16x16x32_bf16 a[88:91], v[52:55], v[248:251], a[88:91]
    v_mfma_f32_16x16x32_bf16 a[92:95], v[52:55], v[252:255], a[92:95]
    buffer_load_dwordx4 v19, s[56:59], s42 offen offset:3072 lds
    v_mfma_f32_16x16x32_bf16 a[96:99], v[56:59], v[240:243], a[96:99]
    v_mfma_f32_16x16x32_bf16 a[100:103], v[56:59], v[244:247], a[100:103]
    s_add_u32 m0, s46, 12288
    v_mfma_f32_16x16x32_bf16 a[104:107], v[56:59], v[248:251], a[104:107]
    buffer_load_dwordx4 v20, s[56:59], s42 offen offset:0 lds
    v_mfma_f32_16x16x32_bf16 a[108:111], v[56:59], v[252:255], a[108:111]
    buffer_store_dwordx4 v[156:159], v8, s[64:67], s85 offen offset:1024 sc1
    v_mfma_f32_16x16x32_bf16 a[112:115], v[60:63], v[240:243], a[112:115]
    v_mfma_f32_16x16x32_bf16 a[116:119], v[60:63], v[244:247], a[116:119]
    buffer_load_dwordx4 v21, s[56:59], s42 offen offset:1024 lds
    v_mfma_f32_16x16x32_bf16 a[120:123], v[60:63], v[248:251], a[120:123]
    v_mfma_f32_16x16x32_bf16 a[124:127], v[60:63], v[252:255], a[124:127]
    v_mfma_f32_16x16x32_bf16 a[128:131], v[64:67], v[240:243], a[128:131]
    buffer_load_dwordx4 v22, s[56:59], s42 offen offset:2048 lds
    v_mfma_f32_16x16x32_bf16 a[132:135], v[64:67], v[244:247], a[132:135]
    v_mfma_f32_16x16x32_bf16 a[136:139], v[64:67], v[248:251], a[136:139]
    v_mfma_f32_16x16x32_bf16 a[140:143], v[64:67], v[252:255], a[140:143]
    buffer_load_dwordx4 v23, s[56:59], s42 offen offset:3072 lds
    v_mfma_f32_16x16x32_bf16 a[144:147], v[68:71], v[240:243], a[144:147]
    v_mfma_f32_16x16x32_bf16 a[148:151], v[68:71], v[244:247], a[148:151]
    v_mfma_f32_16x16x32_bf16 a[152:155], v[68:71], v[248:251], a[152:155]
    v_mfma_f32_16x16x32_bf16 a[156:159], v[68:71], v[252:255], a[156:159]
    s_waitcnt vmcnt(19) lgkmcnt(0)
    v_mfma_f32_16x16x32_bf16 a[0:3], v[72:75], v[192:195], a[0:3]
    s_add_u32 m0, s46, 16384
    v_mfma_f32_16x16x32_bf16 a[4:7], v[72:75], v[196:199], a[4:7]
    s_add_u32 s42, s55, 768
    ds_read_b128 v[224:227], v29 offset:24576
    ds_read_b128 v[240:243], v30 offset:24576
    v_mfma_f32_16x16x32_bf16 a[8:11], v[72:75], v[200:203], a[8:11]
    s_and_b32 s42, s42, 0x3ff
    v_mfma_f32_16x16x32_bf16 a[12:15], v[72:75], v[204:207], a[12:15]
    s_add_u32 s42, s42, s41
    ds_read_b128 v[232:235], v29 offset:0
    ds_read_b128 v[248:251], v30 offset:0
    v_mfma_f32_16x16x32_bf16 a[16:19], v[76:79], v[192:195], a[16:19]
    buffer_load_dwordx4 v16, s[56:59], s42 offen offset:0 lds
    v_mfma_f32_16x16x32_bf16 a[20:23], v[76:79], v[196:199], a[20:23]
    s_add_u32 s83, s77, 0
    ds_read_b128 v[228:231], v29 offset:26624
    ds_read_b128 v[244:247], v30 offset:26624
    v_mfma_f32_16x16x32_bf16 a[24:27], v[76:79], v[200:203], a[24:27]
    buffer_load_dwordx4 v[112:115], v8, s[64:67], s83 offen offset:0
    v_mfma_f32_16x16x32_bf16 a[28:31], v[76:79], v[204:207], a[28:31]
    ds_read_b128 v[236:239], v29 offset:2048
    ds_read_b128 v[252:255], v30 offset:2048
    v_mfma_f32_16x16x32_bf16 a[32:35], v[80:83], v[192:195], a[32:35]
    buffer_load_dwordx4 v17, s[56:59], s42 offen offset:1024 lds
    v_mfma_f32_16x16x32_bf16 a[36:39], v[80:83], v[196:199], a[36:39]
    s_add_u32 s83, s77, 81920
    v_mfma_f32_16x16x32_bf16 a[40:43], v[80:83], v[200:203], a[40:43]
    buffer_load_dwordx4 v[116:119], v8, s[64:67], s83 offen offset:0
    v_mfma_f32_16x16x32_bf16 a[44:47], v[80:83], v[204:207], a[44:47]
    buffer_load_dwordx4 v18, s[56:59], s42 offen offset:2048 lds
    v_mfma_f32_16x16x32_bf16 a[48:51], v[84:87], v[192:195], a[48:51]
    s_add_u32 s83, s77, 163840
    v_mfma_f32_16x16x32_bf16 a[52:55], v[84:87], v[196:199], a[52:55]
    buffer_load_dwordx4 v[120:123], v8, s[64:67], s83 offen offset:0
    v_mfma_f32_16x16x32_bf16 a[56:59], v[84:87], v[200:203], a[56:59]
    buffer_load_dwordx4 v19, s[56:59], s42 offen offset:3072 lds
    v_mfma_f32_16x16x32_bf16 a[60:63], v[84:87], v[204:207], a[60:63]
    s_add_u32 s83, s77, 0
    v_mfma_f32_16x16x32_bf16 a[64:67], v[88:91], v[192:195], a[64:67]
    buffer_load_dwordx4 v[124:127], v8, s[64:67], s83 offen offset:1024
    v_mfma_f32_16x16x32_bf16 a[68:71], v[88:91], v[196:199], a[68:71]
    v_mfma_f32_16x16x32_bf16 a[72:75], v[88:91], v[200:203], a[72:75]
    s_add_u32 m0, s46, 20480
    v_mfma_f32_16x16x32_bf16 a[76:79], v[88:91], v[204:207], a[76:79]
    buffer_load_dwordx4 v20, s[56:59], s42 offen offset:0 lds
    v_mfma_f32_16x16x32_bf16 a[0:3], v[92:95], v[208:211], a[0:3]
    s_add_u32 s83, s77, 81920
    v_mfma_f32_16x16x32_bf16 a[4:7], v[92:95], v[212:215], a[4:7]
    buffer_load_dwordx4 v[128:131], v8, s[64:67], s83 offen offset:1024
    v_mfma_f32_16x16x32_bf16 a[8:11], v[92:95], v[216:219], a[8:11]
    v_mfma_f32_16x16x32_bf16 a[12:15], v[92:95], v[220:223], a[12:15]
    buffer_load_dwordx4 v21, s[56:59], s42 offen offset:1024 lds
    v_mfma_f32_16x16x32_bf16 a[16:19], v[96:99], v[208:211], a[16:19]
    v_mfma_f32_16x16x32_bf16 a[20:23], v[96:99], v[212:215], a[20:23]
    s_add_u32 s83, s77, 163840
    v_mfma_f32_16x16x32_bf16 a[24:27], v[96:99], v[216:219], a[24:27]
    buffer_load_dwordx4 v[132:135], v8, s[64:67], s83 offen offset:1024
    v_mfma_f32_16x16x32_bf16 a[28:31], v[96:99], v[220:223], a[28:31]
    v_mfma_f32_16x16x32_bf16 a[32:35], v[100:103], v[208:211], a[32:35]
    buffer_load_dwordx4 v22, s[56:59], s42 offen offset:2048 lds
    v_mfma_f32_16x16x32_bf16 a[36:39], v[100:103], v[212:215], a[36:39]
    v_mfma_f32_16x16x32_bf16 a[40:43], v[100:103], v[216:219], a[40:43]
    s_add_u32 s83, s77, 0
    v_mfma_f32_16x16x32_bf16 a[44:47], v[100:103], v[220:223], a[44:47]
    buffer_load_dwordx4 v[136:139], v8, s[64:67], s83 offen offset:2048
    v_mfma_f32_16x16x32_bf16 a[48:51], v[104:107], v[208:211], a[48:51]
    v_mfma_f32_16x16x32_bf16 a[52:55], v[104:107], v[212:215], a[52:55]
    buffer_load_dwordx4 v23, s[56:59], s42 offen offset:3072 lds
    v_mfma_f32_16x16x32_bf16 a[56:59], v[104:107], v[216:219], a[56:59]
    v_mfma_f32_16x16x32_bf16 a[60:63], v[104:107], v[220:223], a[60:63]
    s_add_u32 s83, s77, 81920
    v_mfma_f32_16x16x32_bf16 a[64:67], v[108:111], v[208:211], a[64:67]
    buffer_load_dwordx4 v[140:143], v8, s[64:67], s83 offen offset:2048
    v_mfma_f32_16x16x32_bf16 a[68:71], v[108:111], v[212:215], a[68:71]
    v_mfma_f32_16x16x32_bf16 a[72:75], v[108:111], v[216:219], a[72:75]
    v_mfma_f32_16x16x32_bf16 a[76:79], v[108:111], v[220:223], a[76:79]
    s_waitcnt vmcnt(44) lgkmcnt(0)
    v_mfma_f32_16x16x32_bf16 a[0:3], a[160:163], v[224:227], a[0:3]
    s_add_u32 s83, s77, 163840
    ds_read_b128 v[192:195], v29 offset:28672
    ds_read_b128 v[208:211], v30 offset:28672
    v_mfma_f32_16x16x32_bf16 a[16:19], a[164:167], v[224:227], a[16:19]
    ds_read_b128 v[200:203], v29 offset:4096
    ds_read_b128 v[216:219], v30 offset:4096
    v_mfma_f32_16x16x32_bf16 a[32:35], a[168:171], v[224:227], a[32:35]
    ds_read_b128 v[196:199], v29 offset:30720
    ds_read_b128 v[212:215], v30 offset:30720
    v_mfma_f32_16x16x32_bf16 a[48:51], a[172:175], v[224:227], a[48:51]
    ds_read_b128 v[204:207], v29 offset:6144
    ds_read_b128 v[220:223], v30 offset:6144
    v_mfma_f32_16x16x32_bf16 a[64:67], a[176:179], v[224:227], a[64:67]
    buffer_load_dwordx4 v[176:179], v8, s[64:67], s83 offen offset:2048
    v_mfma_f32_16x16x32_bf16 a[0:3], a[180:183], v[240:243], a[0:3]
    s_add_u32 s83, s77, 0
    v_mfma_f32_16x16x32_bf16 a[16:19], a[184:187], v[240:243], a[16:19]
    buffer_load_dwordx4 v[180:183], v8, s[64:67], s83 offen offset:3072
    v_mfma_f32_16x16x32_bf16 a[32:35], a[188:191], v[240:243], a[32:35]
    v_mfma_f32_16x16x32_bf16 a[48:51], a[192:195], v[240:243], a[48:51]
    v_mfma_f32_16x16x32_bf16 a[64:67], a[196:199], v[240:243], a[64:67]
    s_waitcnt vmcnt(26) lgkmcnt(0)
    v_mfma_f32_16x16x32_bf16 a[0:3], a[200:203], v[232:235], a[0:3]
    s_add_u32 m0, s46, 24576
    v_mfma_f32_16x16x32_bf16 a[16:19], a[204:207], v[232:235], a[16:19]
    s_add_u32 s42, s93, 768
    v_mfma_f32_16x16x32_bf16 a[32:35], a[208:211], v[232:235], a[32:35]
    s_and_b32 s42, s42, 0x3ff
    v_mfma_f32_16x16x32_bf16 a[48:51], a[212:215], v[232:235], a[48:51]
    s_add_u32 s42, s42, s41
    v_mfma_f32_16x16x32_bf16 a[64:67], a[216:219], v[232:235], a[64:67]
    buffer_load_dwordx4 v16, s[56:59], s42 offen offset:0 lds
    v_mfma_f32_16x16x32_bf16 a[0:3], a[220:223], v[248:251], a[0:3]
    s_add_u32 s83, s77, 81920
    v_mfma_f32_16x16x32_bf16 a[16:19], a[224:227], v[248:251], a[16:19]
    buffer_load_dwordx4 v[184:187], v8, s[64:67], s83 offen offset:3072
    v_mfma_f32_16x16x32_bf16 a[32:35], a[228:231], v[248:251], a[32:35]
    buffer_load_dwordx4 v17, s[56:59], s42 offen offset:1024 lds
    v_mfma_f32_16x16x32_bf16 a[48:51], a[232:235], v[248:251], a[48:51]
    v_mfma_f32_16x16x32_bf16 a[64:67], a[236:239], v[248:251], a[64:67]
    buffer_load_dwordx4 v18, s[56:59], s42 offen offset:2048 lds
    v_mfma_f32_16x16x32_bf16 a[4:7], a[160:163], v[228:231], a[4:7]
    ds_write_b128 v9, a[0:3] offset:32768
    v_mfma_f32_16x16x32_bf16 a[20:23], a[164:167], v[228:231], a[20:23]
    v_mfma_f32_16x16x32_bf16 a[36:39], a[168:171], v[228:231], a[36:39]
    v_mfma_f32_16x16x32_bf16 a[52:55], a[172:175], v[228:231], a[52:55]
    v_mfma_f32_16x16x32_bf16 a[68:71], a[176:179], v[228:231], a[68:71]
    ds_write_b128 v9, a[16:19] offset:33792
    v_mfma_f32_16x16x32_bf16 a[4:7], a[180:183], v[244:247], a[4:7]
    buffer_load_dwordx4 v19, s[56:59], s42 offen offset:3072 lds
    v_mfma_f32_16x16x32_bf16 a[20:23], a[184:187], v[244:247], a[20:23]
    v_mfma_f32_16x16x32_bf16 a[36:39], a[188:191], v[244:247], a[36:39]
    v_mfma_f32_16x16x32_bf16 a[52:55], a[192:195], v[244:247], a[52:55]
    ds_write_b128 v9, a[32:35] offset:34816
    v_mfma_f32_16x16x32_bf16 a[68:71], a[196:199], v[244:247], a[68:71]
    s_add_u32 m0, s46, 28672
    v_mfma_f32_16x16x32_bf16 a[4:7], a[200:203], v[236:239], a[4:7]
    buffer_load_dwordx4 v20, s[56:59], s42 offen offset:0 lds
    v_mfma_f32_16x16x32_bf16 a[20:23], a[204:207], v[236:239], a[20:23]
    v_mfma_f32_16x16x32_bf16 a[36:39], a[208:211], v[236:239], a[36:39]
    ds_write_b128 v9, a[48:51] offset:35840
    v_mfma_f32_16x16x32_bf16 a[52:55], a[212:215], v[236:239], a[52:55]
    buffer_load_dwordx4 v21, s[56:59], s42 offen offset:1024 lds
    v_mfma_f32_16x16x32_bf16 a[68:71], a[216:219], v[236:239], a[68:71]
    v_mfma_f32_16x16x32_bf16 a[4:7], a[220:223], v[252:255], a[4:7]
    v_mfma_f32_16x16x32_bf16 a[20:23], a[224:227], v[252:255], a[20:23]
    ds_write_b128 v9, a[64:67] offset:36864
    v_mfma_f32_16x16x32_bf16 a[36:39], a[228:231], v[252:255], a[36:39]
    v_mfma_f32_16x16x32_bf16 a[52:55], a[232:235], v[252:255], a[52:55]
    buffer_load_dwordx4 v22, s[56:59], s42 offen offset:2048 lds
    v_mfma_f32_16x16x32_bf16 a[68:71], a[236:239], v[252:255], a[68:71]
    v_mfma_f32_16x16x32_bf16 a[8:11], a[160:163], v[192:195], a[8:11]
    ds_write_b128 v9, a[4:7] offset:37888
    v_mfma_f32_16x16x32_bf16 a[24:27], a[164:167], v[192:195], a[24:27]
    s_waitcnt vmcnt(26) lgkmcnt(1)
    ds_read_b128 v[224:227], v29 offset:8192
    ds_read_b128 v[228:231], v29 offset:10240
    v_mfma_f32_16x16x32_bf16 a[40:43], a[168:171], v[192:195], a[40:43]
    s_add_u32 s83, s77, 163840
    v_mfma_f32_16x16x32_bf16 a[56:59], a[172:175], v[192:195], a[56:59]
    ds_read_b128 v[232:235], v29 offset:12288
    ds_read_b128 v[236:239], v29 offset:14336
    v_mfma_f32_16x16x32_bf16 a[72:75], a[176:179], v[192:195], a[72:75]
    ds_write_b128 v9, a[20:23] offset:38912
    v_mfma_f32_16x16x32_bf16 a[8:11], a[180:183], v[208:211], a[8:11]
    ds_read_b128 v[240:243], v30 offset:8192
    ds_read_b128 v[244:247], v30 offset:10240
    v_mfma_f32_16x16x32_bf16 a[24:27], a[184:187], v[208:211], a[24:27]
    buffer_load_dwordx4 v[188:191], v8, s[64:67], s83 offen offset:3072
    v_mfma_f32_16x16x32_bf16 a[40:43], a[188:191], v[208:211], a[40:43]
    ds_read_b128 v[248:251], v30 offset:12288
    ds_read_b128 v[252:255], v30 offset:14336
    v_mfma_f32_16x16x32_bf16 a[56:59], a[192:195], v[208:211], a[56:59]
    ds_write_b128 v9, a[36:39] offset:39936
    v_mfma_f32_16x16x32_bf16 a[72:75], a[196:199], v[208:211], a[72:75]
    buffer_load_dwordx4 v23, s[56:59], s42 offen offset:3072 lds
    v_mfma_f32_16x16x32_bf16 a[8:11], a[200:203], v[200:203], a[8:11]
    s_add_u32 s83, s77, 4096
    v_mfma_f32_16x16x32_bf16 a[24:27], a[204:207], v[200:203], a[24:27]
    buffer_load_dwordx4 a[252:255], v8, s[64:67], s83 offen offset:0
    v_mfma_f32_16x16x32_bf16 a[40:43], a[208:211], v[200:203], a[40:43]
    ds_write_b128 v9, a[52:55] offset:0
    v_mfma_f32_16x16x32_bf16 a[56:59], a[212:215], v[200:203], a[56:59]
    s_add_u32 s83, s77, 86016
    v_mfma_f32_16x16x32_bf16 a[72:75], a[216:219], v[200:203], a[72:75]
    buffer_load_dwordx4 a[0:3], v8, s[64:67], s83 offen offset:0
    v_mfma_f32_16x16x32_bf16 a[8:11], a[220:223], v[216:219], a[8:11]
    buffer_store_dwordx4 v[156:159], v8, s[64:67], s85 offen offset:2048 sc1
    v_mfma_f32_16x16x32_bf16 a[24:27], a[224:227], v[216:219], a[24:27]
    ds_write_b128 v9, a[68:71] offset:1024
    v_mfma_f32_16x16x32_bf16 a[40:43], a[228:231], v[216:219], a[40:43]
    s_add_u32 s83, s77, 167936
    v_mfma_f32_16x16x32_bf16 a[56:59], a[232:235], v[216:219], a[56:59]
    buffer_load_dwordx4 a[16:19], v8, s[64:67], s83 offen offset:0
    v_mfma_f32_16x16x32_bf16 a[72:75], a[236:239], v[216:219], a[72:75]
    v_mfma_f32_16x16x32_bf16 a[12:15], a[160:163], v[196:199], a[12:15]
    ds_write_b128 v9, a[8:11] offset:2048
    v_mfma_f32_16x16x32_bf16 a[28:31], a[164:167], v[196:199], a[28:31]
    s_waitcnt lgkmcnt(1)
    v_mfma_f32_16x16x32_bf16 a[44:47], a[168:171], v[196:199], a[44:47]
    s_add_u32 s83, s77, 4096
    v_mfma_f32_16x16x32_bf16 a[60:63], a[172:175], v[196:199], a[60:63]
    ds_write_b128 v9, a[24:27] offset:3072
    v_mfma_f32_16x16x32_bf16 a[76:79], a[176:179], v[196:199], a[76:79]
    buffer_load_dwordx4 a[32:35], v8, s[64:67], s83 offen offset:1024
    v_mfma_f32_16x16x32_bf16 a[12:15], a[180:183], v[212:215], a[12:15]
    buffer_store_dwordx4 v[156:159], v8, s[64:67], s86 offen offset:0 sc1
    v_mfma_f32_16x16x32_bf16 a[28:31], a[184:187], v[212:215], a[28:31]
    ds_write_b128 v9, a[40:43] offset:4096
    v_mfma_f32_16x16x32_bf16 a[44:47], a[188:191], v[212:215], a[44:47]
    s_add_u32 s83, s77, 86016
    v_mfma_f32_16x16x32_bf16 a[60:63], a[192:195], v[212:215], a[60:63]
    buffer_load_dwordx4 a[48:51], v8, s[64:67], s83 offen offset:1024
    v_mfma_f32_16x16x32_bf16 a[76:79], a[196:199], v[212:215], a[76:79]
    ds_write_b128 v9, a[56:59] offset:5120
    v_mfma_f32_16x16x32_bf16 a[12:15], a[200:203], v[204:207], a[12:15]
    buffer_store_dwordx4 v[156:159], v8, s[64:67], s86 offen offset:1024 sc1
    v_mfma_f32_16x16x32_bf16 a[28:31], a[204:207], v[204:207], a[28:31]
    s_add_u32 s83, s77, 167936
    v_mfma_f32_16x16x32_bf16 a[44:47], a[208:211], v[204:207], a[44:47]
    ds_write_b128 v9, a[72:75] offset:6144
    v_mfma_f32_16x16x32_bf16 a[60:63], a[212:215], v[204:207], a[60:63]
    buffer_load_dwordx4 a[64:67], v8, s[64:67], s83 offen offset:1024
    v_mfma_f32_16x16x32_bf16 a[76:79], a[216:219], v[204:207], a[76:79]
    v_mfma_f32_16x16x32_bf16 a[12:15], a[220:223], v[220:223], a[12:15]
    buffer_store_dwordx4 v[156:159], v8, s[64:67], s86 offen offset:2048 sc1
    v_mfma_f32_16x16x32_bf16 a[28:31], a[224:227], v[220:223], a[28:31]
    s_add_u32 s83, s77, 4096
    v_mfma_f32_16x16x32_bf16 a[44:47], a[228:231], v[220:223], a[44:47]
    buffer_load_dwordx4 a[4:7], v8, s[64:67], s83 offen offset:2048
    v_mfma_f32_16x16x32_bf16 a[60:63], a[232:235], v[220:223], a[60:63]
    v_mfma_f32_16x16x32_bf16 a[76:79], a[236:239], v[220:223], a[76:79]
    s_waitcnt lgkmcnt(0)
    s_barrier
    v_mfma_f32_16x16x32_bf16 a[80:83], v[72:75], v[224:227], a[80:83]
    s_add_u32 s83, s77, 86016
    ds_read_b128 v[32:35], v4 offset:32768
    ds_read_b128 v[52:55], v5 offset:37888
    v_mfma_f32_16x16x32_bf16 a[84:87], v[72:75], v[228:231], a[84:87]
    buffer_load_dwordx4 a[20:23], v8, s[64:67], s83 offen offset:2048
    v_mfma_f32_16x16x32_bf16 a[88:91], v[72:75], v[232:235], a[88:91]
    ds_read_b128 v[144:147], v6 offset:2048
    ds_read_b128 v[36:39], v4 offset:33792
    v_mfma_f32_16x16x32_bf16 a[92:95], v[72:75], v[236:239], a[92:95]
    v_accvgpr_read_b32 v164, a12
    v_accvgpr_read_b32 v165, a13
    v_accvgpr_read_b32 v166, a14
    v_mfma_f32_16x16x32_bf16 a[96:99], v[76:79], v[224:227], a[96:99]
    ds_read_b128 v[56:59], v5 offset:38912
    ds_read_b128 v[148:151], v6 offset:3072
    v_mfma_f32_16x16x32_bf16 a[100:103], v[76:79], v[228:231], a[100:103]
    s_add_u32 s83, s77, 167936
    v_accvgpr_read_b32 v167, a15
    v_mfma_f32_16x16x32_bf16 a[104:107], v[76:79], v[232:235], a[104:107]
    ds_read_b128 v[40:43], v4 offset:34816
    ds_read_b128 v[60:63], v5 offset:39936
    v_mfma_f32_16x16x32_bf16 a[108:111], v[76:79], v[236:239], a[108:111]
    buffer_load_dwordx4 a[36:39], v8, s[64:67], s83 offen offset:2048
    v_mfma_f32_16x16x32_bf16 a[112:115], v[80:83], v[224:227], a[112:115]
    ds_read_b128 v[152:155], v6 offset:4096
    ds_read_b128 v[44:47], v4 offset:35840
    v_mfma_f32_16x16x32_bf16 a[116:119], v[80:83], v[228:231], a[116:119]
    v_mfma_f32_16x16x32_bf16 a[120:123], v[80:83], v[232:235], a[120:123]
    s_add_u32 s83, s77, 4096
    s_waitcnt lgkmcnt(7)
    ds_read_b128 v[64:67], v5 offset:0
    ds_read_b128 v[156:159], v6 offset:5120
    v_mfma_f32_16x16x32_bf16 a[124:127], v[80:83], v[236:239], a[124:127]
    buffer_load_dwordx4 a[52:55], v8, s[64:67], s83 offen offset:3072
    v_add_f32 v32, v32, v52
    v_mfma_f32_16x16x32_bf16 a[128:131], v[84:87], v[224:227], a[128:131]
    ds_read_b128 v[48:51], v4 offset:36864
    ds_read_b128 v[68:71], v5 offset:1024
    v_mfma_f32_16x16x32_bf16 a[132:135], v[84:87], v[228:231], a[132:135]
    v_add_f32 v33, v33, v53
    v_add_f32 v34, v34, v54
    v_mfma_f32_16x16x32_bf16 a[136:139], v[84:87], v[232:235], a[136:139]
    ds_read_b128 v[160:163], v6 offset:6144
    v_add_f32 v35, v35, v55
    v_mfma_f32_16x16x32_bf16 a[140:143], v[84:87], v[236:239], a[140:143]
    s_add_u32 s83, s77, 86016
    v_add_f32 v164, v164, v144
    v_add_f32 v165, v165, v145
    v_add_f32 v166, v166, v146
    v_mfma_f32_16x16x32_bf16 a[144:147], v[88:91], v[224:227], a[144:147]
    buffer_load_dwordx4 a[68:71], v8, s[64:67], s83 offen offset:3072
    v_mfma_f32_16x16x32_bf16 a[148:151], v[88:91], v[228:231], a[148:151]
    s_waitcnt vmcnt(15)
    ds_read_b128 v[192:195], v29 offset:16384
    ds_read_b128 v[208:211], v30 offset:16384
    v_mfma_f32_16x16x32_bf16 a[152:155], v[88:91], v[232:235], a[152:155]
    v_add_f32 v167, v167, v147
    v_add_f32 v164, v164, v32
    v_mfma_f32_16x16x32_bf16 a[156:159], v[88:91], v[236:239], a[156:159]
    ds_read_b128 v[200:203], v29 offset:24576
    ds_read_b128 v[216:219], v30 offset:24576
    v_add_f32 v165, v165, v33
    v_mfma_f32_16x16x32_bf16 a[80:83], v[92:95], v[240:243], a[80:83]
    s_add_u32 s83, s77, 167936
    v_add_f32 v166, v166, v34
    v_add_f32 v167, v167, v35
    v_mfma_f32_16x16x32_bf16 a[84:87], v[92:95], v[244:247], a[84:87]
    ds_read_b128 v[196:199], v29 offset:18432
    ds_read_b128 v[212:215], v30 offset:18432
    v_mfma_f32_16x16x32_bf16 a[88:91], v[92:95], v[248:251], a[88:91]
    buffer_load_dwordx4 a[8:11], v8, s[64:67], s83 offen offset:3072
    v_mfma_f32_16x16x32_bf16 a[92:95], v[92:95], v[252:255], a[92:95]
    ds_read_b128 v[204:207], v29 offset:26624
    ds_read_b128 v[220:223], v30 offset:26624
    v_cvt_pk_bf16_f32 v16, v164, v165
    v_mfma_f32_16x16x32_bf16 a[96:99], v[96:99], v[240:243], a[96:99]
    v_cvt_pk_bf16_f32 v17, v166, v167
    v_accvgpr_read_b32 v168, a28
    v_mfma_f32_16x16x32_bf16 a[100:103], v[96:99], v[244:247], a[100:103]
    s_add_u32 s83, s77, 8192
    v_accvgpr_read_b32 v169, a29
    v_accvgpr_read_b32 v170, a30
    v_mfma_f32_16x16x32_bf16 a[104:107], v[96:99], v[248:251], a[104:107]
    buffer_load_dwordx4 a[24:27], v8, s[64:67], s83 offen offset:0
    v_accvgpr_read_b32 v171, a31
    v_mfma_f32_16x16x32_bf16 a[108:111], v[96:99], v[252:255], a[108:111]
    s_waitcnt lgkmcnt(15)
    v_add_f32 v36, v36, v56
    v_add_f32 v37, v37, v57
    v_mfma_f32_16x16x32_bf16 a[112:115], v[100:103], v[240:243], a[112:115]
    v_add_f32 v38, v38, v58
    v_add_f32 v39, v39, v59
    v_mfma_f32_16x16x32_bf16 a[116:119], v[100:103], v[244:247], a[116:119]
    v_add_f32 v168, v168, v148
    v_add_f32 v169, v169, v149
    v_mfma_f32_16x16x32_bf16 a[120:123], v[100:103], v[248:251], a[120:123]
    s_add_u32 s83, s77, 90112
    v_add_f32 v170, v170, v150
    v_add_f32 v171, v171, v151
    v_add_f32 v168, v168, v36
    v_mfma_f32_16x16x32_bf16 a[124:127], v[100:103], v[252:255], a[124:127]
    buffer_load_dwordx4 a[40:43], v8, s[64:67], s83 offen offset:0
    v_mfma_f32_16x16x32_bf16 a[128:131], v[104:107], v[240:243], a[128:131]
    v_add_f32 v169, v169, v37
    v_add_f32 v170, v170, v38
    v_mfma_f32_16x16x32_bf16 a[132:135], v[104:107], v[244:247], a[132:135]
    v_add_f32 v171, v171, v39
    v_cvt_pk_bf16_f32 v18, v168, v169
    v_mfma_f32_16x16x32_bf16 a[136:139], v[104:107], v[248:251], a[136:139]
    v_cvt_pk_bf16_f32 v19, v170, v171
    v_mfma_f32_16x16x32_bf16 a[140:143], v[104:107], v[252:255], a[140:143]
    buffer_store_dwordx4 v[16:19], v8, s[64:67], s63 offen offset:0 sc1
    v_accvgpr_read_b32 v172, a44
    v_mfma_f32_16x16x32_bf16 a[144:147], v[108:111], v[240:243], a[144:147]
    s_add_u32 s83, s77, 172032
    v_accvgpr_read_b32 v173, a45
    v_accvgpr_read_b32 v174, a46
    v_mfma_f32_16x16x32_bf16 a[148:151], v[108:111], v[244:247], a[148:151]
    buffer_load_dwordx4 a[56:59], v8, s[64:67], s83 offen offset:0
    v_mfma_f32_16x16x32_bf16 a[152:155], v[108:111], v[248:251], a[152:155]
    s_waitcnt lgkmcnt(14)
    v_accvgpr_read_b32 v175, a47
    v_add_f32 v40, v40, v60
    v_add_f32 v41, v41, v61
    v_mfma_f32_16x16x32_bf16 a[156:159], v[108:111], v[252:255], a[156:159]
    s_waitcnt lgkmcnt(0)
    v_add_f32 v42, v42, v62
    v_add_f32 v43, v43, v63
    v_mfma_f32_16x16x32_bf16 a[80:83], a[160:163], v[192:195], a[80:83]
    s_add_u32 s83, s77, 8192
    ds_read_b128 v[224:227], v29 offset:20480
    ds_read_b128 v[240:243], v30 offset:20480
    v_mfma_f32_16x16x32_bf16 a[96:99], a[164:167], v[192:195], a[96:99]
    ds_read_b128 v[232:235], v29 offset:28672
    ds_read_b128 v[248:251], v30 offset:28672
    v_mfma_f32_16x16x32_bf16 a[112:115], a[168:171], v[192:195], a[112:115]
    ds_read_b128 v[228:231], v29 offset:22528
    ds_read_b128 v[244:247], v30 offset:22528
    v_add_f32 v172, v172, v152
    v_mfma_f32_16x16x32_bf16 a[128:131], a[172:175], v[192:195], a[128:131]
    ds_read_b128 v[236:239], v29 offset:30720
    ds_read_b128 v[252:255], v30 offset:30720
    v_mfma_f32_16x16x32_bf16 a[144:147], a[176:179], v[192:195], a[144:147]
    buffer_load_dwordx4 a[72:75], v8, s[64:67], s83 offen offset:1024
    v_mfma_f32_16x16x32_bf16 a[80:83], a[180:183], v[208:211], a[80:83]
    v_add_f32 v173, v173, v153
    v_add_f32 v174, v174, v154
    v_mfma_f32_16x16x32_bf16 a[96:99], a[184:187], v[208:211], a[96:99]
    v_add_f32 v175, v175, v155
    v_add_f32 v172, v172, v40
    v_add_f32 v173, v173, v41
    v_mfma_f32_16x16x32_bf16 a[112:115], a[188:191], v[208:211], a[112:115]
    v_add_f32 v174, v174, v42
    v_add_f32 v175, v175, v43
    v_mfma_f32_16x16x32_bf16 a[128:131], a[192:195], v[208:211], a[128:131]
    v_cvt_pk_bf16_f32 v20, v172, v173
    v_cvt_pk_bf16_f32 v21, v174, v175
    v_mfma_f32_16x16x32_bf16 a[144:147], a[196:199], v[208:211], a[144:147]
    v_accvgpr_read_b32 v164, a60
    v_accvgpr_read_b32 v165, a61
    v_accvgpr_read_b32 v166, a62
    v_mfma_f32_16x16x32_bf16 a[80:83], a[200:203], v[200:203], a[80:83]
    s_waitcnt lgkmcnt(15)
    v_accvgpr_read_b32 v167, a63
    v_add_f32 v44, v44, v64
    v_mfma_f32_16x16x32_bf16 a[96:99], a[204:207], v[200:203], a[96:99]
    v_add_f32 v45, v45, v65
    v_add_f32 v46, v46, v66
    v_mfma_f32_16x16x32_bf16 a[112:115], a[208:211], v[200:203], a[112:115]
    v_add_f32 v47, v47, v67
    v_add_f32 v164, v164, v156
    v_mfma_f32_16x16x32_bf16 a[128:131], a[212:215], v[200:203], a[128:131]
    v_add_f32 v165, v165, v157
    v_add_f32 v166, v166, v158
    v_add_f32 v167, v167, v159
    v_mfma_f32_16x16x32_bf16 a[144:147], a[216:219], v[200:203], a[144:147]
    v_add_f32 v164, v164, v44
    v_add_f32 v165, v165, v45
    v_mfma_f32_16x16x32_bf16 a[80:83], a[220:223], v[216:219], a[80:83]
    v_add_f32 v166, v166, v46
    v_add_f32 v167, v167, v47
    v_mfma_f32_16x16x32_bf16 a[96:99], a[224:227], v[216:219], a[96:99]
    v_cvt_pk_bf16_f32 v22, v164, v165
    v_cvt_pk_bf16_f32 v23, v166, v167
    v_mfma_f32_16x16x32_bf16 a[112:115], a[228:231], v[216:219], a[112:115]
    buffer_store_dwordx4 v[20:23], v8, s[64:67], s63 offen offset:1024 sc1
    v_accvgpr_read_b32 v168, a76
    v_mfma_f32_16x16x32_bf16 a[128:131], a[232:235], v[216:219], a[128:131]
    v_accvgpr_read_b32 v169, a77
    v_accvgpr_read_b32 v170, a78
    v_mfma_f32_16x16x32_bf16 a[144:147], a[236:239], v[216:219], a[144:147]
    s_waitcnt lgkmcnt(15)
    v_accvgpr_read_b32 v171, a79
    v_add_f32 v48, v48, v68
    v_mfma_f32_16x16x32_bf16 a[84:87], a[160:163], v[196:199], a[84:87]
    ds_write_b128 v9, a[80:83] offset:8192
    v_mfma_f32_16x16x32_bf16 a[100:103], a[164:167], v[196:199], a[100:103]
    v_add_f32 v49, v49, v69
    v_add_f32 v50, v50, v70
    v_add_f32 v51, v51, v71
    v_mfma_f32_16x16x32_bf16 a[116:119], a[168:171], v[196:199], a[116:119]
    v_add_f32 v168, v168, v160
    v_add_f32 v169, v169, v161
    v_mfma_f32_16x16x32_bf16 a[132:135], a[172:175], v[196:199], a[132:135]
    v_add_f32 v170, v170, v162
    v_add_f32 v171, v171, v163
    v_mfma_f32_16x16x32_bf16 a[148:151], a[176:179], v[196:199], a[148:151]
    ds_write_b128 v9, a[96:99] offset:9216
    v_mfma_f32_16x16x32_bf16 a[84:87], a[180:183], v[212:215], a[84:87]
    v_add_f32 v168, v168, v48
    v_add_f32 v169, v169, v49
    v_add_f32 v170, v170, v50
    v_mfma_f32_16x16x32_bf16 a[100:103], a[184:187], v[212:215], a[100:103]
    v_add_f32 v171, v171, v51
    v_cvt_pk_bf16_f32 v24, v168, v169
    v_mfma_f32_16x16x32_bf16 a[116:119], a[188:191], v[212:215], a[116:119]
    v_cvt_pk_bf16_f32 v25, v170, v171
    v_mfma_f32_16x16x32_bf16 a[132:135], a[192:195], v[212:215], a[132:135]
    ds_write_b128 v9, a[112:115] offset:10240
    v_mfma_f32_16x16x32_bf16 a[148:151], a[196:199], v[212:215], a[148:151]
    buffer_store_dwordx2 v[24:25], v7, s[64:67], s63 offen offset:2048 sc1
    v_mfma_f32_16x16x32_bf16 a[84:87], a[200:203], v[204:207], a[84:87]
    s_add_u32 s83, s77, 90112
    v_mfma_f32_16x16x32_bf16 a[100:103], a[204:207], v[204:207], a[100:103]
    buffer_load_dwordx4 a[12:15], v8, s[64:67], s83 offen offset:1024
    v_mfma_f32_16x16x32_bf16 a[116:119], a[208:211], v[204:207], a[116:119]
    ds_write_b128 v9, a[128:131] offset:11264
    v_mfma_f32_16x16x32_bf16 a[132:135], a[212:215], v[204:207], a[132:135]
    v_mfma_f32_16x16x32_bf16 a[148:151], a[216:219], v[204:207], a[148:151]
    v_mfma_f32_16x16x32_bf16 a[84:87], a[220:223], v[220:223], a[84:87]
    s_add_u32 s83, s77, 172032
    v_mfma_f32_16x16x32_bf16 a[100:103], a[224:227], v[220:223], a[100:103]
    ds_write_b128 v9, a[144:147] offset:12288
    v_mfma_f32_16x16x32_bf16 a[116:119], a[228:231], v[220:223], a[116:119]
    buffer_load_dwordx4 a[28:31], v8, s[64:67], s83 offen offset:1024
    v_mfma_f32_16x16x32_bf16 a[132:135], a[232:235], v[220:223], a[132:135]
    v_mfma_f32_16x16x32_bf16 a[148:151], a[236:239], v[220:223], a[148:151]
    s_waitcnt lgkmcnt(5)
    v_mfma_f32_16x16x32_bf16 a[88:91], a[160:163], v[224:227], a[88:91]
    ds_write_b128 v9, a[84:87] offset:13312
    v_mfma_f32_16x16x32_bf16 a[104:107], a[164:167], v[224:227], a[104:107]
    s_waitcnt lgkmcnt(0)
    s_barrier
    v_mfma_f32_16x16x32_bf16 a[120:123], a[168:171], v[224:227], a[120:123]
    s_add_u32 s83, s77, 8192
    ds_read_b128 v[32:35], v4 offset:8192
    ds_read_b128 v[36:39], v4 offset:9216
    v_accvgpr_read_b32 v156, a240
    v_accvgpr_read_b32 v157, a241
    v_mfma_f32_16x16x32_bf16 a[136:139], a[172:175], v[224:227], a[136:139]
    ds_read_b128 v[40:43], v4 offset:10240
    ds_read_b128 v[44:47], v4 offset:11264
    v_accvgpr_read_b32 v158, a242
    v_mfma_f32_16x16x32_bf16 a[152:155], a[176:179], v[224:227], a[152:155]
    ds_write_b128 v9, a[100:103] offset:14336
    v_mfma_f32_16x16x32_bf16 a[88:91], a[180:183], v[240:243], a[88:91]
    ds_read_b128 v[48:51], v4 offset:12288
    v_accvgpr_read_b32 v159, a243
    v_accvgpr_read_b32 v160, a244
    v_mfma_f32_16x16x32_bf16 a[104:107], a[184:187], v[240:243], a[104:107]
    buffer_load_dwordx4 a[44:47], v8, s[64:67], s83 offen offset:2048
    v_mfma_f32_16x16x32_bf16 a[120:123], a[188:191], v[240:243], a[120:123]
    s_add_u32 s83, s77, 90112
    v_accvgpr_read_b32 v161, a245
    v_accvgpr_read_b32 v162, a246
    v_accvgpr_read_b32 v163, a247
    v_mfma_f32_16x16x32_bf16 a[136:139], a[192:195], v[240:243], a[136:139]
    ds_write_b128 v9, a[116:119] offset:15360
    v_mfma_f32_16x16x32_bf16 a[152:155], a[196:199], v[240:243], a[152:155]
    buffer_load_dwordx4 a[60:63], v8, s[64:67], s83 offen offset:2048
    v_accvgpr_read_b32 v164, a248
    v_mfma_f32_16x16x32_bf16 a[88:91], a[200:203], v[232:235], a[88:91]
    s_add_u32 s83, s77, 172032
    v_accvgpr_read_b32 v165, a249
    v_lshlrev_b32 v192, 16, v156
    v_mfma_f32_16x16x32_bf16 a[104:107], a[204:207], v[232:235], a[104:107]
    buffer_load_dwordx4 a[76:79], v8, s[64:67], s83 offen offset:2048
    v_and_b32 v193, 0xffff0000, v156
    v_mfma_f32_16x16x32_bf16 a[120:123], a[208:211], v[232:235], a[120:123]
    ds_write_b128 v9, a[132:135] offset:16384
    v_mfma_f32_16x16x32_bf16 a[136:139], a[212:215], v[232:235], a[136:139]
    v_lshlrev_b32 v194, 16, v157
    v_and_b32 v195, 0xffff0000, v157
    v_lshlrev_b32 v196, 16, v158
    v_mfma_f32_16x16x32_bf16 a[152:155], a[216:219], v[232:235], a[152:155]
    v_and_b32 v197, 0xffff0000, v158
    v_lshlrev_b32 v198, 16, v159
    v_mfma_f32_16x16x32_bf16 a[88:91], a[220:223], v[248:251], a[88:91]
    s_add_u32 s83, s77, 8192
    v_and_b32 v199, 0xffff0000, v159
    v_lshlrev_b32 v200, 16, v160
    v_and_b32 v201, 0xffff0000, v160
    v_mfma_f32_16x16x32_bf16 a[104:107], a[224:227], v[248:251], a[104:107]
    ds_write_b128 v9, a[148:151] offset:17408
    v_mfma_f32_16x16x32_bf16 a[120:123], a[228:231], v[248:251], a[120:123]
    buffer_load_dwordx4 a[80:83], v8, s[64:67], s83 offen offset:3072
    v_lshlrev_b32 v202, 16, v161
    v_mfma_f32_16x16x32_bf16 a[136:139], a[232:235], v[248:251], a[136:139]
    v_and_b32 v203, 0xffff0000, v161
    v_lshlrev_b32 v204, 16, v162
    v_mfma_f32_16x16x32_bf16 a[152:155], a[236:239], v[248:251], a[152:155]
    v_and_b32 v205, 0xffff0000, v162
    v_lshlrev_b32 v206, 16, v163
    v_and_b32 v207, 0xffff0000, v163
    v_mfma_f32_16x16x32_bf16 a[92:95], a[160:163], v[228:231], a[92:95]
    ds_write_b128 v9, a[88:91] offset:18432
    v_mfma_f32_16x16x32_bf16 a[108:111], a[164:167], v[228:231], a[108:111]
    s_waitcnt lgkmcnt(0)
    s_barrier
    v_lshlrev_b32 v208, 16, v164
    v_and_b32 v209, 0xffff0000, v164
    v_mfma_f32_16x16x32_bf16 a[124:127], a[168:171], v[228:231], a[124:127]
    s_add_u32 s83, s77, 90112
    ds_read_b128 v[52:55], v5 offset:13312
    ds_read_b128 v[56:59], v5 offset:14336
    v_mfma_f32_16x16x32_bf16 a[140:143], a[172:175], v[228:231], a[140:143]
    ds_write_b128 v9, a[104:107] offset:19456
    v_lshlrev_b32 v210, 16, v165
    v_mfma_f32_16x16x32_bf16 a[156:159], a[176:179], v[228:231], a[156:159]
    ds_read_b128 v[60:63], v5 offset:15360
    ds_read_b128 v[64:67], v5 offset:16384
    v_mfma_f32_16x16x32_bf16 a[92:95], a[180:183], v[244:247], a[92:95]
    ds_read_b128 v[68:71], v5 offset:17408
    v_and_b32 v211, 0xffff0000, v165
    v_mfma_f32_16x16x32_bf16 a[108:111], a[184:187], v[244:247], a[108:111]
    ds_write_b128 v9, a[120:123] offset:20480
    v_mfma_f32_16x16x32_bf16 a[124:127], a[188:191], v[244:247], a[124:127]
    buffer_load_dwordx4 a[96:99], v8, s[64:67], s83 offen offset:3072
    v_mfma_f32_16x16x32_bf16 a[140:143], a[192:195], v[244:247], a[140:143]
    s_add_u32 s83, s77, 172032
    s_lshl_b32 s22, s17, 31
    s_xor_b32 s22, s22, 0x3f800000
    v_mov_b32 v168, s22
    v_mov_b32 v169, s22
    v_mfma_f32_16x16x32_bf16 a[156:159], a[196:199], v[244:247], a[156:159]
    ds_write_b128 v9, a[136:139] offset:21504
    v_mfma_f32_16x16x32_bf16 a[92:95], a[200:203], v[236:239], a[92:95]
    buffer_load_dwordx4 a[112:115], v8, s[64:67], s83 offen offset:3072
    v_mfma_f32_16x16x32_bf16 a[108:111], a[204:207], v[236:239], a[108:111]
    s_add_u32 s83, s77, 12288
    s_waitcnt lgkmcnt(2)
    v_add_f32 v32, v32, v52
    v_add_f32 v33, v33, v53
    v_add_f32 v34, v34, v54
    v_add_f32 v35, v35, v55
    v_mfma_f32_16x16x32_bf16 a[124:127], a[208:211], v[236:239], a[124:127]
    ds_write_b128 v9, a[152:155] offset:22528
    v_add_f32 v36, v36, v56
    v_mfma_f32_16x16x32_bf16 a[140:143], a[212:215], v[236:239], a[140:143]
    buffer_load_dwordx4 a[128:131], v8, s[64:67], s83 offen offset:0
    v_add_f32 v37, v37, v57
    v_mfma_f32_16x16x32_bf16 a[156:159], a[216:219], v[236:239], a[156:159]
    buffer_load_dwordx4 v[72:75], v8, s[64:67], s68 offen offset:0 sc1
    v_add_f32 v38, v38, v58
    v_mfma_f32_16x16x32_bf16 a[92:95], a[220:223], v[252:255], a[92:95]
    buffer_load_dwordx4 v[76:79], v8, s[64:67], s68 offen offset:1024 sc1
    v_add_f32 v39, v39, v59
    v_add_f32 v40, v40, v60
    v_mfma_f32_16x16x32_bf16 a[108:111], a[224:227], v[252:255], a[108:111]
    buffer_load_dwordx2 v[80:81], v7, s[64:67], s68 offen offset:2048 sc1
    v_add_f32 v41, v41, v61
    v_mfma_f32_16x16x32_bf16 a[124:127], a[228:231], v[252:255], a[124:127]
    v_add_f32 v42, v42, v62
    v_add_f32 v43, v43, v63
    v_add_f32 v44, v44, v64
    v_mfma_f32_16x16x32_bf16 a[140:143], a[232:235], v[252:255], a[140:143]
    v_add_f32 v45, v45, v65
    v_add_f32 v46, v46, v66
    v_add_f32 v47, v47, v67
    v_mfma_f32_16x16x32_bf16 a[156:159], a[236:239], v[252:255], a[156:159]
    v_add_f32 v48, v48, v68
    v_add_f32 v49, v49, v69
    v_add_f32 v50, v50, v70
    v_add_f32 v51, v51, v71
    s_waitcnt lgkmcnt(0)
    s_barrier
    ds_read_b128 v[84:87], v6 offset:18432
    ds_read_b128 v[88:91], v6 offset:19456
    ds_read_b128 v[92:95], v6 offset:20480
    ds_read_b128 v[96:99], v6 offset:21504
    ds_read_b128 v[100:103], v6 offset:22528
    s_add_u32 s83, s77, 94208
    buffer_load_dwordx4 a[144:147], v8, s[64:67], s83 offen offset:0
    s_add_u32 s83, s77, 176128
    buffer_load_dwordx4 a[84:87], v8, s[64:67], s83 offen offset:0
    s_add_u32 s83, s77, 12288
    buffer_load_dwordx4 a[100:103], v8, s[64:67], s83 offen offset:1024
    s_add_u32 s83, s77, 94208
    buffer_load_dwordx4 a[116:119], v8, s[64:67], s83 offen offset:1024
    s_add_u32 s83, s77, 176128
    buffer_load_dwordx4 a[132:135], v8, s[64:67], s83 offen offset:1024
    s_add_u32 s83, s77, 12288
    buffer_load_dwordx4 a[148:151], v8, s[64:67], s83 offen offset:2048
    s_add_u32 s83, s77, 94208
    buffer_load_dwordx4 a[88:91], v8, s[64:67], s83 offen offset:2048
    v_accvgpr_read_b32 v212, a92
    v_accvgpr_read_b32 v213, a93
    v_accvgpr_read_b32 v214, a94
    v_accvgpr_read_b32 v215, a95
    v_accvgpr_read_b32 v216, a108
    v_accvgpr_read_b32 v217, a109
    v_accvgpr_read_b32 v218, a110
    v_accvgpr_read_b32 v219, a111
    v_accvgpr_read_b32 v220, a124
    v_accvgpr_read_b32 v221, a125
    v_accvgpr_read_b32 v222, a126
    v_accvgpr_read_b32 v223, a127
    v_accvgpr_read_b32 v224, a140
    v_accvgpr_read_b32 v225, a141
    v_accvgpr_read_b32 v226, a142
    v_accvgpr_read_b32 v227, a143
    v_accvgpr_read_b32 v228, a156
    v_accvgpr_read_b32 v229, a157
    v_accvgpr_read_b32 v230, a158
    v_accvgpr_read_b32 v231, a159
    s_waitcnt lgkmcnt(0)
    s_barrier
    v_pk_add_f32 v[212:213], v[212:213], v[84:85]
    v_pk_add_f32 v[214:215], v[214:215], v[86:87]
    v_pk_add_f32 v[212:213], v[212:213], v[32:33]
    v_pk_add_f32 v[214:215], v[214:215], v[34:35]
    v_cvt_pk_bf16_f32 v144, v212, v213
    v_cvt_pk_bf16_f32 v145, v214, v215
    v_pk_add_f32 v[216:217], v[216:217], v[88:89]
    v_pk_add_f32 v[218:219], v[218:219], v[90:91]
    v_pk_add_f32 v[216:217], v[216:217], v[36:37]
    v_pk_add_f32 v[218:219], v[218:219], v[38:39]
    v_cvt_pk_bf16_f32 v146, v216, v217
    v_cvt_pk_bf16_f32 v147, v218, v219
    v_pk_add_f32 v[220:221], v[220:221], v[92:93]
    v_pk_add_f32 v[222:223], v[222:223], v[94:95]
    v_pk_add_f32 v[220:221], v[220:221], v[40:41]
    v_pk_add_f32 v[222:223], v[222:223], v[42:43]
    v_cvt_pk_bf16_f32 v148, v220, v221
    v_cvt_pk_bf16_f32 v149, v222, v223
    v_pk_add_f32 v[224:225], v[224:225], v[96:97]
    v_pk_add_f32 v[226:227], v[226:227], v[98:99]
    v_pk_add_f32 v[224:225], v[224:225], v[44:45]
    v_pk_add_f32 v[226:227], v[226:227], v[46:47]
    v_cvt_pk_bf16_f32 v150, v224, v225
    v_cvt_pk_bf16_f32 v151, v226, v227
    v_pk_add_f32 v[228:229], v[228:229], v[100:101]
    v_pk_add_f32 v[230:231], v[230:231], v[102:103]
    v_pk_add_f32 v[228:229], v[228:229], v[48:49]
    v_pk_add_f32 v[230:231], v[230:231], v[50:51]
    v_cvt_pk_bf16_f32 v152, v228, v229
    v_cvt_pk_bf16_f32 v153, v230, v231
    v_lshlrev_b32 v212, 16, v144
    v_and_b32 v213, 0xffff0000, v144
    v_lshlrev_b32 v214, 16, v145
    v_and_b32 v215, 0xffff0000, v145
    v_lshlrev_b32 v216, 16, v146
    v_and_b32 v217, 0xffff0000, v146
    v_lshlrev_b32 v218, 16, v147
    v_and_b32 v219, 0xffff0000, v147
    v_lshlrev_b32 v220, 16, v148
    v_and_b32 v221, 0xffff0000, v148
    v_lshlrev_b32 v222, 16, v149
    v_and_b32 v223, 0xffff0000, v149
    v_lshlrev_b32 v224, 16, v150
    v_and_b32 v225, 0xffff0000, v150
    v_lshlrev_b32 v226, 16, v151
    v_and_b32 v227, 0xffff0000, v151
    v_lshlrev_b32 v228, 16, v152
    v_and_b32 v229, 0xffff0000, v152
    v_lshlrev_b32 v230, 16, v153
    v_and_b32 v231, 0xffff0000, v153
    s_cmp_lg_u32 s70, 0
    s_cbranch_scc1 k2_priv
    s_waitcnt vmcnt(7)
    v_max3_u32 v232, v72, v73, v74
    v_max3_u32 v233, v75, v76, v77
    v_max3_u32 v234, v78, v79, v80
    v_max3_u32 v232, v232, v233, v81
    v_max_u32 v232, v232, v234
    v_cmp_eq_u32 vcc, -1, v232
    s_cbranch_vccnz k2_retry
k2_own:
    v_lshlrev_b32 v232, 16, v72
    v_and_b32 v233, 0xffff0000, v72
    v_lshlrev_b32 v234, 16, v73
    v_and_b32 v235, 0xffff0000, v73
    v_pk_add_f32 v[232:233], v[212:213], v[232:233] neg_lo:[0,1] neg_hi:[0,1]
    v_pk_add_f32 v[234:235], v[214:215], v[234:235] neg_lo:[0,1] neg_hi:[0,1]
    v_cvt_pk_bf16_f32 v236, v232, v233
    v_cvt_pk_bf16_f32 v237, v234, v235
    v_lshlrev_b32 v232, 16, v236
    v_and_b32 v233, 0xffff0000, v236
    v_lshlrev_b32 v234, 16, v237
    v_and_b32 v235, 0xffff0000, v237
    v_pk_fma_f32 v[232:233], v[232:233], v[168:169], v[192:193]
    v_pk_fma_f32 v[234:235], v[234:235], v[168:169], v[194:195]
    v_cvt_pk_bf16_f32 v32, v232, v233
    v_cvt_pk_bf16_f32 v33, v234, v235
    buffer_store_dwordx2 v[32:33], v7, s[64:67], s62 offen offset:0 sc1
    v_lshlrev_b32 v240, 16, v74
    v_and_b32 v241, 0xffff0000, v74
    v_lshlrev_b32 v242, 16, v75
    v_and_b32 v243, 0xffff0000, v75
    v_pk_add_f32 v[240:241], v[216:217], v[240:241] neg_lo:[0,1] neg_hi:[0,1]
    v_pk_add_f32 v[242:243], v[218:219], v[242:243] neg_lo:[0,1] neg_hi:[0,1]
    v_cvt_pk_bf16_f32 v244, v240, v241
    v_cvt_pk_bf16_f32 v245, v242, v243
    v_lshlrev_b32 v240, 16, v244
    v_and_b32 v241, 0xffff0000, v244
    v_lshlrev_b32 v242, 16, v245
    v_and_b32 v243, 0xffff0000, v245
    v_pk_fma_f32 v[240:241], v[240:241], v[168:169], v[196:197]
    v_pk_fma_f32 v[242:243], v[242:243], v[168:169], v[198:199]
    v_cvt_pk_bf16_f32 v34, v240, v241
    v_cvt_pk_bf16_f32 v35, v242, v243
    buffer_store_dwordx2 v[34:35], v7, s[64:67], s62 offen offset:512 sc1
    v_lshlrev_b32 v232, 16, v76
    v_and_b32 v233, 0xffff0000, v76
    v_lshlrev_b32 v234, 16, v77
    v_and_b32 v235, 0xffff0000, v77
    v_pk_add_f32 v[232:233], v[220:221], v[232:233] neg_lo:[0,1] neg_hi:[0,1]
    v_pk_add_f32 v[234:235], v[222:223], v[234:235] neg_lo:[0,1] neg_hi:[0,1]
    v_cvt_pk_bf16_f32 v236, v232, v233
    v_cvt_pk_bf16_f32 v237, v234, v235
    v_lshlrev_b32 v232, 16, v236
    v_and_b32 v233, 0xffff0000, v236
    v_lshlrev_b32 v234, 16, v237
    v_and_b32 v235, 0xffff0000, v237
    v_pk_fma_f32 v[232:233], v[232:233], v[168:169], v[200:201]
    v_pk_fma_f32 v[234:235], v[234:235], v[168:169], v[202:203]
    v_cvt_pk_bf16_f32 v36, v232, v233
    v_cvt_pk_bf16_f32 v37, v234, v235
    buffer_store_dwordx2 v[36:37], v7, s[64:67], s62 offen offset:1024 sc1
    v_lshlrev_b32 v240, 16, v78
    v_and_b32 v241, 0xffff0000, v78
    v_lshlrev_b32 v242, 16, v79
    v_and_b32 v243, 0xffff0000, v79
    v_pk_add_f32 v[240:241], v[224:225], v[240:241] neg_lo:[0,1] neg_hi:[0,1]
    v_pk_add_f32 v[242:243], v[226:227], v[242:243] neg_lo:[0,1] neg_hi:[0,1]
    v_cvt_pk_bf16_f32 v244, v240, v241
    v_cvt_pk_bf16_f32 v245, v242, v243
    v_lshlrev_b32 v240, 16, v244
    v_and_b32 v241, 0xffff0000, v244
    v_lshlrev_b32 v242, 16, v245
    v_and_b32 v243, 0xffff0000, v245
    v_pk_fma_f32 v[240:241], v[240:241], v[168:169], v[204:205]
    v_pk_fma_f32 v[242:243], v[242:243], v[168:169], v[206:207]
    v_cvt_pk_bf16_f32 v38, v240, v241
    v_cvt_pk_bf16_f32 v39, v242, v243
    buffer_store_dwordx2 v[38:39], v7, s[64:67], s62 offen offset:1536 sc1
    v_lshlrev_b32 v232, 16, v80
    v_and_b32 v233, 0xffff0000, v80
    v_lshlrev_b32 v234, 16, v81
    v_and_b32 v235, 0xffff0000, v81
    v_pk_add_f32 v[232:233], v[228:229], v[232:233] neg_lo:[0,1] neg_hi:[0,1]
    v_pk_add_f32 v[234:235], v[230:231], v[234:235] neg_lo:[0,1] neg_hi:[0,1]
    v_cvt_pk_bf16_f32 v236, v232, v233
    v_cvt_pk_bf16_f32 v237, v234, v235
    v_lshlrev_b32 v232, 16, v236
    v_and_b32 v233, 0xffff0000, v236
    v_lshlrev_b32 v234, 16, v237
    v_and_b32 v235, 0xffff0000, v237
    v_pk_fma_f32 v[232:233], v[232:233], v[168:169], v[208:209]
    v_pk_fma_f32 v[234:235], v[234:235], v[168:169], v[210:211]
    v_cvt_pk_bf16_f32 v40, v232, v233
    v_cvt_pk_bf16_f32 v41, v234, v235
    buffer_store_dwordx2 v[40:41], v7, s[64:67], s62 offen offset:2048 sc1
    v_mov_b32 v44, 0
    v_mov_b32 v45, 0
    s_mov_b32 s23, 0x3f803f80
    v_dot2_f32_bf16 v44, v32, s23, v44
    v_dot2_f32_bf16 v45, v32, v32, v45
    v_dot2_f32_bf16 v44, v33, s23, v44
    v_dot2_f32_bf16 v45, v33, v33, v45
    v_dot2_f32_bf16 v44, v34, s23, v44
    v_dot2_f32_bf16 v45, v34, v34, v45
    v_dot2_f32_bf16 v44, v35, s23, v44
    v_dot2_f32_bf16 v45, v35, v35, v45
    v_dot2_f32_bf16 v44, v36, s23, v44
    v_dot2_f32_bf16 v45, v36, v36, v45
    v_dot2_f32_bf16 v44, v37, s23, v44
    v_dot2_f32_bf16 v45, v37, v37, v45
    v_dot2_f32_bf16 v44, v38, s23, v44
    v_dot2_f32_bf16 v45, v38, v38, v45
    v_dot2_f32_bf16 v44, v39, s23, v44
    v_dot2_f32_bf16 v45, v39, v39, v45
    v_dot2_f32_bf16 v44, v40, s23, v44
    v_dot2_f32_bf16 v45, v40, v40, v45
    v_dot2_f32_bf16 v44, v41, s23, v44
    v_dot2_f32_bf16 v45, v41, v41, v45
    s_nop 3
    v_mov_b32 v46, v44
    v_mov_b32 v47, v45
    s_nop 1
    v_permlane16_swap_b32 v44, v46
    v_permlane16_swap_b32 v45, v47
    s_nop 1
    v_add_f32 v44, v44, v46
    v_add_f32 v45, v45, v47
    s_nop 3
    v_mov_b32 v46, v44
    v_mov_b32 v47, v45
    s_nop 1
    v_permlane32_swap_b32 v44, v46
    v_permlane32_swap_b32 v45, v47
    s_nop 1
    v_add_f32 v44, v44, v46
    v_add_f32 v45, v45, v47
    s_mov_b32 exec_hi, 0
    buffer_store_dwordx2 v[44:45], v10, s[64:67], s45 offen sc1
    s_mov_b64 exec, -1
k2_skip:
    s_add_u32 s83, s77, 176128
    buffer_load_dwordx4 v[144:147], v8, s[64:67], s83 offen offset:2048
    s_add_u32 s83, s77, 12288
    buffer_load_dwordx4 v[148:151], v8, s[64:67], s83 offen offset:3072
    s_add_u32 s83, s77, 94208
    buffer_load_dwordx4 v[152:155], v8, s[64:67], s83 offen offset:3072
    s_add_u32 s83, s77, 176128
    buffer_load_dwordx4 v[156:159], v8, s[64:67], s83 offen offset:3072
    s_add_u32 s83, s77, 16384
    buffer_load_dwordx4 v[160:163], v8, s[64:67], s83 offen offset:0
    s_add_u32 s83, s77, 98304
    buffer_load_dwordx4 v[164:167], v8, s[64:67], s83 offen offset:0
    s_add_u32 s83, s77, 180224
    buffer_load_dwordx4 v[168:171], v8, s[64:67], s83 offen offset:0
    s_add_u32 s83, s77, 16384
    buffer_load_dwordx4 v[172:175], v8, s[64:67], s83 offen offset:1024
    s_add_u32 s83, s77, 98304
    buffer_load_dwordx4 v[192:195], v8, s[64:67], s83 offen offset:1024
    s_add_u32 s83, s77, 180224
    buffer_load_dwordx4 v[196:199], v8, s[64:67], s83 offen offset:1024
    s_add_u32 s83, s77, 16384
    buffer_load_dwordx4 v[200:203], v8, s[64:67], s83 offen offset:2048
    s_add_u32 s83, s77, 98304
    buffer_load_dwordx4 v[204:207], v8, s[64:67], s83 offen offset:2048
    s_add_u32 s83, s77, 180224
    buffer_load_dwordx4 v[208:211], v8, s[64:67], s83 offen offset:2048
    s_add_u32 s83, s77, 16384
    buffer_load_dwordx4 v[212:215], v8, s[64:67], s83 offen offset:3072
    s_add_u32 s83, s77, 98304
    buffer_load_dwordx4 v[216:219], v8, s[64:67], s83 offen offset:3072
    s_add_u32 s83, s77, 180224
    buffer_load_dwordx4 v[220:223], v8, s[64:67], s83 offen offset:3072
kf_gate:
    v_lshlrev_b32 v9, 7, v1
    s_lshr_b32 s48, s76, 3
    s_lshl4_add_u32 s48, s19, s48
    s_lshl_b32 s48, s48, 13
    s_add_u32 s48, s48, s74
    s_add_u32 s48, s48, 9437184
    buffer_load_dword v10, v9, s[64:67], s48 offen sc1
    s_load_dwordx2 s[24:25], s[0:1], 72
    s_mov_b32 s17, 986500301
    s_mov_b32 s18, 925353388
    v_mov_b32 v16, 0x3f803f80
    v_mov_b32 v17, 0x3f803f80
    v_mov_b32 v18, 0x3f803f80
    v_mov_b32 v19, 0x3f803f80
    s_and_b32 s22, s16, 1
    s_mul_i32 s29, s22, 20480
    s_lshr_b32 s22, s16, 1
    s_lshl_b32 s22, s22, 11
    s_add_u32 s29, s29, s22
    s_mul_i32 s28, s19, 163840
    s_add_u32 s28, s28, s74
    s_add_u32 s28, s28, s29
    s_mul_i32 s30, s16, 20480
    s_add_u32 s30, s30, 81920
    s_nop 0
    s_waitcnt vmcnt(63)
    v_mfma_f32_16x16x32_bf16 v[20:23], v[112:115], v[16:19], 0
    s_mul_i32 s43, s19, 393216
    s_mul_i32 s50, s73, 3072
    s_add_u32 s43, s43, s50
    v_mfma_f32_16x16x32_bf16 v[24:27], v[116:119], v[16:19], 0
    s_lshl_b32 s50, s16, 8
    s_add_u32 s43, s43, s50
    s_add_u32 s43, s43, s74
    v_mfma_f32_16x16x32_bf16 v[28:31], v[120:123], v[16:19], 0
    s_add_u32 s43, s43, 3145728
    s_cmp_lg_u32 s71, 0
    s_cselect_b32 s43, 27262976, s43
    s_waitcnt vmcnt(63)
    v_mfma_f32_16x16x32_bf16 v[20:23], v[124:127], v[16:19], v[20:23]
    s_and_b32 s87, s76, 7
    s_lshr_b32 s86, s76, 3
    s_lshl_b32 s50, s19, 3
    v_mfma_f32_16x16x32_bf16 v[24:27], v[128:131], v[16:19], v[24:27]
    s_add_u32 s86, s86, s50
    s_lshr_b32 s50, s2, 5
    s_mul_i32 s51, s16, 12288
    v_mfma_f32_16x16x32_bf16 v[28:31], v[132:135], v[16:19], v[28:31]
    s_mul_i32 s59, s87, 245760
    s_add_u32 s59, s59, 20971520
    s_and_b32 s50, s50, 3
    s_waitcnt vmcnt(63)
    v_mfma_f32_16x16x32_bf16 v[20:23], v[136:139], v[16:19], v[20:23]
    s_mul_i32 s88, s50, 3072
    s_add_u32 s88, s88, s51
    s_add_u32 s92, s88, s59
    v_mfma_f32_16x16x32_bf16 v[24:27], v[140:143], v[16:19], v[24:27]
    s_add_u32 s50, s50, 1
    s_and_b32 s50, s50, 3
    s_mul_i32 s89, s50, 3072
    v_mfma_f32_16x16x32_bf16 v[28:31], v[176:179], v[16:19], v[28:31]
    s_add_u32 s89, s89, s51
    s_add_u32 s93, s89, s59
    s_add_u32 s50, s50, 1
    s_waitcnt vmcnt(63)
    v_mfma_f32_16x16x32_bf16 v[20:23], v[180:183], v[16:19], v[20:23]
    s_and_b32 s50, s50, 3
    s_mul_i32 s90, s50, 3072
    s_add_u32 s90, s90, s51
    v_mfma_f32_16x16x32_bf16 v[24:27], v[184:187], v[16:19], v[24:27]
    s_add_u32 s94, s90, s59
    s_add_u32 s50, s50, 1
    s_and_b32 s50, s50, 3
    v_mfma_f32_16x16x32_bf16 v[28:31], v[188:191], v[16:19], v[28:31]
    s_mul_i32 s91, s50, 3072
    s_add_u32 s91, s91, s51
    s_add_u32 s95, s91, s59
    s_waitcnt vmcnt(61)
    v_mfma_f32_16x16x32_bf16 v[20:23], a[252:255], v[16:19], v[20:23]
    s_add_u32 s50, s50, 1
    v_add_u32 v11, 49152, v8
    v_add_u32 v12, 98304, v8
    v_mfma_f32_16x16x32_bf16 v[24:27], a[0:3], v[16:19], v[24:27]
    v_add_u32 v13, 147456, v8
    v_add_u32 v14, 196608, v8
    s_mul_i32 s51, s86, 49152
    v_mfma_f32_16x16x32_bf16 v[28:31], a[16:19], v[16:19], v[28:31]
    s_add_u32 s51, s51, s74
    s_add_u32 s51, s51, 3145728
    v_add_u32 v4, s51, v8
    s_waitcnt vmcnt(56)
    v_mfma_f32_16x16x32_bf16 v[20:23], a[32:35], v[16:19], v[20:23]
    v_add_u32 v5, 98304, v4
    v_add_u32 v6, 196608, v4
    v_add_u32 v7, 294912, v4
    v_mfma_f32_16x16x32_bf16 v[24:27], a[48:51], v[16:19], v[24:27]
    s_mov_b32 s62, 0xbdd2d3e8
    s_mov_b32 s63, 0xc0135761
    s_cmp_eq_u32 s70, 0
    v_mfma_f32_16x16x32_bf16 v[28:31], a[64:67], v[16:19], v[28:31]
    s_cselect_b64 s[84:85], -1, 0
    v_and_b32 v56, 3, v1
    v_lshlrev_b32 v56, 10, v56
    s_waitcnt vmcnt(52)
    v_mfma_f32_16x16x32_bf16 v[20:23], a[4:7], v[16:19], v[20:23]
    v_lshrrev_b32 v57, 2, v1
    v_lshl_add_u32 v56, v57, 4, v56
    v_lshlrev_b32 v57, 5, v57
    v_mfma_f32_16x16x32_bf16 v[24:27], a[20:23], v[16:19], v[24:27]
    v_and_b32 v58, 1, v1
    v_lshl_add_u32 v57, v58, 4, v57
    s_add_u32 s50, s30, 19456
    v_mfma_f32_16x16x32_bf16 v[28:31], a[36:39], v[16:19], v[28:31]
    v_add_u32 v57, s50, v57
    v_lshlrev_b32 v60, 4, v2
    v_add_u32 v60, 101376, v60
    s_waitcnt vmcnt(49)
    v_mfma_f32_16x16x32_bf16 v[20:23], a[52:55], v[16:19], v[20:23]
    s_lshl_b32 s47, s16, 8
    s_add_u32 s47, s47, s48
    s_add_u32 s49, s47, 4096
    v_mfma_f32_16x16x32_bf16 v[24:27], a[68:71], v[16:19], v[24:27]
    v_add_u32 v61, s30, v8
    v_mfma_f32_16x16x32_bf16 v[28:31], a[8:11], v[16:19], v[28:31]
    s_waitcnt vmcnt(0) lgkmcnt(0)
    v_cmp_u_f32 vcc, v10, v10
    s_mov_b32 s26, 2621440
    s_mov_b32 s27, 0x20000
    s_cbranch_vccnz kf_gr
kf_gok:
    v_add_u32 v10, 40960, v8
    v_and_b32 v9, 1, v3
    v_mul_u32_u24 v9, 49152, v9
    v_lshl_add_u32 v9, v2, 4, v9
    v_lshrrev_b32 v58, 1, v3
    v_lshl_add_u32 v9, v58, 3, v9
    s_add_u32 m0, s29, 0
    s_add_u32 s44, s28, 0
    buffer_load_dwordx4 v8, s[64:67], s44 offen sc1 lds
    buffer_load_dwordx4 v8, s[64:67], s44 offen offset:1024 sc1 lds
    s_add_u32 m0, s29, 4096
    s_add_u32 s44, s28, 4096
    buffer_load_dwordx4 v8, s[64:67], s44 offen sc1 lds
    buffer_load_dwordx4 v8, s[64:67], s44 offen offset:1024 sc1 lds
    s_add_u32 m0, s29, 8192
    s_add_u32 s44, s28, 8192
    buffer_load_dwordx4 v8, s[64:67], s44 offen sc1 lds
    buffer_load_dwordx4 v8, s[64:67], s44 offen offset:1024 sc1 lds
    s_add_u32 m0, s29, 12288
    s_add_u32 s44, s28, 12288
    buffer_load_dwordx4 v8, s[64:67], s44 offen sc1 lds
    buffer_load_dwordx4 v8, s[64:67], s44 offen offset:1024 sc1 lds
    s_add_u32 m0, s29, 16384
    s_add_u32 s44, s28, 16384
    buffer_load_dwordx4 v8, s[64:67], s44 offen sc1 lds
    buffer_load_dwordx4 v8, s[64:67], s44 offen offset:1024 sc1 lds
    buffer_load_dwordx4 v[40:43], v56, s[64:67], s47 offen sc1
    buffer_load_dwordx4 v[44:47], v56, s[64:67], s49 offen sc1
    s_add_u32 m0, s29, 40960
    s_add_u32 s44, s28, 40960
    buffer_load_dwordx4 v8, s[64:67], s44 offen sc1 lds
    buffer_load_dwordx4 v8, s[64:67], s44 offen offset:1024 sc1 lds
    s_waitcnt vmcnt(59)
    v_mfma_f32_16x16x32_bf16 v[20:23], a[24:27], v[16:19], v[20:23]
    v_mfma_f32_16x16x32_bf16 v[24:27], a[40:43], v[16:19], v[24:27]
    v_mfma_f32_16x16x32_bf16 v[28:31], a[56:59], v[16:19], v[28:31]
    s_waitcnt vmcnt(54)
    v_mfma_f32_16x16x32_bf16 v[20:23], a[72:75], v[16:19], v[20:23]
    v_mfma_f32_16x16x32_bf16 v[24:27], a[12:15], v[16:19], v[24:27]
    v_mfma_f32_16x16x32_bf16 v[28:31], a[28:31], v[16:19], v[28:31]
    s_waitcnt vmcnt(51)
    v_mfma_f32_16x16x32_bf16 v[20:23], a[44:47], v[16:19], v[20:23]
    v_mfma_f32_16x16x32_bf16 v[24:27], a[60:63], v[16:19], v[24:27]
    v_mfma_f32_16x16x32_bf16 v[28:31], a[76:79], v[16:19], v[28:31]
    s_waitcnt vmcnt(48)
    v_mfma_f32_16x16x32_bf16 v[20:23], a[80:83], v[16:19], v[20:23]
    v_mfma_f32_16x16x32_bf16 v[24:27], a[96:99], v[16:19], v[24:27]
    v_mfma_f32_16x16x32_bf16 v[28:31], a[112:115], v[16:19], v[28:31]
    s_waitcnt vmcnt(42)
    v_mfma_f32_16x16x32_bf16 v[20:23], a[128:131], v[16:19], v[20:23]
    v_mfma_f32_16x16x32_bf16 v[24:27], a[144:147], v[16:19], v[24:27]
    v_mfma_f32_16x16x32_bf16 v[28:31], a[84:87], v[16:19], v[28:31]
    s_waitcnt vmcnt(39)
    v_mfma_f32_16x16x32_bf16 v[20:23], a[100:103], v[16:19], v[20:23]
    v_mfma_f32_16x16x32_bf16 v[24:27], a[116:119], v[16:19], v[24:27]
    v_mfma_f32_16x16x32_bf16 v[28:31], a[132:135], v[16:19], v[28:31]
    s_waitcnt vmcnt(30)
    v_mfma_f32_16x16x32_bf16 v[20:23], a[148:151], v[16:19], v[20:23]
    v_mfma_f32_16x16x32_bf16 v[24:27], a[88:91], v[16:19], v[24:27]
    v_mfma_f32_16x16x32_bf16 v[28:31], v[144:147], v[16:19], v[28:31]
    s_waitcnt vmcnt(27)
    v_mfma_f32_16x16x32_bf16 v[20:23], v[148:151], v[16:19], v[20:23]
    v_mfma_f32_16x16x32_bf16 v[24:27], v[152:155], v[16:19], v[24:27]
    v_mfma_f32_16x16x32_bf16 v[28:31], v[156:159], v[16:19], v[28:31]
    s_waitcnt vmcnt(24)
    v_mfma_f32_16x16x32_bf16 v[20:23], v[160:163], v[16:19], v[20:23]
    v_mfma_f32_16x16x32_bf16 v[24:27], v[164:167], v[16:19], v[24:27]
    v_mfma_f32_16x16x32_bf16 v[28:31], v[168:171], v[16:19], v[28:31]
    s_waitcnt vmcnt(21)
    v_mfma_f32_16x16x32_bf16 v[20:23], v[172:175], v[16:19], v[20:23]
    v_mfma_f32_16x16x32_bf16 v[24:27], v[192:195], v[16:19], v[24:27]
    v_mfma_f32_16x16x32_bf16 v[28:31], v[196:199], v[16:19], v[28:31]
    s_waitcnt vmcnt(18)
    v_mfma_f32_16x16x32_bf16 v[20:23], v[200:203], v[16:19], v[20:23]
    v_mfma_f32_16x16x32_bf16 v[24:27], v[204:207], v[16:19], v[24:27]
    v_mfma_f32_16x16x32_bf16 v[28:31], v[208:211], v[16:19], v[28:31]
    s_waitcnt vmcnt(15)
    v_mfma_f32_16x16x32_bf16 v[20:23], v[212:215], v[16:19], v[20:23]
    v_mfma_f32_16x16x32_bf16 v[24:27], v[216:219], v[16:19], v[24:27]
    v_mfma_f32_16x16x32_bf16 v[28:31], v[220:223], v[16:19], v[28:31]
    s_waitcnt vmcnt(12)
    s_barrier
    ds_read_b128 v[224:227], v8 offset:0
    ds_read_b128 v[228:231], v8 offset:20480
    ds_read_b128 v[232:235], v8 offset:1024
    ds_read_b128 v[236:239], v8 offset:21504
    ds_read_b128 v[240:243], v8 offset:2048
    ds_read_b128 v[244:247], v8 offset:22528
    s_waitcnt lgkmcnt(4)
    v_mfma_f32_16x16x32_bf16 v[64:67], v[112:115], v[224:227], 0
    s_add_u32 m0, s29, 45056
    v_mfma_f32_16x16x32_bf16 v[72:75], v[116:119], v[224:227], 0
    s_add_u32 s44, s28, 45056
    v_mfma_f32_16x16x32_bf16 v[80:83], v[120:123], v[224:227], 0
    buffer_load_dwordx4 v8, s[64:67], s44 offen sc1 lds
    v_mfma_f32_16x16x32_bf16 v[68:71], v[112:115], v[228:231], 0
    buffer_load_dwordx4 v8, s[64:67], s44 offen offset:1024 sc1 lds
    v_mfma_f32_16x16x32_bf16 v[76:79], v[116:119], v[228:231], 0
    v_mfma_f32_16x16x32_bf16 v[84:87], v[120:123], v[228:231], 0
    s_waitcnt lgkmcnt(2)
    ds_read_b128 v[248:251], v8 offset:3072
    ds_read_b128 v[252:255], v8 offset:23552
    v_mfma_f32_16x16x32_bf16 v[64:67], v[124:127], v[232:235], v[64:67]
    v_mfma_f32_16x16x32_bf16 v[72:75], v[128:131], v[232:235], v[72:75]
    v_mfma_f32_16x16x32_bf16 v[80:83], v[132:135], v[232:235], v[80:83]
    v_mfma_f32_16x16x32_bf16 v[68:71], v[124:127], v[236:239], v[68:71]
    s_add_u32 m0, s29, 49152
    v_mfma_f32_16x16x32_bf16 v[76:79], v[128:131], v[236:239], v[76:79]
    s_waitcnt vmcnt(12) lgkmcnt(2)
    s_barrier
    v_mfma_f32_16x16x32_bf16 v[84:87], v[132:135], v[236:239], v[84:87]
    s_add_u32 s44, s28, 49152
    ds_read_b128 v[224:227], v8 offset:4096
    ds_read_b128 v[228:231], v8 offset:24576
    v_mfma_f32_16x16x32_bf16 v[64:67], v[136:139], v[240:243], v[64:67]
    buffer_load_dwordx4 v8, s[64:67], s44 offen sc1 lds
    v_mfma_f32_16x16x32_bf16 v[72:75], v[140:143], v[240:243], v[72:75]
    buffer_load_dwordx4 v8, s[64:67], s44 offen offset:1024 sc1 lds
    v_mfma_f32_16x16x32_bf16 v[80:83], v[176:179], v[240:243], v[80:83]
    v_mfma_f32_16x16x32_bf16 v[68:71], v[136:139], v[244:247], v[68:71]
    v_mfma_f32_16x16x32_bf16 v[76:79], v[140:143], v[244:247], v[76:79]
    v_mfma_f32_16x16x32_bf16 v[84:87], v[176:179], v[244:247], v[84:87]
    s_waitcnt lgkmcnt(2)
    ds_read_b128 v[232:235], v8 offset:5120
    ds_read_b128 v[236:239], v8 offset:25600
    v_mfma_f32_16x16x32_bf16 v[64:67], v[180:183], v[248:251], v[64:67]
    v_mfma_f32_16x16x32_bf16 v[72:75], v[184:187], v[248:251], v[72:75]
    s_add_u32 m0, s29, 53248
    v_mfma_f32_16x16x32_bf16 v[80:83], v[188:191], v[248:251], v[80:83]
    s_add_u32 s44, s28, 53248
    v_mfma_f32_16x16x32_bf16 v[68:71], v[180:183], v[252:255], v[68:71]
    buffer_load_dwordx4 v8, s[64:67], s44 offen sc1 lds
    v_mfma_f32_16x16x32_bf16 v[76:79], v[184:187], v[252:255], v[76:79]
    buffer_load_dwordx4 v8, s[64:67], s44 offen offset:1024 sc1 lds
    v_mfma_f32_16x16x32_bf16 v[84:87], v[188:191], v[252:255], v[84:87]
    s_waitcnt lgkmcnt(2)
    ds_read_b128 v[240:243], v8 offset:6144
    ds_read_b128 v[244:247], v8 offset:26624
    v_mfma_f32_16x16x32_bf16 v[64:67], a[252:255], v[224:227], v[64:67]
    v_mfma_f32_16x16x32_bf16 v[72:75], a[0:3], v[224:227], v[72:75]
    v_mfma_f32_16x16x32_bf16 v[80:83], a[16:19], v[224:227], v[80:83]
    v_mfma_f32_16x16x32_bf16 v[68:71], a[252:255], v[228:231], v[68:71]
    v_mfma_f32_16x16x32_bf16 v[76:79], a[0:3], v[228:231], v[76:79]
    s_add_u32 m0, s29, 57344
    v_mfma_f32_16x16x32_bf16 v[84:87], a[16:19], v[228:231], v[84:87]
    s_waitcnt lgkmcnt(2)
    ds_read_b128 v[248:251], v8 offset:7168
    ds_read_b128 v[252:255], v8 offset:27648
    v_mfma_f32_16x16x32_bf16 v[64:67], a[32:35], v[232:235], v[64:67]
    s_add_u32 s44, s28, 57344
    v_mfma_f32_16x16x32_bf16 v[72:75], a[48:51], v[232:235], v[72:75]
    buffer_load_dwordx4 v8, s[64:67], s44 offen sc1 lds
    v_mfma_f32_16x16x32_bf16 v[80:83], a[64:67], v[232:235], v[80:83]
    buffer_load_dwordx4 v8, s[64:67], s44 offen offset:1024 sc1 lds
    v_mfma_f32_16x16x32_bf16 v[68:71], a[32:35], v[236:239], v[68:71]
    v_mfma_f32_16x16x32_bf16 v[76:79], a[48:51], v[236:239], v[76:79]
    s_waitcnt vmcnt(16) lgkmcnt(2)
    s_barrier
    v_mfma_f32_16x16x32_bf16 v[84:87], a[64:67], v[236:239], v[84:87]
    ds_read_b128 v[224:227], v8 offset:8192
    ds_read_b128 v[228:231], v8 offset:28672
    v_mfma_f32_16x16x32_bf16 v[64:67], a[4:7], v[240:243], v[64:67]
    v_mfma_f32_16x16x32_bf16 v[72:75], a[20:23], v[240:243], v[72:75]
    v_mfma_f32_16x16x32_bf16 v[80:83], a[36:39], v[240:243], v[80:83]
    v_mfma_f32_16x16x32_bf16 v[68:71], a[4:7], v[244:247], v[68:71]
    s_sub_u32 m0, s30, 1024
    v_mfma_f32_16x16x32_bf16 v[76:79], a[20:23], v[244:247], v[76:79]
    buffer_load_dwordx4 v12, s[64:67], s94 offen offset:1024 lds
    v_mfma_f32_16x16x32_bf16 v[84:87], a[36:39], v[244:247], v[84:87]
    s_waitcnt lgkmcnt(2)
    ds_read_b128 v[232:235], v8 offset:9216
    ds_read_b128 v[236:239], v8 offset:29696
    v_mfma_f32_16x16x32_bf16 v[64:67], a[52:55], v[248:251], v[64:67]
    v_mfma_f32_16x16x32_bf16 v[72:75], a[68:71], v[248:251], v[72:75]
    v_mfma_f32_16x16x32_bf16 v[80:83], a[8:11], v[248:251], v[80:83]
    s_add_u32 m0, s30, 0
    v_mfma_f32_16x16x32_bf16 v[68:71], a[52:55], v[252:255], v[68:71]
    buffer_load_dwordx4 v13, s[64:67], s94 offen offset:1024 lds
    v_mfma_f32_16x16x32_bf16 v[76:79], a[68:71], v[252:255], v[76:79]
    v_mfma_f32_16x16x32_bf16 v[84:87], a[8:11], v[252:255], v[84:87]
    s_waitcnt lgkmcnt(2)
    ds_read_b128 v[240:243], v8 offset:10240
    ds_read_b128 v[244:247], v8 offset:30720
    v_mfma_f32_16x16x32_bf16 v[64:67], a[24:27], v[224:227], v[64:67]
    v_mfma_f32_16x16x32_bf16 v[72:75], a[40:43], v[224:227], v[72:75]
    s_add_u32 m0, s30, 1024
    v_mfma_f32_16x16x32_bf16 v[80:83], a[56:59], v[224:227], v[80:83]
    buffer_load_dwordx4 v14, s[64:67], s94 offen offset:1024 lds
    v_mfma_f32_16x16x32_bf16 v[68:71], a[24:27], v[228:231], v[68:71]
    v_mfma_f32_16x16x32_bf16 v[76:79], a[40:43], v[228:231], v[76:79]
    v_mfma_f32_16x16x32_bf16 v[84:87], a[56:59], v[228:231], v[84:87]
    s_waitcnt lgkmcnt(2)
    ds_read_b128 v[248:251], v8 offset:11264
    ds_read_b128 v[252:255], v8 offset:31744
    v_mfma_f32_16x16x32_bf16 v[64:67], a[72:75], v[232:235], v[64:67]
    s_add_u32 m0, s30, 2048
    s_waitcnt vmcnt(13)
    v_add_f32 v40, v40, v44
    v_mfma_f32_16x16x32_bf16 v[72:75], a[12:15], v[232:235], v[72:75]
    buffer_load_dwordx4 v8, s[64:67], s95 offen offset:1024 lds
    v_mfma_f32_16x16x32_bf16 v[80:83], a[28:31], v[232:235], v[80:83]
    v_add_f32 v41, v41, v45
    v_add_f32 v42, v42, v46
    v_mfma_f32_16x16x32_bf16 v[68:71], a[72:75], v[236:239], v[68:71]
    v_add_f32 v43, v43, v47
    v_mfma_f32_16x16x32_bf16 v[76:79], a[12:15], v[236:239], v[76:79]
    s_waitcnt vmcnt(18) lgkmcnt(2)
    s_barrier
    s_mov_b32 vcc_lo, 0xaaaaaaaa
    v_mfma_f32_16x16x32_bf16 v[84:87], a[28:31], v[236:239], v[84:87]
    s_add_u32 m0, s30, 3072
    ds_read_b128 v[224:227], v8 offset:12288
    ds_read_b128 v[228:231], v8 offset:32768
    v_mfma_f32_16x16x32_bf16 v[64:67], a[44:47], v[240:243], v[64:67]
    buffer_load_dwordx4 v11, s[64:67], s95 offen offset:1024 lds
    v_mfma_f32_16x16x32_bf16 v[72:75], a[60:63], v[240:243], v[72:75]
    s_mov_b32 vcc_hi, 0xaaaaaaaa
    v_add_f32_dpp v40, v40, v40 quad_perm:[1,0,3,2] row_mask:0xf bank_mask:0xf
    v_add_f32_dpp v41, v41, v41 quad_perm:[1,0,3,2] row_mask:0xf bank_mask:0xf
    v_mfma_f32_16x16x32_bf16 v[80:83], a[76:79], v[240:243], v[80:83]
    v_add_f32_dpp v42, v42, v42 quad_perm:[1,0,3,2] row_mask:0xf bank_mask:0xf
    v_add_f32_dpp v43, v43, v43 quad_perm:[1,0,3,2] row_mask:0xf bank_mask:0xf
    v_mfma_f32_16x16x32_bf16 v[68:71], a[44:47], v[244:247], v[68:71]
    s_add_u32 m0, s30, 4096
    v_add_f32_dpp v40, v40, v40 quad_perm:[2,3,0,1] row_mask:0xf bank_mask:0xf
    v_add_f32_dpp v41, v41, v41 quad_perm:[2,3,0,1] row_mask:0xf bank_mask:0xf
    v_mfma_f32_16x16x32_bf16 v[76:79], a[60:63], v[244:247], v[76:79]
    buffer_load_dwordx4 v12, s[64:67], s95 offen offset:1024 lds
    v_mfma_f32_16x16x32_bf16 v[84:87], a[76:79], v[244:247], v[84:87]
    s_waitcnt lgkmcnt(2)
    ds_read_b128 v[232:235], v8 offset:13312
    ds_read_b128 v[236:239], v8 offset:33792
    v_mfma_f32_16x16x32_bf16 v[64:67], a[80:83], v[248:251], v[64:67]
    v_add_f32_dpp v42, v42, v42 quad_perm:[2,3,0,1] row_mask:0xf bank_mask:0xf
    v_add_f32_dpp v43, v43, v43 quad_perm:[2,3,0,1] row_mask:0xf bank_mask:0xf
    v_mfma_f32_16x16x32_bf16 v[72:75], a[96:99], v[248:251], v[72:75]
    v_cndmask_b32 v40, v40, v42, vcc
    v_cndmask_b32 v41, v41, v43, vcc
    v_mfma_f32_16x16x32_bf16 v[80:83], a[112:115], v[248:251], v[80:83]
    s_add_u32 m0, s30, 5120
    v_mul_f32 v44, s17, v40
    v_mul_f32 v47, s17, v41
    v_mfma_f32_16x16x32_bf16 v[68:71], a[80:83], v[252:255], v[68:71]
    buffer_load_dwordx4 v13, s[64:67], s95 offen offset:1024 lds
    v_mfma_f32_16x16x32_bf16 v[76:79], a[96:99], v[252:255], v[76:79]
    v_fma_f32 v47, -v44, v44, v47
    v_max_f32 v47, 0, v47
    v_cvt_pk_bf16_f32 v44, v44, v44
    v_mfma_f32_16x16x32_bf16 v[84:87], a[112:115], v[252:255], v[84:87]
    s_waitcnt lgkmcnt(2)
    ds_read_b128 v[240:243], v8 offset:14336
    ds_read_b128 v[244:247], v8 offset:34816
    v_mfma_f32_16x16x32_bf16 v[64:67], a[128:131], v[224:227], v[64:67]
    s_add_u32 m0, s30, 6144
    v_lshlrev_b32 v44, 16, v44
    v_cvt_pk_bf16_f32 v47, v47, v47
    v_mfma_f32_16x16x32_bf16 v[72:75], a[144:147], v[224:227], v[72:75]
    buffer_load_dwordx4 v14, s[64:67], s95 offen offset:1024 lds
    v_mfma_f32_16x16x32_bf16 v[80:83], a[84:87], v[224:227], v[80:83]
    v_lshlrev_b32 v47, 16, v47
    v_add_f32 v47, s18, v47
    v_mfma_f32_16x16x32_bf16 v[68:71], a[128:131], v[228:231], v[68:71]
    v_cvt_pk_bf16_f32 v47, v47, v47
    v_lshlrev_b32 v47, 16, v47
    v_mfma_f32_16x16x32_bf16 v[76:79], a[144:147], v[228:231], v[76:79]
    v_sqrt_f32 v47, v47
    v_mfma_f32_16x16x32_bf16 v[84:87], a[84:87], v[228:231], v[84:87]
    s_waitcnt lgkmcnt(2)
    ds_read_b128 v[248:251], v8 offset:15360
    ds_read_b128 v[252:255], v8 offset:35840
    v_mfma_f32_16x16x32_bf16 v[64:67], a[100:103], v[232:235], v[64:67]
    s_add_u32 m0, s30, 6144
    v_cvt_pk_bf16_f32 v47, v47, v47
    v_lshlrev_b32 v47, 16, v47
    v_mfma_f32_16x16x32_bf16 v[72:75], a[116:119], v[232:235], v[72:75]
    buffer_load_dwordx4 v8, s[64:67], s92 offen offset:2048 lds
    v_mfma_f32_16x16x32_bf16 v[80:83], a[132:135], v[232:235], v[80:83]
    v_rcp_f32 v48, v47
    v_mfma_f32_16x16x32_bf16 v[68:71], a[100:103], v[236:239], v[68:71]
    v_mul_f32 v45, s63, v48
    v_mul_f32 v46, v48, v48
    v_mfma_f32_16x16x32_bf16 v[76:79], a[116:119], v[236:239], v[76:79]
    s_waitcnt vmcnt(21) lgkmcnt(2)
    s_barrier
    v_mul_f32 v48, s62, v48
    v_mfma_f32_16x16x32_bf16 v[84:87], a[132:135], v[236:239], v[84:87]
    s_add_u32 m0, s30, 7168
    ds_read_b128 v[224:227], v8 offset:16384
    ds_read_b128 v[228:231], v8 offset:36864
    v_mfma_f32_16x16x32_bf16 v[64:67], a[148:151], v[240:243], v[64:67]
    buffer_load_dwordx4 v11, s[64:67], s92 offen offset:2048 lds
    v_mfma_f32_16x16x32_bf16 v[72:75], a[88:91], v[240:243], v[72:75]
    v_mul_f32 v47, v47, v47
    v_mul_f32 v46, v46, v48
    v_mfma_f32_16x16x32_bf16 v[80:83], v[144:147], v[240:243], v[80:83]
    ds_write_b128 v57, v[44:47]
    v_mfma_f32_16x16x32_bf16 v[68:71], a[148:151], v[244:247], v[68:71]
    s_add_u32 m0, s30, 8192
    v_subrev_u32 v62, 40, v1
    v_min_u32 v62, v62, v1
    v_mul_u32_u24 v63, 26, v62
    v_mfma_f32_16x16x32_bf16 v[76:79], a[88:91], v[244:247], v[76:79]
    buffer_load_dwordx4 v12, s[64:67], s92 offen offset:2048 lds
    v_mfma_f32_16x16x32_bf16 v[84:87], v[144:147], v[244:247], v[84:87]
    s_waitcnt lgkmcnt(3)
    ds_read_b128 v[232:235], v8 offset:17408
    ds_read_b128 v[236:239], v8 offset:37888
    v_mfma_f32_16x16x32_bf16 v[64:67], v[148:151], v[248:251], v[64:67]
    v_lshrrev_b32 v63, 8, v63
    v_mul_u32_u24 v56, 10, v63
    v_mfma_f32_16x16x32_bf16 v[72:75], v[152:155], v[248:251], v[72:75]
    s_add_u32 m0, s30, 9216
    v_sub_u32 v62, v62, v56
    v_mfma_f32_16x16x32_bf16 v[80:83], v[156:159], v[248:251], v[80:83]
    buffer_load_dwordx4 v13, s[64:67], s92 offen offset:2048 lds
    v_mfma_f32_16x16x32_bf16 v[68:71], v[148:151], v[252:255], v[68:71]
    s_lshl_b32 s22, s16, 2
    v_add_u32 v63, s22, v63
    v_lshlrev_b32 v58, 4, v63
    v_mfma_f32_16x16x32_bf16 v[76:79], v[152:155], v[252:255], v[76:79]
    v_mul_u32_u24 v57, 576, v62
    v_add_u32 v57, v57, v58
    v_mfma_f32_16x16x32_bf16 v[84:87], v[156:159], v[252:255], v[84:87]
    s_waitcnt lgkmcnt(3)
    ds_read_b128 v[240:243], v8 offset:18432
    ds_read_b128 v[244:247], v8 offset:38912
    v_mfma_f32_16x16x32_bf16 v[64:67], v[160:163], v[224:227], v[64:67]
    s_add_u32 m0, s30, 10240
    v_lshl_add_u32 v58, v62, 8, v58
    v_mul_u32_u24 v59, 1280, v63
    v_mfma_f32_16x16x32_bf16 v[72:75], v[164:167], v[224:227], v[72:75]
    buffer_load_dwordx4 v14, s[64:67], s92 offen offset:2048 lds
    v_mfma_f32_16x16x32_bf16 v[80:83], v[168:171], v[224:227], v[80:83]
    v_lshl_add_u32 v59, v62, 4, v59
    v_mfma_f32_16x16x32_bf16 v[68:71], v[160:163], v[228:231], v[68:71]
    s_mul_i32 s22, s16, 5760
    v_mul_u32_u24 v56, 288, v3
    v_lshl_add_u32 v56, v2, 4, v56
    v_mfma_f32_16x16x32_bf16 v[76:79], v[164:167], v[228:231], v[76:79]
    v_add_u32 v56, s22, v56
    v_mfma_f32_16x16x32_bf16 v[84:87], v[168:171], v[228:231], v[84:87]
    s_waitcnt lgkmcnt(2)
    ds_read_b128 v[248:251], v8 offset:19456
    ds_read_b128 v[252:255], v8 offset:39936
    v_mfma_f32_16x16x32_bf16 v[64:67], v[172:175], v[232:235], v[64:67]
    s_add_u32 m0, s30, 11264
    s_mul_i32 s46, s86, 20480
    s_mul_i32 s45, s87, 2560
    v_mfma_f32_16x16x32_bf16 v[72:75], v[192:195], v[232:235], v[72:75]
    buffer_load_dwordx4 v8, s[64:67], s93 offen offset:2048 lds
    v_mfma_f32_16x16x32_bf16 v[80:83], v[196:199], v[232:235], v[80:83]
    s_add_u32 s45, s45, s46
    s_add_u32 s45, s45, s74
    s_mul_i32 s22, s87, 160
    s_add_u32 s46, s46, s22
    v_mfma_f32_16x16x32_bf16 v[68:71], v[172:175], v[236:239], v[68:71]
    v_mfma_f32_16x16x32_bf16 v[76:79], v[192:195], v[236:239], v[76:79]
    s_waitcnt vmcnt(14) lgkmcnt(0)
    s_barrier
    v_mfma_f32_16x16x32_bf16 v[84:87], v[196:199], v[236:239], v[84:87]
    s_add_u32 m0, s30, 12288
    ds_read_b128 v[224:227], v10 offset:0
    ds_read_b128 v[228:231], v10 offset:20480
    v_mfma_f32_16x16x32_bf16 v[64:67], v[200:203], v[240:243], v[64:67]
    buffer_load_dwordx4 v11, s[64:67], s93 offen offset:2048 lds
    v_mfma_f32_16x16x32_bf16 v[72:75], v[204:207], v[240:243], v[72:75]
    s_add_u32 m0, s29, 0
    ds_read_b128 v[48:51], v60 offset:0
    ds_read_b128 v[52:55], v60 offset:256
    v_mfma_f32_16x16x32_bf16 v[80:83], v[208:211], v[240:243], v[80:83]
    s_add_u32 s44, s28, 81920
    v_mfma_f32_16x16x32_bf16 v[68:71], v[200:203], v[244:247], v[68:71]
    buffer_load_dwordx4 v8, s[64:67], s44 offen sc1 lds
    v_mfma_f32_16x16x32_bf16 v[76:79], v[204:207], v[244:247], v[76:79]
    buffer_load_dwordx4 v8, s[64:67], s44 offen offset:1024 sc1 lds
    v_mfma_f32_16x16x32_bf16 v[84:87], v[208:211], v[244:247], v[84:87]
    s_waitcnt lgkmcnt(4)
    ds_read_b128 v[232:235], v10 offset:1024
    ds_read_b128 v[236:239], v10 offset:21504
    v_mfma_f32_16x16x32_bf16 v[64:67], v[212:215], v[248:251], v[64:67]
    v_mfma_f32_16x16x32_bf16 v[72:75], v[216:219], v[248:251], v[72:75]
    v_mfma_f32_16x16x32_bf16 v[80:83], v[220:223], v[248:251], v[80:83]
    v_mfma_f32_16x16x32_bf16 v[68:71], v[212:215], v[252:255], v[68:71]
    v_mfma_f32_16x16x32_bf16 v[76:79], v[216:219], v[252:255], v[76:79]
    v_mfma_f32_16x16x32_bf16 v[84:87], v[220:223], v[252:255], v[84:87]
    s_waitcnt lgkmcnt(4)
    ds_read_b128 v[240:243], v10 offset:2048
    ds_read_b128 v[244:247], v10 offset:22528
    v_mfma_f32_16x16x32_bf16 v[88:91], v[112:115], v[224:227], 0
    s_add_u32 m0, s29, 4096
    v_mfma_f32_16x16x32_bf16 v[96:99], v[116:119], v[224:227], 0
    s_add_u32 s44, s28, 86016
    v_mfma_f32_16x16x32_bf16 v[104:107], v[120:123], v[224:227], 0
    buffer_load_dwordx4 v8, s[64:67], s44 offen sc1 lds
    v_mfma_f32_16x16x32_bf16 v[92:95], v[112:115], v[228:231], 0
    buffer_load_dwordx4 v8, s[64:67], s44 offen offset:1024 sc1 lds
    v_mfma_f32_16x16x32_bf16 v[100:103], v[116:119], v[228:231], 0
    s_waitcnt lgkmcnt(4)
    v_fma_f32 v64, -v48, v20, v64
    v_fma_f32 v68, -v52, v20, v68
    v_fma_f32 v65, -v48, v21, v65
    v_mfma_f32_16x16x32_bf16 v[108:111], v[120:123], v[228:231], 0
    s_waitcnt lgkmcnt(2)
    ds_read_b128 v[248:251], v10 offset:3072
    ds_read_b128 v[252:255], v10 offset:23552
    v_mfma_f32_16x16x32_bf16 v[88:91], v[124:127], v[232:235], v[88:91]
    v_fma_f32 v69, -v52, v21, v69
    v_fma_f32 v66, -v48, v22, v66
    v_mfma_f32_16x16x32_bf16 v[96:99], v[128:131], v[232:235], v[96:99]
    v_fma_f32 v70, -v52, v22, v70
    v_fma_f32 v67, -v48, v23, v67
    v_fma_f32 v71, -v52, v23, v71
    v_mfma_f32_16x16x32_bf16 v[104:107], v[132:135], v[232:235], v[104:107]
    s_add_u32 m0, s29, 8192
    v_cmp_u_f32 s[82:83], v66, v70
    v_mul_f32 v32, v64, v64
    v_mfma_f32_16x16x32_bf16 v[92:95], v[124:127], v[236:239], v[92:95]
    s_add_u32 s44, s28, 90112
    v_mul_f32 v34, v68, v68
    v_mul_f32 v33, v65, v65
    v_mfma_f32_16x16x32_bf16 v[100:103], v[128:131], v[236:239], v[100:103]
    buffer_load_dwordx4 v8, s[64:67], s44 offen sc1 lds
    v_mul_f32 v35, v69, v69
    v_mfma_f32_16x16x32_bf16 v[108:111], v[132:135], v[236:239], v[108:111]
    s_waitcnt lgkmcnt(2)
    ds_read_b128 v[224:227], v10 offset:4096
    ds_read_b128 v[228:231], v10 offset:24576
    v_mfma_f32_16x16x32_bf16 v[88:91], v[136:139], v[240:243], v[88:91]
    buffer_load_dwordx4 v8, s[64:67], s44 offen offset:1024 sc1 lds
    v_mfma_f32_16x16x32_bf16 v[96:99], v[140:143], v[240:243], v[96:99]
    v_fma_f32 v32, v32, v50, v49
    v_fma_f32 v34, v34, v54, v53
    v_mfma_f32_16x16x32_bf16 v[104:107], v[176:179], v[240:243], v[104:107]
    v_fma_f32 v33, v33, v50, v49
    v_fma_f32 v35, v35, v54, v53
    v_mul_f32 v32, v32, v64
    v_mfma_f32_16x16x32_bf16 v[92:95], v[136:139], v[244:247], v[92:95]
    v_mul_f32 v34, v34, v68
    v_mul_f32 v33, v33, v65
    v_mfma_f32_16x16x32_bf16 v[100:103], v[140:143], v[244:247], v[100:103]
    v_mul_f32 v35, v35, v69
    v_mfma_f32_16x16x32_bf16 v[108:111], v[176:179], v[244:247], v[108:111]
    s_waitcnt lgkmcnt(2)
    ds_read_b128 v[232:235], v10 offset:5120
    ds_read_b128 v[236:239], v10 offset:25600
    v_mfma_f32_16x16x32_bf16 v[88:91], v[180:183], v[248:251], v[88:91]
    s_add_u32 m0, s29, 12288
    s_and_b64 s[82:83], s[82:83], s[84:85]
    s_cselect_b32 s43, 27262976, s43
    v_mfma_f32_16x16x32_bf16 v[96:99], v[184:187], v[248:251], v[96:99]
    s_add_u32 s44, s28, 94208
    v_exp_f32 v32, v32
    v_mfma_f32_16x16x32_bf16 v[104:107], v[188:191], v[248:251], v[104:107]
    buffer_load_dwordx4 v8, s[64:67], s44 offen sc1 lds
    v_mfma_f32_16x16x32_bf16 v[92:95], v[180:183], v[252:255], v[92:95]
    buffer_load_dwordx4 v8, s[64:67], s44 offen offset:1024 sc1 lds
    v_exp_f32 v34, v34
    v_mfma_f32_16x16x32_bf16 v[100:103], v[184:187], v[252:255], v[100:103]
    v_exp_f32 v33, v33
    v_mfma_f32_16x16x32_bf16 v[108:111], v[188:191], v[252:255], v[108:111]
    s_waitcnt lgkmcnt(2)
    ds_read_b128 v[240:243], v10 offset:6144
    ds_read_b128 v[244:247], v10 offset:26624
    v_mfma_f32_16x16x32_bf16 v[88:91], a[252:255], v[224:227], v[88:91]
    v_exp_f32 v35, v35
    v_mul_f32 v64, v64, v66
    v_mfma_f32_16x16x32_bf16 v[96:99], a[0:3], v[224:227], v[96:99]
    v_mul_f32 v68, v68, v70
    v_mul_f32 v65, v65, v67
    v_mfma_f32_16x16x32_bf16 v[104:107], a[16:19], v[224:227], v[104:107]
    v_mul_f32 v69, v69, v71
    v_fma_f32 v32, v32, v51, v51
    v_mfma_f32_16x16x32_bf16 v[92:95], a[252:255], v[228:231], v[92:95]
    v_fma_f32 v34, v34, v55, v55
    v_fma_f32 v33, v33, v51, v51
    v_mfma_f32_16x16x32_bf16 v[100:103], a[0:3], v[228:231], v[100:103]
    s_add_u32 m0, s29, 16384
    v_fma_f32 v35, v35, v55, v55
    v_rcp_f32 v32, v32
    v_mfma_f32_16x16x32_bf16 v[108:111], a[16:19], v[228:231], v[108:111]
    s_waitcnt lgkmcnt(2)
    ds_read_b128 v[248:251], v10 offset:7168
    ds_read_b128 v[252:255], v10 offset:27648
    v_mfma_f32_16x16x32_bf16 v[88:91], a[32:35], v[232:235], v[88:91]
    s_add_u32 s44, s28, 98304
    v_rcp_f32 v34, v34
    v_mfma_f32_16x16x32_bf16 v[96:99], a[48:51], v[232:235], v[96:99]
    buffer_load_dwordx4 v8, s[64:67], s44 offen sc1 lds
    v_mfma_f32_16x16x32_bf16 v[104:107], a[64:67], v[232:235], v[104:107]
    buffer_load_dwordx4 v8, s[64:67], s44 offen offset:1024 sc1 lds
    v_mfma_f32_16x16x32_bf16 v[92:95], a[32:35], v[236:239], v[92:95]
    v_rcp_f32 v33, v33
    v_mfma_f32_16x16x32_bf16 v[100:103], a[48:51], v[236:239], v[100:103]
    s_add_u32 s42, s43, 0
    v_rcp_f32 v35, v35
    v_mul_f32 v32, v32, v64
    v_mfma_f32_16x16x32_bf16 v[108:111], a[64:67], v[236:239], v[108:111]
    s_waitcnt lgkmcnt(2)
    ds_read_b128 v[224:227], v10 offset:8192
    ds_read_b128 v[228:231], v10 offset:28672
    v_mul_f32 v34, v34, v68
    v_mfma_f32_16x16x32_bf16 v[88:91], a[4:7], v[240:243], v[88:91]
    v_mul_f32 v33, v33, v65
    v_mul_f32 v35, v35, v69
    v_mfma_f32_16x16x32_bf16 v[96:99], a[20:23], v[240:243], v[96:99]
    v_cvt_pk_bf16_f32 v40, v32, v33
    v_cvt_pk_bf16_f32 v41, v34, v35
    v_mfma_f32_16x16x32_bf16 v[104:107], a[36:39], v[240:243], v[104:107]
    s_add_u32 m0, s30, 13312
    v_fma_f32 v72, -v48, v24, v72
    v_fma_f32 v76, -v52, v24, v76
    v_mfma_f32_16x16x32_bf16 v[92:95], a[4:7], v[244:247], v[92:95]
    buffer_load_dwordx4 v12, s[64:67], s93 offen offset:2048 lds
    v_mfma_f32_16x16x32_bf16 v[100:103], a[20:23], v[244:247], v[100:103]
    v_permlane16_swap_b32 v40, v41
    v_fma_f32 v73, -v48, v25, v73
    v_mfma_f32_16x16x32_bf16 v[108:111], a[36:39], v[244:247], v[108:111]
    s_waitcnt lgkmcnt(2)
    ds_read_b128 v[232:235], v10 offset:9216
    ds_read_b128 v[236:239], v10 offset:29696
    v_mfma_f32_16x16x32_bf16 v[88:91], a[52:55], v[248:251], v[88:91]
    v_fma_f32 v77, -v52, v25, v77
    v_mfma_f32_16x16x32_bf16 v[96:99], a[68:71], v[248:251], v[96:99]
    buffer_store_dwordx2 v[40:41], v9, s[64:67], s42 offen sc1
    v_fma_f32 v74, -v48, v26, v74
    v_mfma_f32_16x16x32_bf16 v[104:107], a[8:11], v[248:251], v[104:107]
    s_add_u32 m0, s30, 14336
    v_fma_f32 v78, -v52, v26, v78
    v_fma_f32 v75, -v48, v27, v75
    v_mfma_f32_16x16x32_bf16 v[92:95], a[52:55], v[252:255], v[92:95]
    buffer_load_dwordx4 v13, s[64:67], s93 offen offset:2048 lds
    v_mfma_f32_16x16x32_bf16 v[100:103], a[68:71], v[252:255], v[100:103]
    v_fma_f32 v79, -v52, v27, v79
    v_mul_f32 v36, v72, v72
    v_mul_f32 v38, v76, v76
    v_mfma_f32_16x16x32_bf16 v[108:111], a[8:11], v[252:255], v[108:111]
    s_waitcnt lgkmcnt(2)
    ds_read_b128 v[240:243], v10 offset:10240
    ds_read_b128 v[244:247], v10 offset:30720
    v_mfma_f32_16x16x32_bf16 v[88:91], a[24:27], v[224:227], v[88:91]
    s_add_u32 m0, s30, 15360
    v_mul_f32 v37, v73, v73
    v_mul_f32 v39, v77, v77
    v_mfma_f32_16x16x32_bf16 v[96:99], a[40:43], v[224:227], v[96:99]
    buffer_load_dwordx4 v14, s[64:67], s93 offen offset:2048 lds
    v_fma_f32 v36, v36, v50, v49
    v_mfma_f32_16x16x32_bf16 v[104:107], a[56:59], v[224:227], v[104:107]
    v_fma_f32 v38, v38, v54, v53
    v_fma_f32 v37, v37, v50, v49
    v_mfma_f32_16x16x32_bf16 v[92:95], a[24:27], v[228:231], v[92:95]
    v_fma_f32 v39, v39, v54, v53
    v_mul_f32 v36, v36, v72
    v_mfma_f32_16x16x32_bf16 v[100:103], a[40:43], v[228:231], v[100:103]
    s_add_u32 m0, s30, 16384
    v_mul_f32 v38, v38, v76
    v_mul_f32 v37, v37, v73
    v_mfma_f32_16x16x32_bf16 v[108:111], a[56:59], v[228:231], v[108:111]
    s_waitcnt lgkmcnt(2)
    ds_read_b128 v[248:251], v10 offset:11264
    ds_read_b128 v[252:255], v10 offset:31744
    v_mul_f32 v39, v39, v77
    v_mfma_f32_16x16x32_bf16 v[88:91], a[72:75], v[232:235], v[88:91]
    buffer_load_dwordx4 v8, s[64:67], s94 offen offset:2048 lds
    v_mfma_f32_16x16x32_bf16 v[96:99], a[12:15], v[232:235], v[96:99]
    v_exp_f32 v36, v36
    v_mfma_f32_16x16x32_bf16 v[104:107], a[28:31], v[232:235], v[104:107]
    v_exp_f32 v38, v38
    v_mfma_f32_16x16x32_bf16 v[92:95], a[72:75], v[236:239], v[92:95]
    v_exp_f32 v37, v37
    v_mfma_f32_16x16x32_bf16 v[100:103], a[12:15], v[236:239], v[100:103]
    buffer_load_dwordx4 a[104:107], v8, s[64:67], s92 offen offset:0
    v_mfma_f32_16x16x32_bf16 v[108:111], a[28:31], v[236:239], v[108:111]
    s_waitcnt lgkmcnt(2)
    ds_read_b128 v[224:227], v10 offset:12288
    ds_read_b128 v[228:231], v10 offset:32768
    v_mfma_f32_16x16x32_bf16 v[88:91], a[44:47], v[240:243], v[88:91]
    v_exp_f32 v39, v39
    v_mul_f32 v72, v72, v74
    v_mul_f32 v76, v76, v78
    v_mfma_f32_16x16x32_bf16 v[96:99], a[60:63], v[240:243], v[96:99]
    v_mul_f32 v73, v73, v75
    v_mul_f32 v77, v77, v79
    v_mfma_f32_16x16x32_bf16 v[104:107], a[76:79], v[240:243], v[104:107]
    v_fma_f32 v36, v36, v51, v51
    v_fma_f32 v38, v38, v55, v55
    v_mfma_f32_16x16x32_bf16 v[92:95], a[44:47], v[244:247], v[92:95]
    buffer_load_dwordx4 a[120:123], v11, s[64:67], s92 offen offset:0
    v_mfma_f32_16x16x32_bf16 v[100:103], a[60:63], v[244:247], v[100:103]
    v_fma_f32 v37, v37, v51, v51
    v_fma_f32 v39, v39, v55, v55
    v_mfma_f32_16x16x32_bf16 v[108:111], a[76:79], v[244:247], v[108:111]
    s_waitcnt lgkmcnt(2)
    ds_read_b128 v[232:235], v10 offset:13312
    ds_read_b128 v[236:239], v10 offset:33792
    v_mfma_f32_16x16x32_bf16 v[88:91], a[80:83], v[248:251], v[88:91]
    v_rcp_f32 v36, v36
    v_mfma_f32_16x16x32_bf16 v[96:99], a[96:99], v[248:251], v[96:99]
    v_rcp_f32 v38, v38
    v_rcp_f32 v37, v37
    v_mfma_f32_16x16x32_bf16 v[104:107], a[112:115], v[248:251], v[104:107]
    buffer_load_dwordx4 a[136:139], v12, s[64:67], s92 offen offset:0
    v_mfma_f32_16x16x32_bf16 v[92:95], a[80:83], v[252:255], v[92:95]
    s_add_u32 s42, s43, 1024
    v_rcp_f32 v39, v39
    v_mfma_f32_16x16x32_bf16 v[100:103], a[96:99], v[252:255], v[100:103]
    v_mul_f32 v36, v36, v72
    v_mul_f32 v38, v38, v76
    v_mfma_f32_16x16x32_bf16 v[108:111], a[112:115], v[252:255], v[108:111]
    s_waitcnt lgkmcnt(2)
    ds_read_b128 v[240:243], v10 offset:14336
    ds_read_b128 v[244:247], v10 offset:34816
    v_mul_f32 v37, v37, v73
    v_mfma_f32_16x16x32_bf16 v[88:91], a[128:131], v[224:227], v[88:91]
    buffer_load_dwordx4 a[152:155], v13, s[64:67], s92 offen offset:0
    v_mfma_f32_16x16x32_bf16 v[96:99], a[144:147], v[224:227], v[96:99]
    v_mul_f32 v39, v39, v77
    v_cvt_pk_bf16_f32 v42, v36, v37
    v_mfma_f32_16x16x32_bf16 v[104:107], a[84:87], v[224:227], v[104:107]
    v_cvt_pk_bf16_f32 v43, v38, v39
    v_fma_f32 v80, -v48, v28, v80
    v_fma_f32 v84, -v52, v28, v84
    v_mfma_f32_16x16x32_bf16 v[92:95], a[128:131], v[228:231], v[92:95]
    v_permlane16_swap_b32 v42, v43
    v_mfma_f32_16x16x32_bf16 v[100:103], a[144:147], v[228:231], v[100:103]
    v_fma_f32 v81, -v48, v29, v81
    v_fma_f32 v85, -v52, v29, v85
    v_mfma_f32_16x16x32_bf16 v[108:111], a[84:87], v[228:231], v[108:111]
    s_waitcnt lgkmcnt(2)
    ds_read_b128 v[248:251], v10 offset:15360
    ds_read_b128 v[252:255], v10 offset:35840
    v_mfma_f32_16x16x32_bf16 v[88:91], a[100:103], v[232:235], v[88:91]
    buffer_load_dwordx4 a[92:95], v14, s[64:67], s92 offen offset:0
    v_mfma_f32_16x16x32_bf16 v[96:99], a[116:119], v[232:235], v[96:99]
    buffer_store_dwordx2 v[42:43], v9, s[64:67], s42 offen sc1
    v_fma_f32 v82, -v48, v30, v82
    v_mfma_f32_16x16x32_bf16 v[104:107], a[132:135], v[232:235], v[104:107]
    v_fma_f32 v86, -v52, v30, v86
    v_fma_f32 v83, -v48, v31, v83
    v_mfma_f32_16x16x32_bf16 v[92:95], a[100:103], v[236:239], v[92:95]
    v_fma_f32 v87, -v52, v31, v87
    v_mul_f32 v32, v80, v80
    v_mfma_f32_16x16x32_bf16 v[100:103], a[116:119], v[236:239], v[100:103]
    buffer_load_dwordx4 a[108:111], v8, s[64:67], s93 offen offset:0
    v_mul_f32 v34, v84, v84
    v_mfma_f32_16x16x32_bf16 v[108:111], a[132:135], v[236:239], v[108:111]
    s_waitcnt lgkmcnt(2)
    ds_read_b128 v[224:227], v10 offset:16384
    ds_read_b128 v[228:231], v10 offset:36864
    v_mfma_f32_16x16x32_bf16 v[88:91], a[148:151], v[240:243], v[88:91]
    v_mul_f32 v33, v81, v81
    v_mul_f32 v35, v85, v85
    v_mfma_f32_16x16x32_bf16 v[96:99], a[88:91], v[240:243], v[96:99]
    v_fma_f32 v32, v32, v50, v49
    v_fma_f32 v34, v34, v54, v53
    v_fma_f32 v33, v33, v50, v49
    v_mfma_f32_16x16x32_bf16 v[104:107], v[144:147], v[240:243], v[104:107]
    v_fma_f32 v35, v35, v54, v53
    v_mul_f32 v32, v32, v80
    v_mfma_f32_16x16x32_bf16 v[92:95], a[148:151], v[244:247], v[92:95]
    buffer_load_dwordx4 a[124:127], v11, s[64:67], s93 offen offset:0
    v_mfma_f32_16x16x32_bf16 v[100:103], a[88:91], v[244:247], v[100:103]
    v_mul_f32 v34, v34, v84
    v_mul_f32 v33, v33, v81
    v_mfma_f32_16x16x32_bf16 v[108:111], v[144:147], v[244:247], v[108:111]
    s_waitcnt lgkmcnt(2)
    ds_read_b128 v[232:235], v10 offset:17408
    ds_read_b128 v[236:239], v10 offset:37888
    v_mul_f32 v35, v35, v85
    v_mfma_f32_16x16x32_bf16 v[88:91], v[148:151], v[248:251], v[88:91]
    v_exp_f32 v32, v32
    v_mfma_f32_16x16x32_bf16 v[96:99], v[152:155], v[248:251], v[96:99]
    buffer_load_dwordx4 a[140:143], v12, s[64:67], s93 offen offset:0
    v_mfma_f32_16x16x32_bf16 v[104:107], v[156:159], v[248:251], v[104:107]
    v_exp_f32 v34, v34
    v_mfma_f32_16x16x32_bf16 v[92:95], v[148:151], v[252:255], v[92:95]
    v_exp_f32 v33, v33
    v_mfma_f32_16x16x32_bf16 v[100:103], v[152:155], v[252:255], v[100:103]
    v_exp_f32 v35, v35
    v_mul_f32 v80, v80, v82
    v_mfma_f32_16x16x32_bf16 v[108:111], v[156:159], v[252:255], v[108:111]
    s_waitcnt lgkmcnt(2)
    ds_read_b128 v[240:243], v10 offset:18432
    ds_read_b128 v[244:247], v10 offset:38912
    v_mfma_f32_16x16x32_bf16 v[88:91], v[160:163], v[224:227], v[88:91]
    buffer_load_dwordx4 a[156:159], v13, s[64:67], s93 offen offset:0
    v_mul_f32 v84, v84, v86
    v_mfma_f32_16x16x32_bf16 v[96:99], v[164:167], v[224:227], v[96:99]
    v_mul_f32 v81, v81, v83
    v_mul_f32 v85, v85, v87
    v_mfma_f32_16x16x32_bf16 v[104:107], v[168:171], v[224:227], v[104:107]
    v_fma_f32 v32, v32, v51, v51
    v_fma_f32 v34, v34, v55, v55
    v_mfma_f32_16x16x32_bf16 v[92:95], v[160:163], v[228:231], v[92:95]
    v_fma_f32 v33, v33, v51, v51
    v_fma_f32 v35, v35, v55, v55
    v_mfma_f32_16x16x32_bf16 v[100:103], v[164:167], v[228:231], v[100:103]
    ds_read_b128 v[48:51], v60 offset:20480
    ds_read_b128 v[52:55], v60 offset:20736
    v_mfma_f32_16x16x32_bf16 v[108:111], v[168:171], v[228:231], v[108:111]
    s_waitcnt lgkmcnt(4)
    ds_read_b128 v[248:251], v10 offset:19456
    ds_read_b128 v[252:255], v10 offset:39936
    v_mfma_f32_16x16x32_bf16 v[88:91], v[172:175], v[232:235], v[88:91]
    buffer_load_dwordx4 a[160:163], v14, s[64:67], s93 offen offset:0
    v_mfma_f32_16x16x32_bf16 v[96:99], v[192:195], v[232:235], v[96:99]
    v_rcp_f32 v32, v32
    v_rcp_f32 v34, v34
    v_mfma_f32_16x16x32_bf16 v[104:107], v[196:199], v[232:235], v[104:107]
    v_rcp_f32 v33, v33
    v_mfma_f32_16x16x32_bf16 v[92:95], v[172:175], v[236:239], v[92:95]
    s_add_u32 s42, s43, 2048
    v_rcp_f32 v35, v35
    v_mfma_f32_16x16x32_bf16 v[100:103], v[192:195], v[236:239], v[100:103]
    s_waitcnt vmcnt(16) lgkmcnt(0)
    s_barrier
    v_mul_f32 v32, v32, v80
    v_mfma_f32_16x16x32_bf16 v[108:111], v[196:199], v[236:239], v[108:111]
    ds_read_b128 v[224:227], v8 offset:0
    ds_read_b128 v[228:231], v8 offset:20480
    v_mul_f32 v34, v34, v84
    v_mfma_f32_16x16x32_bf16 v[88:91], v[200:203], v[240:243], v[88:91]
    buffer_load_dwordx4 a[164:167], v8, s[64:67], s94 offen offset:0
    v_mfma_f32_16x16x32_bf16 v[96:99], v[204:207], v[240:243], v[96:99]
    s_add_u32 m0, s29, 40960
    v_mul_f32 v33, v33, v81
    v_mul_f32 v35, v35, v85
    v_mfma_f32_16x16x32_bf16 v[104:107], v[208:211], v[240:243], v[104:107]
    s_add_u32 s44, s28, 122880
    v_cvt_pk_bf16_f32 v40, v32, v33
    v_cvt_pk_bf16_f32 v41, v34, v35
    v_mfma_f32_16x16x32_bf16 v[92:95], v[200:203], v[244:247], v[92:95]
    buffer_load_dwordx4 v8, s[64:67], s44 offen sc1 lds
    v_mfma_f32_16x16x32_bf16 v[100:103], v[204:207], v[244:247], v[100:103]
    buffer_load_dwordx4 v8, s[64:67], s44 offen offset:1024 sc1 lds
    v_mfma_f32_16x16x32_bf16 v[108:111], v[208:211], v[244:247], v[108:111]
    s_waitcnt lgkmcnt(2)
    ds_read_b128 v[232:235], v8 offset:1024
    ds_read_b128 v[236:239], v8 offset:21504
    v_mfma_f32_16x16x32_bf16 v[88:91], v[212:215], v[248:251], v[88:91]
    v_permlane16_swap_b32 v40, v41
    v_mfma_f32_16x16x32_bf16 v[96:99], v[216:219], v[248:251], v[96:99]
    s_nop 0
    buffer_store_dwordx2 v[40:41], v9, s[64:67], s42 offen sc1
    v_mfma_f32_16x16x32_bf16 v[104:107], v[220:223], v[248:251], v[104:107]
    v_mfma_f32_16x16x32_bf16 v[92:95], v[212:215], v[252:255], v[92:95]
    v_mfma_f32_16x16x32_bf16 v[100:103], v[216:219], v[252:255], v[100:103]
    s_add_u32 m0, s29, 45056
    v_mfma_f32_16x16x32_bf16 v[108:111], v[220:223], v[252:255], v[108:111]
    s_waitcnt lgkmcnt(2)
    ds_read_b128 v[240:243], v8 offset:2048
    ds_read_b128 v[244:247], v8 offset:22528
    v_mfma_f32_16x16x32_bf16 v[64:67], v[112:115], v[224:227], 0
    s_add_u32 s44, s28, 126976
    v_mfma_f32_16x16x32_bf16 v[72:75], v[116:119], v[224:227], 0
    buffer_load_dwordx4 v8, s[64:67], s44 offen sc1 lds
    v_mfma_f32_16x16x32_bf16 v[80:83], v[120:123], v[224:227], 0
    buffer_load_dwordx4 v8, s[64:67], s44 offen offset:1024 sc1 lds
    v_mfma_f32_16x16x32_bf16 v[68:71], v[112:115], v[228:231], 0
    s_waitcnt lgkmcnt(8)
    v_fma_f32 v88, -v48, v20, v88
    v_fma_f32 v92, -v52, v20, v92
    v_mfma_f32_16x16x32_bf16 v[76:79], v[116:119], v[228:231], 0
    v_fma_f32 v89, -v48, v21, v89
    v_fma_f32 v93, -v52, v21, v93
    v_fma_f32 v90, -v48, v22, v90
    v_mfma_f32_16x16x32_bf16 v[84:87], v[120:123], v[228:231], 0
    s_waitcnt lgkmcnt(2)
    ds_read_b128 v[248:251], v8 offset:3072
    ds_read_b128 v[252:255], v8 offset:23552
    v_mfma_f32_16x16x32_bf16 v[64:67], v[124:127], v[232:235], v[64:67]
    v_fma_f32 v94, -v52, v22, v94
    v_fma_f32 v91, -v48, v23, v91
    v_mfma_f32_16x16x32_bf16 v[72:75], v[128:131], v[232:235], v[72:75]
    v_fma_f32 v95, -v52, v23, v95
    v_cmp_u_f32 s[82:83], v90, v94
    v_mfma_f32_16x16x32_bf16 v[80:83], v[132:135], v[232:235], v[80:83]
    s_add_u32 m0, s29, 49152
    v_mul_f32 v32, v88, v88
    v_mul_f32 v34, v92, v92
    v_mul_f32 v33, v89, v89
    v_mfma_f32_16x16x32_bf16 v[68:71], v[124:127], v[236:239], v[68:71]
    s_add_u32 s44, s28, 131072
    v_mul_f32 v35, v93, v93
    v_fma_f32 v32, v32, v50, v49
    v_mfma_f32_16x16x32_bf16 v[76:79], v[128:131], v[236:239], v[76:79]
    buffer_load_dwordx4 v8, s[64:67], s44 offen sc1 lds
    v_mfma_f32_16x16x32_bf16 v[84:87], v[132:135], v[236:239], v[84:87]
    s_waitcnt lgkmcnt(2)
    ds_read_b128 v[224:227], v8 offset:4096
    ds_read_b128 v[228:231], v8 offset:24576
    v_mfma_f32_16x16x32_bf16 v[64:67], v[136:139], v[240:243], v[64:67]
    buffer_load_dwordx4 v8, s[64:67], s44 offen offset:1024 sc1 lds
    v_fma_f32 v34, v34, v54, v53
    v_mfma_f32_16x16x32_bf16 v[72:75], v[140:143], v[240:243], v[72:75]
    v_fma_f32 v33, v33, v50, v49
    v_fma_f32 v35, v35, v54, v53
    v_mfma_f32_16x16x32_bf16 v[80:83], v[176:179], v[240:243], v[80:83]
    v_mul_f32 v32, v32, v88
    v_mul_f32 v34, v34, v92
    v_mfma_f32_16x16x32_bf16 v[68:71], v[136:139], v[244:247], v[68:71]
    v_mul_f32 v33, v33, v89
    v_mul_f32 v35, v35, v93
    v_mfma_f32_16x16x32_bf16 v[76:79], v[140:143], v[244:247], v[76:79]
    s_and_b64 s[82:83], s[82:83], s[84:85]
    s_cselect_b32 s43, 27262976, s43
    v_exp_f32 v32, v32
    v_mfma_f32_16x16x32_bf16 v[84:87], v[176:179], v[244:247], v[84:87]
    s_waitcnt lgkmcnt(2)
    ds_read_b128 v[232:235], v8 offset:5120
    ds_read_b128 v[236:239], v8 offset:25600
    v_mfma_f32_16x16x32_bf16 v[64:67], v[180:183], v[248:251], v[64:67]
    s_add_u32 m0, s29, 53248
    v_exp_f32 v34, v34
    v_mfma_f32_16x16x32_bf16 v[72:75], v[184:187], v[248:251], v[72:75]
    s_add_u32 s44, s28, 135168
    v_exp_f32 v33, v33
    v_mfma_f32_16x16x32_bf16 v[80:83], v[188:191], v[248:251], v[80:83]
    buffer_load_dwordx4 v8, s[64:67], s44 offen sc1 lds
    v_mfma_f32_16x16x32_bf16 v[68:71], v[180:183], v[252:255], v[68:71]
    buffer_load_dwordx4 v8, s[64:67], s44 offen offset:1024 sc1 lds
    v_mfma_f32_16x16x32_bf16 v[76:79], v[184:187], v[252:255], v[76:79]
    v_exp_f32 v35, v35
    v_mul_f32 v88, v88, v90
    v_mfma_f32_16x16x32_bf16 v[84:87], v[188:191], v[252:255], v[84:87]
    s_waitcnt lgkmcnt(2)
    ds_read_b128 v[240:243], v8 offset:6144
    ds_read_b128 v[244:247], v8 offset:26624
    v_mfma_f32_16x16x32_bf16 v[64:67], a[252:255], v[224:227], v[64:67]
    v_mul_f32 v92, v92, v94
    v_mul_f32 v89, v89, v91
    v_mul_f32 v93, v93, v95
    v_mfma_f32_16x16x32_bf16 v[72:75], a[0:3], v[224:227], v[72:75]
    v_fma_f32 v32, v32, v51, v51
    v_fma_f32 v34, v34, v55, v55
    v_mfma_f32_16x16x32_bf16 v[80:83], a[16:19], v[224:227], v[80:83]
    v_fma_f32 v33, v33, v51, v51
    v_fma_f32 v35, v35, v55, v55
    v_mfma_f32_16x16x32_bf16 v[68:71], a[252:255], v[228:231], v[68:71]
    s_add_u32 m0, s29, 57344
    v_rcp_f32 v32, v32
    v_mfma_f32_16x16x32_bf16 v[76:79], a[0:3], v[228:231], v[76:79]
    s_add_u32 s44, s28, 139264
    v_rcp_f32 v34, v34
    v_mfma_f32_16x16x32_bf16 v[84:87], a[16:19], v[228:231], v[84:87]
    s_waitcnt lgkmcnt(2)
    ds_read_b128 v[248:251], v8 offset:7168
    ds_read_b128 v[252:255], v8 offset:27648
    v_mfma_f32_16x16x32_bf16 v[64:67], a[32:35], v[232:235], v[64:67]
    buffer_load_dwordx4 v8, s[64:67], s44 offen sc1 lds
    v_mfma_f32_16x16x32_bf16 v[72:75], a[48:51], v[232:235], v[72:75]
    buffer_load_dwordx4 v8, s[64:67], s44 offen offset:1024 sc1 lds
    v_mfma_f32_16x16x32_bf16 v[80:83], a[64:67], v[232:235], v[80:83]
    v_rcp_f32 v33, v33
    v_mfma_f32_16x16x32_bf16 v[68:71], a[32:35], v[236:239], v[68:71]
    s_add_u32 s42, s43, 98304
    v_rcp_f32 v35, v35
    v_mul_f32 v32, v32, v88
    v_mul_f32 v34, v34, v92
    v_mfma_f32_16x16x32_bf16 v[76:79], a[48:51], v[236:239], v[76:79]
    v_mul_f32 v33, v33, v89
    v_mul_f32 v35, v35, v93
    v_mfma_f32_16x16x32_bf16 v[84:87], a[64:67], v[236:239], v[84:87]
    s_waitcnt lgkmcnt(2)
    ds_read_b128 v[224:227], v8 offset:8192
    ds_read_b128 v[228:231], v8 offset:28672
    v_mfma_f32_16x16x32_bf16 v[64:67], a[4:7], v[240:243], v[64:67]
    v_cvt_pk_bf16_f32 v40, v32, v33
    v_cvt_pk_bf16_f32 v41, v34, v35
    v_mfma_f32_16x16x32_bf16 v[72:75], a[20:23], v[240:243], v[72:75]
    v_fma_f32 v96, -v48, v24, v96
    v_fma_f32 v100, -v52, v24, v100
    v_mfma_f32_16x16x32_bf16 v[80:83], a[36:39], v[240:243], v[80:83]
    buffer_load_dwordx4 a[168:171], v11, s[64:67], s94 offen offset:0
    v_mfma_f32_16x16x32_bf16 v[68:71], a[4:7], v[244:247], v[68:71]
    v_permlane16_swap_b32 v40, v41
    v_fma_f32 v97, -v48, v25, v97
    v_mfma_f32_16x16x32_bf16 v[76:79], a[20:23], v[244:247], v[76:79]
    v_fma_f32 v101, -v52, v25, v101
    v_mfma_f32_16x16x32_bf16 v[84:87], a[36:39], v[244:247], v[84:87]
    s_waitcnt lgkmcnt(2)
    ds_read_b128 v[232:235], v8 offset:9216
    ds_read_b128 v[236:239], v8 offset:29696
    v_mfma_f32_16x16x32_bf16 v[64:67], a[52:55], v[248:251], v[64:67]
    buffer_store_dwordx2 v[40:41], v9, s[64:67], s42 offen sc1
    v_fma_f32 v98, -v48, v26, v98
    v_mfma_f32_16x16x32_bf16 v[72:75], a[68:71], v[248:251], v[72:75]
    buffer_load_dwordx4 a[172:175], v12, s[64:67], s94 offen offset:0
    v_mfma_f32_16x16x32_bf16 v[80:83], a[8:11], v[248:251], v[80:83]
    v_fma_f32 v102, -v52, v26, v102
    v_fma_f32 v99, -v48, v27, v99
    v_mfma_f32_16x16x32_bf16 v[68:71], a[52:55], v[252:255], v[68:71]
    v_fma_f32 v103, -v52, v27, v103
    v_mul_f32 v36, v96, v96
    v_mul_f32 v38, v100, v100
    v_mfma_f32_16x16x32_bf16 v[76:79], a[68:71], v[252:255], v[76:79]
    v_mul_f32 v37, v97, v97
    v_mul_f32 v39, v101, v101
    v_mfma_f32_16x16x32_bf16 v[84:87], a[8:11], v[252:255], v[84:87]
    s_waitcnt lgkmcnt(2)
    ds_read_b128 v[240:243], v8 offset:10240
    ds_read_b128 v[244:247], v8 offset:30720
    v_mfma_f32_16x16x32_bf16 v[64:67], a[24:27], v[224:227], v[64:67]
    buffer_load_dwordx4 a[176:179], v13, s[64:67], s94 offen offset:0
    v_mfma_f32_16x16x32_bf16 v[72:75], a[40:43], v[224:227], v[72:75]
    v_fma_f32 v36, v36, v50, v49
    v_fma_f32 v38, v38, v54, v53
    v_fma_f32 v37, v37, v50, v49
    v_mfma_f32_16x16x32_bf16 v[80:83], a[56:59], v[224:227], v[80:83]
    v_fma_f32 v39, v39, v54, v53
    v_mul_f32 v36, v36, v96
    v_mfma_f32_16x16x32_bf16 v[68:71], a[24:27], v[228:231], v[68:71]
    v_mul_f32 v38, v38, v100
    v_mul_f32 v37, v37, v97
    v_mfma_f32_16x16x32_bf16 v[76:79], a[40:43], v[228:231], v[76:79]
    buffer_load_dwordx4 a[180:183], v14, s[64:67], s94 offen offset:0
    v_mfma_f32_16x16x32_bf16 v[84:87], a[56:59], v[228:231], v[84:87]
    s_waitcnt lgkmcnt(2)
    ds_read_b128 v[248:251], v8 offset:11264
    ds_read_b128 v[252:255], v8 offset:31744
    v_mfma_f32_16x16x32_bf16 v[64:67], a[72:75], v[232:235], v[64:67]
    v_mul_f32 v39, v39, v101
    v_exp_f32 v36, v36
    v_mfma_f32_16x16x32_bf16 v[72:75], a[12:15], v[232:235], v[72:75]
    v_exp_f32 v38, v38
    v_mfma_f32_16x16x32_bf16 v[80:83], a[28:31], v[232:235], v[80:83]
    v_exp_f32 v37, v37
    v_mfma_f32_16x16x32_bf16 v[68:71], a[72:75], v[236:239], v[68:71]
    buffer_load_dwordx4 a[184:187], v8, s[64:67], s95 offen offset:0
    v_mfma_f32_16x16x32_bf16 v[76:79], a[12:15], v[236:239], v[76:79]
    v_exp_f32 v39, v39
    v_mul_f32 v96, v96, v98
    v_mfma_f32_16x16x32_bf16 v[84:87], a[28:31], v[236:239], v[84:87]
    s_waitcnt lgkmcnt(2)
    ds_read_b128 v[224:227], v8 offset:12288
    ds_read_b128 v[228:231], v8 offset:32768
    v_mfma_f32_16x16x32_bf16 v[64:67], a[44:47], v[240:243], v[64:67]
    v_mul_f32 v100, v100, v102
    v_mul_f32 v97, v97, v99
    v_mfma_f32_16x16x32_bf16 v[72:75], a[60:63], v[240:243], v[72:75]
    v_mul_f32 v101, v101, v103
    v_fma_f32 v36, v36, v51, v51
    v_mfma_f32_16x16x32_bf16 v[80:83], a[76:79], v[240:243], v[80:83]
    buffer_load_dwordx4 a[188:191], v11, s[64:67], s95 offen offset:0
    v_fma_f32 v38, v38, v55, v55
    v_mfma_f32_16x16x32_bf16 v[68:71], a[44:47], v[244:247], v[68:71]
    v_fma_f32 v37, v37, v51, v51
    v_fma_f32 v39, v39, v55, v55
    v_mfma_f32_16x16x32_bf16 v[76:79], a[60:63], v[244:247], v[76:79]
    v_rcp_f32 v36, v36
    v_mfma_f32_16x16x32_bf16 v[84:87], a[76:79], v[244:247], v[84:87]
    s_waitcnt lgkmcnt(2)
    ds_read_b128 v[232:235], v8 offset:13312
    ds_read_b128 v[236:239], v8 offset:33792
    v_mfma_f32_16x16x32_bf16 v[64:67], a[80:83], v[248:251], v[64:67]
    v_rcp_f32 v38, v38
    v_mfma_f32_16x16x32_bf16 v[72:75], a[96:99], v[248:251], v[72:75]
    buffer_load_dwordx4 a[192:195], v12, s[64:67], s95 offen offset:0
    v_mfma_f32_16x16x32_bf16 v[80:83], a[112:115], v[248:251], v[80:83]
    v_rcp_f32 v37, v37
    v_mfma_f32_16x16x32_bf16 v[68:71], a[80:83], v[252:255], v[68:71]
    s_add_u32 s42, s43, 99328
    v_rcp_f32 v39, v39
    v_mul_f32 v36, v36, v96
    v_mfma_f32_16x16x32_bf16 v[76:79], a[96:99], v[252:255], v[76:79]
    v_mul_f32 v38, v38, v100
    v_mul_f32 v37, v37, v97
    v_mul_f32 v39, v39, v101
    v_mfma_f32_16x16x32_bf16 v[84:87], a[112:115], v[252:255], v[84:87]
    s_waitcnt lgkmcnt(2)
    ds_read_b128 v[240:243], v8 offset:14336
    ds_read_b128 v[244:247], v8 offset:34816
    v_mfma_f32_16x16x32_bf16 v[64:67], a[128:131], v[224:227], v[64:67]
    buffer_load_dwordx4 a[196:199], v13, s[64:67], s95 offen offset:0
    v_mfma_f32_16x16x32_bf16 v[72:75], a[144:147], v[224:227], v[72:75]
    v_cvt_pk_bf16_f32 v42, v36, v37
    v_cvt_pk_bf16_f32 v43, v38, v39
    v_mfma_f32_16x16x32_bf16 v[80:83], a[84:87], v[224:227], v[80:83]
    v_fma_f32 v104, -v48, v28, v104
    v_fma_f32 v108, -v52, v28, v108
    v_mfma_f32_16x16x32_bf16 v[68:71], a[128:131], v[228:231], v[68:71]
    v_permlane16_swap_b32 v42, v43
    v_fma_f32 v105, -v48, v29, v105
    v_mfma_f32_16x16x32_bf16 v[76:79], a[144:147], v[228:231], v[76:79]
    buffer_load_dwordx4 a[200:203], v14, s[64:67], s95 offen offset:0
    v_mfma_f32_16x16x32_bf16 v[84:87], a[84:87], v[228:231], v[84:87]
    s_waitcnt lgkmcnt(2)
    ds_read_b128 v[248:251], v8 offset:15360
    ds_read_b128 v[252:255], v8 offset:35840
    v_mfma_f32_16x16x32_bf16 v[64:67], a[100:103], v[232:235], v[64:67]
    v_fma_f32 v109, -v52, v29, v109
    v_mfma_f32_16x16x32_bf16 v[72:75], a[116:119], v[232:235], v[72:75]
    buffer_store_dwordx2 v[42:43], v9, s[64:67], s42 offen sc1
    v_fma_f32 v106, -v48, v30, v106
    v_mfma_f32_16x16x32_bf16 v[80:83], a[132:135], v[232:235], v[80:83]
    v_fma_f32 v110, -v52, v30, v110
    v_fma_f32 v107, -v48, v31, v107
    v_mfma_f32_16x16x32_bf16 v[68:71], a[100:103], v[236:239], v[68:71]
    buffer_load_dwordx4 a[204:207], v8, s[64:67], s92 offen offset:1024
    v_mfma_f32_16x16x32_bf16 v[76:79], a[116:119], v[236:239], v[76:79]
    v_fma_f32 v111, -v52, v31, v111
    v_mul_f32 v32, v104, v104
    v_mfma_f32_16x16x32_bf16 v[84:87], a[132:135], v[236:239], v[84:87]
    s_waitcnt lgkmcnt(2)
    ds_read_b128 v[224:227], v8 offset:16384
    ds_read_b128 v[228:231], v8 offset:36864
    v_mul_f32 v34, v108, v108
    v_mfma_f32_16x16x32_bf16 v[64:67], a[148:151], v[240:243], v[64:67]
    v_mul_f32 v33, v105, v105
    v_mul_f32 v35, v109, v109
    v_mfma_f32_16x16x32_bf16 v[72:75], a[88:91], v[240:243], v[72:75]
    v_fma_f32 v32, v32, v50, v49
    v_fma_f32 v34, v34, v54, v53
    v_mfma_f32_16x16x32_bf16 v[80:83], v[144:147], v[240:243], v[80:83]
    buffer_load_dwordx4 a[208:211], v11, s[64:67], s92 offen offset:1024
    v_mfma_f32_16x16x32_bf16 v[68:71], a[148:151], v[244:247], v[68:71]
    v_fma_f32 v33, v33, v50, v49
    v_fma_f32 v35, v35, v54, v53
    v_mul_f32 v32, v32, v104
    v_mfma_f32_16x16x32_bf16 v[76:79], a[88:91], v[244:247], v[76:79]
    v_mul_f32 v34, v34, v108
    v_mul_f32 v33, v33, v105
    v_mfma_f32_16x16x32_bf16 v[84:87], v[144:147], v[244:247], v[84:87]
    s_waitcnt lgkmcnt(2)
    ds_read_b128 v[232:235], v8 offset:17408
    ds_read_b128 v[236:239], v8 offset:37888
    v_mfma_f32_16x16x32_bf16 v[64:67], v[148:151], v[248:251], v[64:67]
    buffer_load_dwordx4 a[212:215], v12, s[64:67], s92 offen offset:1024
    v_mfma_f32_16x16x32_bf16 v[72:75], v[152:155], v[248:251], v[72:75]
    v_mul_f32 v35, v35, v109
    v_exp_f32 v32, v32
    v_mfma_f32_16x16x32_bf16 v[80:83], v[156:159], v[248:251], v[80:83]
    v_exp_f32 v34, v34
    v_mfma_f32_16x16x32_bf16 v[68:71], v[148:151], v[252:255], v[68:71]
    v_exp_f32 v33, v33
    v_mfma_f32_16x16x32_bf16 v[76:79], v[152:155], v[252:255], v[76:79]
    v_exp_f32 v35, v35
    v_mfma_f32_16x16x32_bf16 v[84:87], v[156:159], v[252:255], v[84:87]
    s_waitcnt lgkmcnt(2)
    ds_read_b128 v[240:243], v8 offset:18432
    ds_read_b128 v[244:247], v8 offset:38912
    v_mul_f32 v104, v104, v106
    v_mfma_f32_16x16x32_bf16 v[64:67], v[160:163], v[224:227], v[64:67]
    buffer_load_dwordx4 a[216:219], v13, s[64:67], s92 offen offset:1024
    v_mfma_f32_16x16x32_bf16 v[72:75], v[164:167], v[224:227], v[72:75]
    v_mul_f32 v108, v108, v110
    v_mul_f32 v105, v105, v107
    v_mfma_f32_16x16x32_bf16 v[80:83], v[168:171], v[224:227], v[80:83]
    v_mul_f32 v109, v109, v111
    v_fma_f32 v32, v32, v51, v51
    v_mfma_f32_16x16x32_bf16 v[68:71], v[160:163], v[228:231], v[68:71]
    v_fma_f32 v34, v34, v55, v55
    v_fma_f32 v33, v33, v51, v51
    v_fma_f32 v35, v35, v55, v55
    v_mfma_f32_16x16x32_bf16 v[76:79], v[164:167], v[228:231], v[76:79]
    buffer_load_dwordx4 a[220:223], v14, s[64:67], s92 offen offset:1024
    v_mfma_f32_16x16x32_bf16 v[84:87], v[168:171], v[228:231], v[84:87]
    s_waitcnt lgkmcnt(2)
    ds_read_b128 v[248:251], v8 offset:19456
    ds_read_b128 v[252:255], v8 offset:39936
    v_mfma_f32_16x16x32_bf16 v[64:67], v[172:175], v[232:235], v[64:67]
    ds_read_b128 v[48:51], v60 offset:40960
    ds_read_b128 v[52:55], v60 offset:41216
    v_mfma_f32_16x16x32_bf16 v[72:75], v[192:195], v[232:235], v[72:75]
    v_rcp_f32 v32, v32
    v_mfma_f32_16x16x32_bf16 v[80:83], v[196:199], v[232:235], v[80:83]
    v_rcp_f32 v34, v34
    v_mfma_f32_16x16x32_bf16 v[68:71], v[172:175], v[236:239], v[68:71]
    buffer_load_dwordx4 a[224:227], v8, s[64:67], s93 offen offset:1024
    v_mfma_f32_16x16x32_bf16 v[76:79], v[192:195], v[236:239], v[76:79]
    s_waitcnt vmcnt(17) lgkmcnt(0)
    s_barrier
    v_rcp_f32 v33, v33
    v_mfma_f32_16x16x32_bf16 v[84:87], v[196:199], v[236:239], v[84:87]
    s_add_u32 s42, s43, 100352
    ds_read_b128 v[224:227], v10 offset:0
    ds_read_b128 v[228:231], v10 offset:20480
    v_mfma_f32_16x16x32_bf16 v[64:67], v[200:203], v[240:243], v[64:67]
    v_rcp_f32 v35, v35
    v_mul_f32 v32, v32, v104
    v_mfma_f32_16x16x32_bf16 v[72:75], v[204:207], v[240:243], v[72:75]
    v_mul_f32 v34, v34, v108
    v_mul_f32 v33, v33, v105
    v_mfma_f32_16x16x32_bf16 v[80:83], v[208:211], v[240:243], v[80:83]
    buffer_load_dwordx4 a[228:231], v11, s[64:67], s93 offen offset:1024
    v_mfma_f32_16x16x32_bf16 v[68:71], v[200:203], v[244:247], v[68:71]
    v_mul_f32 v35, v35, v109
    v_cvt_pk_bf16_f32 v40, v32, v33
    v_mfma_f32_16x16x32_bf16 v[76:79], v[204:207], v[244:247], v[76:79]
    v_cvt_pk_bf16_f32 v41, v34, v35
    v_mfma_f32_16x16x32_bf16 v[84:87], v[208:211], v[244:247], v[84:87]
    s_waitcnt lgkmcnt(4)
    ds_read_b128 v[232:235], v10 offset:1024
    ds_read_b128 v[236:239], v10 offset:21504
    v_mfma_f32_16x16x32_bf16 v[64:67], v[212:215], v[248:251], v[64:67]
    buffer_load_dwordx4 a[232:235], v12, s[64:67], s93 offen offset:1024
    v_mfma_f32_16x16x32_bf16 v[72:75], v[216:219], v[248:251], v[72:75]
    v_permlane16_swap_b32 v40, v41
    v_mfma_f32_16x16x32_bf16 v[80:83], v[220:223], v[248:251], v[80:83]
    s_nop 0
    buffer_store_dwordx2 v[40:41], v9, s[64:67], s42 offen sc1
    v_mfma_f32_16x16x32_bf16 v[68:71], v[212:215], v[252:255], v[68:71]
    v_mfma_f32_16x16x32_bf16 v[76:79], v[216:219], v[252:255], v[76:79]
    v_mfma_f32_16x16x32_bf16 v[84:87], v[220:223], v[252:255], v[84:87]
    s_waitcnt lgkmcnt(2)
    ds_read_b128 v[240:243], v10 offset:2048
    ds_read_b128 v[244:247], v10 offset:22528
    v_mfma_f32_16x16x32_bf16 v[88:91], v[112:115], v[224:227], 0
    buffer_load_dwordx4 a[236:239], v13, s[64:67], s93 offen offset:1024
    v_mfma_f32_16x16x32_bf16 v[96:99], v[116:119], v[224:227], 0
    v_mfma_f32_16x16x32_bf16 v[104:107], v[120:123], v[224:227], 0
    s_waitcnt lgkmcnt(6)
    v_fma_f32 v64, -v48, v20, v64
    v_fma_f32 v68, -v52, v20, v68
    v_fma_f32 v65, -v48, v21, v65
    v_mfma_f32_16x16x32_bf16 v[92:95], v[112:115], v[228:231], 0
    v_fma_f32 v69, -v52, v21, v69
    v_fma_f32 v66, -v48, v22, v66
    v_mfma_f32_16x16x32_bf16 v[100:103], v[116:119], v[228:231], 0
    buffer_load_dwordx4 a[240:243], v14, s[64:67], s93 offen offset:1024
    v_fma_f32 v70, -v52, v22, v70
    v_mfma_f32_16x16x32_bf16 v[108:111], v[120:123], v[228:231], 0
    s_waitcnt lgkmcnt(2)
    ds_read_b128 v[248:251], v10 offset:3072
    ds_read_b128 v[252:255], v10 offset:23552
    v_mfma_f32_16x16x32_bf16 v[88:91], v[124:127], v[232:235], v[88:91]
    v_fma_f32 v67, -v48, v23, v67
    v_fma_f32 v71, -v52, v23, v71
    v_mfma_f32_16x16x32_bf16 v[96:99], v[128:131], v[232:235], v[96:99]
    v_cmp_u_f32 s[82:83], v66, v70
    v_mul_f32 v32, v64, v64
    v_mul_f32 v34, v68, v68
    v_mfma_f32_16x16x32_bf16 v[104:107], v[132:135], v[232:235], v[104:107]
    v_mul_f32 v33, v65, v65
    v_mul_f32 v35, v69, v69
    v_mfma_f32_16x16x32_bf16 v[92:95], v[124:127], v[236:239], v[92:95]
    buffer_load_dwordx4 v[112:115], v4, s[64:67], s88 offen offset:0 sc1
    v_fma_f32 v32, v32, v50, v49
    v_mfma_f32_16x16x32_bf16 v[100:103], v[128:131], v[236:239], v[100:103]
    v_fma_f32 v34, v34, v54, v53
    v_fma_f32 v33, v33, v50, v49
    v_mfma_f32_16x16x32_bf16 v[108:111], v[132:135], v[236:239], v[108:111]
    s_waitcnt lgkmcnt(2)
    ds_read_b128 v[224:227], v10 offset:15360
    ds_read_b128 v[228:231], v10 offset:35840
    v_mfma_f32_16x16x32_bf16 v[88:91], v[136:139], v[240:243], v[88:91]
    v_fma_f32 v35, v35, v54, v53
    v_mul_f32 v32, v32, v64
    v_mul_f32 v34, v34, v68
    v_mfma_f32_16x16x32_bf16 v[96:99], v[140:143], v[240:243], v[96:99]
    buffer_load_dwordx4 v[116:119], v4, s[64:67], s89 offen offset:0 sc1
    v_mfma_f32_16x16x32_bf16 v[104:107], v[176:179], v[240:243], v[104:107]
    v_mul_f32 v33, v33, v65
    v_mul_f32 v35, v35, v69
    v_mfma_f32_16x16x32_bf16 v[92:95], v[136:139], v[244:247], v[92:95]
    s_and_b64 s[82:83], s[82:83], s[84:85]
    s_cselect_b32 s43, 27262976, s43
    v_exp_f32 v32, v32
    v_mfma_f32_16x16x32_bf16 v[100:103], v[140:143], v[244:247], v[100:103]
    v_exp_f32 v34, v34
    v_mfma_f32_16x16x32_bf16 v[108:111], v[176:179], v[244:247], v[108:111]
    s_waitcnt lgkmcnt(2)
    ds_read_b128 v[232:235], v10 offset:16384
    ds_read_b128 v[236:239], v10 offset:36864
    v_mfma_f32_16x16x32_bf16 v[88:91], v[180:183], v[248:251], v[88:91]
    buffer_load_dwordx4 v[120:123], v4, s[64:67], s90 offen offset:0 sc1
    v_mfma_f32_16x16x32_bf16 v[96:99], v[184:187], v[248:251], v[96:99]
    v_exp_f32 v33, v33
    v_exp_f32 v35, v35
    v_mfma_f32_16x16x32_bf16 v[104:107], v[188:191], v[248:251], v[104:107]
    v_mul_f32 v64, v64, v66
    v_mul_f32 v68, v68, v70
    v_mfma_f32_16x16x32_bf16 v[92:95], v[180:183], v[252:255], v[92:95]
    v_mul_f32 v65, v65, v67
    v_mul_f32 v69, v69, v71
    v_mfma_f32_16x16x32_bf16 v[100:103], v[184:187], v[252:255], v[100:103]
    v_fma_f32 v32, v32, v51, v51
    v_fma_f32 v34, v34, v55, v55
    v_fma_f32 v33, v33, v51, v51
    v_mfma_f32_16x16x32_bf16 v[108:111], v[188:191], v[252:255], v[108:111]
    s_waitcnt lgkmcnt(2)
    ds_read_b128 v[240:243], v10 offset:17408
    ds_read_b128 v[244:247], v10 offset:37888
    v_mfma_f32_16x16x32_bf16 v[88:91], v[148:151], v[224:227], v[88:91]
    buffer_load_dwordx4 v[124:127], v4, s[64:67], s91 offen offset:0 sc1
    v_fma_f32 v35, v35, v55, v55
    v_mfma_f32_16x16x32_bf16 v[96:99], v[152:155], v[224:227], v[96:99]
    v_rcp_f32 v32, v32
    v_mfma_f32_16x16x32_bf16 v[104:107], v[156:159], v[224:227], v[104:107]
    v_rcp_f32 v34, v34
    v_mfma_f32_16x16x32_bf16 v[92:95], v[148:151], v[228:231], v[92:95]
    v_rcp_f32 v33, v33
    v_mfma_f32_16x16x32_bf16 v[100:103], v[152:155], v[228:231], v[100:103]
    buffer_load_dwordx4 v[128:131], v4, s[64:67], s88 offen offset:1024 sc1
    v_mfma_f32_16x16x32_bf16 v[108:111], v[156:159], v[228:231], v[108:111]
    s_waitcnt lgkmcnt(2)
    ds_read_b128 v[248:251], v10 offset:18432
    ds_read_b128 v[252:255], v10 offset:38912
    v_rcp_f32 v35, v35
    v_mfma_f32_16x16x32_bf16 v[88:91], v[160:163], v[232:235], v[88:91]
    s_add_u32 s42, s43, 196608
    v_mul_f32 v32, v32, v64
    v_mul_f32 v34, v34, v68
    v_mfma_f32_16x16x32_bf16 v[96:99], v[164:167], v[232:235], v[96:99]
    v_mul_f32 v33, v33, v65
    v_mul_f32 v35, v35, v69
    v_mfma_f32_16x16x32_bf16 v[104:107], v[168:171], v[232:235], v[104:107]
    buffer_load_dwordx4 v[132:135], v4, s[64:67], s89 offen offset:1024 sc1
    v_cvt_pk_bf16_f32 v40, v32, v33
    v_mfma_f32_16x16x32_bf16 v[92:95], v[160:163], v[236:239], v[92:95]
    v_cvt_pk_bf16_f32 v41, v34, v35
    v_fma_f32 v72, -v48, v24, v72
    v_mfma_f32_16x16x32_bf16 v[100:103], v[164:167], v[236:239], v[100:103]
    v_fma_f32 v76, -v52, v24, v76
    v_permlane16_swap_b32 v40, v41
    v_mfma_f32_16x16x32_bf16 v[108:111], v[168:171], v[236:239], v[108:111]
    s_waitcnt lgkmcnt(2)
    ds_read_b128 v[224:227], v10 offset:19456
    ds_read_b128 v[228:231], v10 offset:39936
    v_mfma_f32_16x16x32_bf16 v[88:91], v[172:175], v[240:243], v[88:91]
    v_fma_f32 v73, -v48, v25, v73
    v_fma_f32 v77, -v52, v25, v77
    v_mfma_f32_16x16x32_bf16 v[96:99], v[192:195], v[240:243], v[96:99]
    buffer_load_dwordx4 v[136:139], v4, s[64:67], s90 offen offset:1024 sc1
    v_mfma_f32_16x16x32_bf16 v[104:107], v[196:199], v[240:243], v[104:107]
    buffer_store_dwordx2 v[40:41], v9, s[64:67], s42 offen sc1
    v_fma_f32 v74, -v48, v26, v74
    v_mfma_f32_16x16x32_bf16 v[92:95], v[172:175], v[244:247], v[92:95]
    v_fma_f32 v78, -v52, v26, v78
    v_fma_f32 v75, -v48, v27, v75
    v_fma_f32 v79, -v52, v27, v79
    v_mfma_f32_16x16x32_bf16 v[100:103], v[192:195], v[244:247], v[100:103]
    v_mul_f32 v36, v72, v72
    v_mul_f32 v38, v76, v76
    v_mfma_f32_16x16x32_bf16 v[108:111], v[196:199], v[244:247], v[108:111]
    s_waitcnt lgkmcnt(2)
    ds_read_b128 v[232:235], v10 offset:14336
    ds_read_b128 v[236:239], v10 offset:34816
    v_mfma_f32_16x16x32_bf16 v[88:91], v[200:203], v[248:251], v[88:91]
    buffer_load_dwordx4 v[140:143], v4, s[64:67], s91 offen offset:1024 sc1
    v_mul_f32 v37, v73, v73
    v_mfma_f32_16x16x32_bf16 v[96:99], v[204:207], v[248:251], v[96:99]
    v_mul_f32 v39, v77, v77
    v_fma_f32 v36, v36, v50, v49
    v_mfma_f32_16x16x32_bf16 v[104:107], v[208:211], v[248:251], v[104:107]
    v_fma_f32 v38, v38, v54, v53
    v_fma_f32 v37, v37, v50, v49
    v_fma_f32 v39, v39, v54, v53
    v_mfma_f32_16x16x32_bf16 v[92:95], v[200:203], v[252:255], v[92:95]
    v_mul_f32 v36, v36, v72
    v_mul_f32 v38, v38, v76
    v_mfma_f32_16x16x32_bf16 v[100:103], v[204:207], v[252:255], v[100:103]
    v_mul_f32 v37, v37, v73
    v_mul_f32 v39, v39, v77
    v_mfma_f32_16x16x32_bf16 v[108:111], v[208:211], v[252:255], v[108:111]
    s_waitcnt lgkmcnt(2)
    ds_read_b128 v[240:243], v10 offset:4096
    ds_read_b128 v[244:247], v10 offset:24576
    v_mfma_f32_16x16x32_bf16 v[88:91], v[212:215], v[224:227], v[88:91]
    buffer_load_dwordx4 a[244:247], v8, s[64:67], s94 offen offset:1024
    v_mfma_f32_16x16x32_bf16 v[96:99], v[216:219], v[224:227], v[96:99]
    v_exp_f32 v36, v36
    v_exp_f32 v38, v38
    v_mfma_f32_16x16x32_bf16 v[104:107], v[220:223], v[224:227], v[104:107]
    v_exp_f32 v37, v37
    v_mfma_f32_16x16x32_bf16 v[92:95], v[212:215], v[228:231], v[92:95]
    buffer_load_dwordx4 a[248:251], v11, s[64:67], s94 offen offset:1024
    v_mfma_f32_16x16x32_bf16 v[100:103], v[216:219], v[228:231], v[100:103]
    v_exp_f32 v39, v39
    v_mul_f32 v72, v72, v74
    v_mfma_f32_16x16x32_bf16 v[108:111], v[220:223], v[228:231], v[108:111]
    s_waitcnt lgkmcnt(2)
    ds_read_b128 v[248:251], v10 offset:5120
    ds_read_b128 v[252:255], v10 offset:25600
    v_mfma_f32_16x16x32_bf16 v[88:91], a[148:151], v[232:235], v[88:91]
    v_mul_f32 v76, v76, v78
    v_mul_f32 v73, v73, v75
    v_mul_f32 v77, v77, v79
    v_mfma_f32_16x16x32_bf16 v[96:99], a[88:91], v[232:235], v[96:99]
    v_fma_f32 v36, v36, v51, v51
    v_fma_f32 v38, v38, v55, v55
    v_mfma_f32_16x16x32_bf16 v[104:107], v[144:147], v[232:235], v[104:107]
    buffer_load_dwordx4 v[176:179], v4, s[64:67], s88 offen offset:2048 sc1
    v_mfma_f32_16x16x32_bf16 v[92:95], a[148:151], v[236:239], v[92:95]
    v_fma_f32 v37, v37, v51, v51
    v_fma_f32 v39, v39, v55, v55
    v_mfma_f32_16x16x32_bf16 v[100:103], a[88:91], v[236:239], v[100:103]
    v_rcp_f32 v36, v36
    v_mfma_f32_16x16x32_bf16 v[108:111], v[144:147], v[236:239], v[108:111]
    s_waitcnt lgkmcnt(2)
    ds_read_b128 v[224:227], v10 offset:6144
    ds_read_b128 v[228:231], v10 offset:26624
    v_rcp_f32 v38, v38
    v_mfma_f32_16x16x32_bf16 v[88:91], a[252:255], v[240:243], v[88:91]
    v_rcp_f32 v37, v37
    v_mfma_f32_16x16x32_bf16 v[96:99], a[0:3], v[240:243], v[96:99]
    buffer_load_dwordx4 v[180:183], v4, s[64:67], s89 offen offset:2048 sc1
    v_mfma_f32_16x16x32_bf16 v[104:107], a[16:19], v[240:243], v[104:107]
    s_add_u32 s42, s43, 197632
    v_rcp_f32 v39, v39
    v_mul_f32 v36, v36, v72
    v_mfma_f32_16x16x32_bf16 v[92:95], a[252:255], v[244:247], v[92:95]
    v_mul_f32 v38, v38, v76
    v_mul_f32 v37, v37, v73
    v_mfma_f32_16x16x32_bf16 v[100:103], a[0:3], v[244:247], v[100:103]
    v_mul_f32 v39, v39, v77
    v_cvt_pk_bf16_f32 v42, v36, v37
    v_cvt_pk_bf16_f32 v43, v38, v39
    v_mfma_f32_16x16x32_bf16 v[108:111], a[16:19], v[244:247], v[108:111]
    s_waitcnt lgkmcnt(2)
    ds_read_b128 v[232:235], v10 offset:7168
    ds_read_b128 v[236:239], v10 offset:27648
    v_mfma_f32_16x16x32_bf16 v[88:91], a[32:35], v[248:251], v[88:91]
    buffer_load_dwordx4 v[184:187], v4, s[64:67], s90 offen offset:2048 sc1
    v_mfma_f32_16x16x32_bf16 v[96:99], a[48:51], v[248:251], v[96:99]
    v_fma_f32 v80, -v48, v28, v80
    v_fma_f32 v84, -v52, v28, v84
    v_mfma_f32_16x16x32_bf16 v[104:107], a[64:67], v[248:251], v[104:107]
    v_permlane16_swap_b32 v42, v43
    v_fma_f32 v81, -v48, v29, v81
    v_mfma_f32_16x16x32_bf16 v[92:95], a[32:35], v[252:255], v[92:95]
    v_fma_f32 v85, -v52, v29, v85
    v_mfma_f32_16x16x32_bf16 v[100:103], a[48:51], v[252:255], v[100:103]
    buffer_load_dwordx4 v[188:191], v4, s[64:67], s91 offen offset:2048 sc1
    v_mfma_f32_16x16x32_bf16 v[108:111], a[64:67], v[252:255], v[108:111]
    s_waitcnt lgkmcnt(2)
    ds_read_b128 v[240:243], v10 offset:8192
    ds_read_b128 v[244:247], v10 offset:28672
    v_mfma_f32_16x16x32_bf16 v[88:91], a[4:7], v[224:227], v[88:91]
    buffer_store_dwordx2 v[42:43], v9, s[64:67], s42 offen sc1
    v_fma_f32 v82, -v48, v30, v82
    v_fma_f32 v86, -v52, v30, v86
    v_mfma_f32_16x16x32_bf16 v[96:99], a[20:23], v[224:227], v[96:99]
    v_fma_f32 v83, -v48, v31, v83
    v_fma_f32 v87, -v52, v31, v87
    v_mfma_f32_16x16x32_bf16 v[104:107], a[36:39], v[224:227], v[104:107]
    v_mul_f32 v32, v80, v80
    v_mul_f32 v34, v84, v84
    v_mul_f32 v33, v81, v81
    v_mfma_f32_16x16x32_bf16 v[92:95], a[4:7], v[228:231], v[92:95]
    buffer_load_dwordx4 a[148:151], v11, s[64:67], s94 offen offset:2048
    v_mfma_f32_16x16x32_bf16 v[100:103], a[20:23], v[228:231], v[100:103]
    v_mul_f32 v35, v85, v85
    v_fma_f32 v32, v32, v50, v49
    v_mfma_f32_16x16x32_bf16 v[108:111], a[36:39], v[228:231], v[108:111]
    s_waitcnt vmcnt(63) lgkmcnt(2)
    ds_read_b128 v[248:251], v10 offset:9216
    ds_read_b128 v[252:255], v10 offset:29696
    v_fma_f32 v34, v34, v54, v53
    v_mfma_f32_16x16x32_bf16 v[88:91], a[52:55], v[232:235], v[88:91]
    v_fma_f32 v33, v33, v50, v49
    v_fma_f32 v35, v35, v54, v53
    v_mfma_f32_16x16x32_bf16 v[96:99], a[68:71], v[232:235], v[96:99]
    ds_read_b128 a[20:23], v61 offset:0
    ds_read_b128 a[36:39], v61 offset:1024
    v_mul_f32 v32, v32, v80
    v_mfma_f32_16x16x32_bf16 v[104:107], a[8:11], v[232:235], v[104:107]
    buffer_load_dwordx4 a[88:91], v12, s[64:67], s94 offen offset:2048
    v_mfma_f32_16x16x32_bf16 v[92:95], a[52:55], v[236:239], v[92:95]
    v_mul_f32 v34, v34, v84
    v_mul_f32 v33, v33, v81
    v_mfma_f32_16x16x32_bf16 v[100:103], a[68:71], v[236:239], v[100:103]
    v_mul_f32 v35, v35, v85
    v_exp_f32 v32, v32
    v_mfma_f32_16x16x32_bf16 v[108:111], a[8:11], v[236:239], v[108:111]
    s_waitcnt vmcnt(63) lgkmcnt(4)
    ds_read_b128 v[224:227], v10 offset:10240
    ds_read_b128 v[228:231], v10 offset:30720
    v_mfma_f32_16x16x32_bf16 v[88:91], a[24:27], v[240:243], v[88:91]
    v_exp_f32 v34, v34
    v_mfma_f32_16x16x32_bf16 v[96:99], a[40:43], v[240:243], v[96:99]
    ds_read_b128 a[52:55], v61 offset:2048
    ds_read_b128 a[68:71], v61 offset:3072
    v_mfma_f32_16x16x32_bf16 v[104:107], a[56:59], v[240:243], v[104:107]
    ds_read_b128 a[8:11], v61 offset:4096
    v_exp_f32 v33, v33
    v_mfma_f32_16x16x32_bf16 v[92:95], a[24:27], v[244:247], v[92:95]
    buffer_load_dwordx4 a[252:255], v13, s[64:67], s94 offen offset:2048
    v_mfma_f32_16x16x32_bf16 v[100:103], a[40:43], v[244:247], v[100:103]
    v_exp_f32 v35, v35
    v_mul_f32 v80, v80, v82
    v_mfma_f32_16x16x32_bf16 v[108:111], a[56:59], v[244:247], v[108:111]
    s_waitcnt vmcnt(63) lgkmcnt(7)
    ds_read_b128 v[232:235], v10 offset:11264
    ds_read_b128 v[236:239], v10 offset:31744
    v_mul_f32 v84, v84, v86
    v_mfma_f32_16x16x32_bf16 v[88:91], a[72:75], v[248:251], v[88:91]
    buffer_load_dwordx4 a[0:3], v14, s[64:67], s94 offen offset:2048
    v_mfma_f32_16x16x32_bf16 v[96:99], a[12:15], v[248:251], v[96:99]
    ds_read_b128 a[24:27], v61 offset:5120
    ds_read_b128 a[40:43], v61 offset:6144
    v_mfma_f32_16x16x32_bf16 v[104:107], a[28:31], v[248:251], v[104:107]
    ds_read_b128 a[56:59], v61 offset:7168
    v_mul_f32 v81, v81, v83
    v_mul_f32 v85, v85, v87
    v_mfma_f32_16x16x32_bf16 v[92:95], a[72:75], v[252:255], v[92:95]
    v_fma_f32 v32, v32, v51, v51
    v_fma_f32 v34, v34, v55, v55
    v_mfma_f32_16x16x32_bf16 v[100:103], a[12:15], v[252:255], v[100:103]
    buffer_load_dwordx4 a[16:19], v8, s[64:67], s95 offen offset:2048
    v_fma_f32 v33, v33, v51, v51
    v_mfma_f32_16x16x32_bf16 v[108:111], a[28:31], v[252:255], v[108:111]
    s_waitcnt vmcnt(63) lgkmcnt(8)
    ds_read_b128 v[240:243], v10 offset:12288
    ds_read_b128 v[244:247], v10 offset:32768
    v_mfma_f32_16x16x32_bf16 v[88:91], a[44:47], v[224:227], v[88:91]
    v_fma_f32 v35, v35, v55, v55
    v_mfma_f32_16x16x32_bf16 v[96:99], a[60:63], v[224:227], v[96:99]
    ds_read_b128 a[72:75], v61 offset:8192
    ds_read_b128 a[12:15], v61 offset:9216
    ds_read_b128 v[48:51], v60 offset:61440
    v_mfma_f32_16x16x32_bf16 v[104:107], a[76:79], v[224:227], v[104:107]
    ds_read_b128 a[28:31], v61 offset:10240
    ds_read_b128 v[52:55], v60 offset:61696
    v_mfma_f32_16x16x32_bf16 v[92:95], a[44:47], v[228:231], v[92:95]
    buffer_load_dwordx4 a[32:35], v11, s[64:67], s95 offen offset:2048
    v_mfma_f32_16x16x32_bf16 v[100:103], a[60:63], v[228:231], v[100:103]
    v_rcp_f32 v32, v32
    v_mfma_f32_16x16x32_bf16 v[108:111], a[76:79], v[228:231], v[108:111]
    s_waitcnt vmcnt(63) lgkmcnt(10)
    ds_read_b128 v[248:251], v10 offset:13312
    ds_read_b128 v[252:255], v10 offset:33792
    v_mfma_f32_16x16x32_bf16 v[88:91], a[80:83], v[232:235], v[88:91]
    v_rcp_f32 v34, v34
    v_rcp_f32 v33, v33
    v_mfma_f32_16x16x32_bf16 v[96:99], a[96:99], v[232:235], v[96:99]
    s_add_u32 s42, s43, 198656
    ds_read_b128 a[44:47], v61 offset:11264
    ds_read_b128 a[60:63], v61 offset:12288
    v_mfma_f32_16x16x32_bf16 v[104:107], a[112:115], v[232:235], v[104:107]
    ds_read_b128 a[76:79], v61 offset:13312
    v_rcp_f32 v35, v35
    v_mfma_f32_16x16x32_bf16 v[92:95], a[80:83], v[236:239], v[92:95]
    buffer_load_dwordx4 a[48:51], v12, s[64:67], s95 offen offset:2048
    v_mfma_f32_16x16x32_bf16 v[100:103], a[96:99], v[236:239], v[100:103]
    v_mul_f32 v32, v32, v80
    v_mul_f32 v34, v34, v84
    v_mfma_f32_16x16x32_bf16 v[108:111], a[112:115], v[236:239], v[108:111]
    s_waitcnt vmcnt(63) lgkmcnt(10)
    v_mul_f32 v33, v33, v81
    v_mul_f32 v35, v35, v85
    v_cvt_pk_bf16_f32 v40, v32, v33
    v_mfma_f32_16x16x32_bf16 v[88:91], a[128:131], v[240:243], v[88:91]
    v_cvt_pk_bf16_f32 v41, v34, v35
    v_mfma_f32_16x16x32_bf16 v[96:99], a[144:147], v[240:243], v[96:99]
    ds_read_b128 a[80:83], v61 offset:14336
    ds_read_b128 a[96:99], v61 offset:15360
    v_mfma_f32_16x16x32_bf16 v[104:107], a[84:87], v[240:243], v[104:107]
    ds_read_b128 a[112:115], v61 offset:16384
    v_permlane16_swap_b32 v40, v41
    v_mfma_f32_16x16x32_bf16 v[92:95], a[128:131], v[244:247], v[92:95]
    buffer_load_dwordx4 a[64:67], v13, s[64:67], s95 offen offset:2048
    v_mfma_f32_16x16x32_bf16 v[100:103], a[144:147], v[244:247], v[100:103]
    buffer_store_dwordx2 v[40:41], v9, s[64:67], s42 offen sc1
    v_mfma_f32_16x16x32_bf16 v[108:111], a[84:87], v[244:247], v[108:111]
    s_waitcnt vmcnt(63) lgkmcnt(6)
    v_mfma_f32_16x16x32_bf16 v[88:91], a[100:103], v[248:251], v[88:91]
    buffer_load_dwordx4 a[4:7], v14, s[64:67], s95 offen offset:2048
    v_mfma_f32_16x16x32_bf16 v[96:99], a[116:119], v[248:251], v[96:99]
    ds_read_b128 a[128:131], v61 offset:17408
    ds_read_b128 a[144:147], v61 offset:18432
    v_mfma_f32_16x16x32_bf16 v[104:107], a[132:135], v[248:251], v[104:107]
    s_waitcnt vmcnt(22)
    v_max3_u32 v16, v112, v116, v120
    v_max_u32 v16, v16, v124
    v_mfma_f32_16x16x32_bf16 v[92:95], a[100:103], v[252:255], v[92:95]
    v_cmp_eq_u32 vcc, -1, v16
    v_mfma_f32_16x16x32_bf16 v[100:103], a[116:119], v[252:255], v[100:103]
    s_waitcnt vmcnt(63)
    v_mfma_f32_16x16x32_bf16 v[108:111], a[132:135], v[252:255], v[108:111]
    s_cbranch_vccnz k4_r0
k4_ok0:
    v_mfma_f32_16x16x32_bf16 v[64:67], a[104:107], v[112:115], 0
    buffer_load_dwordx4 v[148:151], v5, s[64:67], s88 offen offset:0 sc1
    v_mfma_f32_16x16x32_bf16 v[68:71], a[120:123], v[112:115], 0
    v_mfma_f32_16x16x32_bf16 v[72:75], a[136:139], v[112:115], 0
    s_waitcnt lgkmcnt(10)
    v_fma_f32 v88, -v48, v20, v88
    v_fma_f32 v92, -v52, v20, v92
    v_fma_f32 v89, -v48, v21, v89
    v_fma_f32 v93, -v52, v21, v93
    v_fma_f32 v90, -v48, v22, v90
    v_fma_f32 v94, -v52, v22, v94
    v_mfma_f32_16x16x32_bf16 v[76:79], a[152:155], v[112:115], 0
    s_waitcnt vmcnt(61)
    v_fma_f32 v91, -v48, v23, v91
    v_fma_f32 v95, -v52, v23, v95
    v_cmp_u_f32 s[82:83], v90, v94
    v_mul_f32 v32, v88, v88
    v_mfma_f32_16x16x32_bf16 v[80:83], a[92:95], v[112:115], 0
    buffer_load_dwordx4 v[152:155], v5, s[64:67], s89 offen offset:0 sc1
    v_mul_f32 v34, v92, v92
    v_mul_f32 v33, v89, v89
    v_mul_f32 v35, v93, v93
    v_mfma_f32_16x16x32_bf16 v[64:67], a[108:111], v[116:119], v[64:67]
    v_fma_f32 v32, v32, v50, v49
    v_fma_f32 v34, v34, v54, v53
    v_fma_f32 v33, v33, v50, v49
    v_fma_f32 v35, v35, v54, v53
    v_mfma_f32_16x16x32_bf16 v[68:71], a[124:127], v[116:119], v[68:71]
    v_mul_f32 v32, v32, v88
    v_mul_f32 v34, v34, v92
    v_mul_f32 v33, v33, v89
    v_mul_f32 v35, v35, v93
    v_mfma_f32_16x16x32_bf16 v[72:75], a[140:143], v[116:119], v[72:75]
    buffer_load_dwordx4 v[156:159], v5, s[64:67], s90 offen offset:0 sc1
    v_mfma_f32_16x16x32_bf16 v[76:79], a[156:159], v[116:119], v[76:79]
    s_waitcnt vmcnt(46)
    s_and_b64 s[82:83], s[82:83], s[84:85]
    s_cselect_b32 s43, 27262976, s43
    v_exp_f32 v32, v32
    v_exp_f32 v34, v34
    v_mfma_f32_16x16x32_bf16 v[80:83], a[160:163], v[116:119], v[80:83]
    v_exp_f32 v33, v33
    v_exp_f32 v35, v35
    v_mfma_f32_16x16x32_bf16 v[64:67], a[164:167], v[120:123], v[64:67]
    buffer_load_dwordx4 v[160:163], v5, s[64:67], s91 offen offset:0 sc1
    v_mul_f32 v88, v88, v90
    v_mul_f32 v92, v92, v94
    v_mul_f32 v89, v89, v91
    v_mfma_f32_16x16x32_bf16 v[68:71], a[168:171], v[120:123], v[68:71]
    v_mul_f32 v93, v93, v95
    v_fma_f32 v32, v32, v51, v51
    v_fma_f32 v34, v34, v55, v55
    v_fma_f32 v33, v33, v51, v51
    v_mfma_f32_16x16x32_bf16 v[72:75], a[172:175], v[120:123], v[72:75]
    v_fma_f32 v35, v35, v55, v55
    v_rcp_f32 v32, v32
    v_mfma_f32_16x16x32_bf16 v[76:79], a[176:179], v[120:123], v[76:79]
    s_waitcnt vmcnt(42)
    v_rcp_f32 v34, v34
    v_rcp_f32 v33, v33
    v_rcp_f32 v35, v35
    v_mfma_f32_16x16x32_bf16 v[80:83], a[180:183], v[120:123], v[80:83]
    s_add_u32 s42, s43, 294912
    v_mul_f32 v32, v32, v88
    v_mul_f32 v34, v34, v92
    v_mul_f32 v33, v33, v89
    v_mul_f32 v35, v35, v93
    v_mfma_f32_16x16x32_bf16 v[64:67], a[184:187], v[124:127], v[64:67]
    v_cvt_pk_bf16_f32 v40, v32, v33
    v_cvt_pk_bf16_f32 v41, v34, v35
    v_fma_f32 v96, -v48, v24, v96
    v_fma_f32 v100, -v52, v24, v100
    v_mfma_f32_16x16x32_bf16 v[68:71], a[188:191], v[124:127], v[68:71]
    s_waitcnt vmcnt(21)
    v_max3_u32 v16, v128, v132, v136
    v_max_u32 v16, v16, v140
    v_permlane16_swap_b32 v40, v41
    v_fma_f32 v97, -v48, v25, v97
    v_mfma_f32_16x16x32_bf16 v[72:75], a[192:195], v[124:127], v[72:75]
    v_cmp_eq_u32 vcc, -1, v16
    v_fma_f32 v101, -v52, v25, v101
    v_mfma_f32_16x16x32_bf16 v[76:79], a[196:199], v[124:127], v[76:79]
    s_waitcnt vmcnt(36)
    v_mfma_f32_16x16x32_bf16 v[80:83], a[200:203], v[124:127], v[80:83]
    s_cbranch_vccnz k4_r4
k4_ok4:
    v_mfma_f32_16x16x32_bf16 v[64:67], a[204:207], v[128:131], v[64:67]
    buffer_load_dwordx4 v[164:167], v5, s[64:67], s88 offen offset:1024 sc1
    v_mfma_f32_16x16x32_bf16 v[68:71], a[208:211], v[128:131], v[68:71]
    buffer_load_dwordx4 v[168:171], v5, s[64:67], s89 offen offset:1024 sc1
    v_mfma_f32_16x16x32_bf16 v[72:75], a[212:215], v[128:131], v[72:75]
    buffer_store_dwordx2 v[40:41], v9, s[64:67], s42 offen sc1
    v_fma_f32 v98, -v48, v26, v98
    v_fma_f32 v102, -v52, v26, v102
    v_fma_f32 v99, -v48, v27, v99
    v_fma_f32 v103, -v52, v27, v103
    v_mfma_f32_16x16x32_bf16 v[76:79], a[216:219], v[128:131], v[76:79]
    s_waitcnt vmcnt(33)
    v_mul_f32 v36, v96, v96
    v_mul_f32 v38, v100, v100
    v_mul_f32 v37, v97, v97
    v_mul_f32 v39, v101, v101
    v_mfma_f32_16x16x32_bf16 v[80:83], a[220:223], v[128:131], v[80:83]
    v_fma_f32 v36, v36, v50, v49
    v_fma_f32 v38, v38, v54, v53
    v_fma_f32 v37, v37, v50, v49
    v_fma_f32 v39, v39, v54, v53
    v_mul_f32 v36, v36, v96
    v_mfma_f32_16x16x32_bf16 v[64:67], a[224:227], v[132:135], v[64:67]
    buffer_load_dwordx4 v[172:175], v5, s[64:67], s90 offen offset:1024 sc1
    v_mul_f32 v38, v38, v100
    v_mul_f32 v37, v37, v97
    v_mfma_f32_16x16x32_bf16 v[68:71], a[228:231], v[132:135], v[68:71]
    v_mul_f32 v39, v39, v101
    v_exp_f32 v36, v36
    v_mfma_f32_16x16x32_bf16 v[72:75], a[232:235], v[132:135], v[72:75]
    v_exp_f32 v38, v38
    v_exp_f32 v37, v37
    v_exp_f32 v39, v39
    v_mfma_f32_16x16x32_bf16 v[76:79], a[236:239], v[132:135], v[76:79]
    s_waitcnt vmcnt(23) lgkmcnt(15)
    v_mul_f32 v96, v96, v98
    v_mul_f32 v100, v100, v102
    v_mul_f32 v97, v97, v99
    v_mul_f32 v101, v101, v103
    v_mfma_f32_16x16x32_bf16 v[80:83], a[240:243], v[132:135], v[80:83]
    s_add_u32 s44, s45, 0
    v_fma_f32 v36, v36, v51, v51
    v_fma_f32 v38, v38, v55, v55
    v_fma_f32 v37, v37, v51, v51
    v_fma_f32 v39, v39, v55, v55
    v_mfma_f32_16x16x32_bf16 v[64:67], a[244:247], v[136:139], v[64:67]
    buffer_load_dwordx4 v[60:63], v58, s[64:67], s44 offen sc1
    v_rcp_f32 v36, v36
    v_mfma_f32_16x16x32_bf16 v[68:71], a[248:251], v[136:139], v[68:71]
    buffer_load_dwordx4 v[192:195], v5, s[64:67], s91 offen offset:1024 sc1
    v_rcp_f32 v38, v38
    v_mfma_f32_16x16x32_bf16 v[72:75], a[20:23], v[136:139], v[72:75]
    v_rcp_f32 v37, v37
    v_rcp_f32 v39, v39
    v_mfma_f32_16x16x32_bf16 v[76:79], a[36:39], v[136:139], v[76:79]
    s_waitcnt lgkmcnt(15)
    s_add_u32 s42, s43, 295936
    v_mul_f32 v36, v36, v96
    v_mul_f32 v38, v38, v100
    v_mul_f32 v37, v37, v97
    v_mul_f32 v39, v39, v101
    v_cvt_pk_bf16_f32 v42, v36, v37
    v_mfma_f32_16x16x32_bf16 v[80:83], a[52:55], v[136:139], v[80:83]
    v_cvt_pk_bf16_f32 v43, v38, v39
    v_fma_f32 v104, -v48, v28, v104
    v_fma_f32 v108, -v52, v28, v108
    v_mfma_f32_16x16x32_bf16 v[64:67], a[68:71], v[140:143], v[64:67]
    v_permlane16_swap_b32 v42, v43
    v_fma_f32 v105, -v48, v29, v105
    v_fma_f32 v109, -v52, v29, v109
    v_mfma_f32_16x16x32_bf16 v[68:71], a[8:11], v[140:143], v[68:71]
    s_waitcnt vmcnt(21)
    v_max3_u32 v16, v176, v180, v184
    v_max_u32 v16, v16, v188
    v_mfma_f32_16x16x32_bf16 v[72:75], a[24:27], v[140:143], v[72:75]
    v_cmp_eq_u32 vcc, -1, v16
    v_mfma_f32_16x16x32_bf16 v[76:79], a[40:43], v[140:143], v[76:79]
    s_waitcnt lgkmcnt(6)
    v_mfma_f32_16x16x32_bf16 v[80:83], a[56:59], v[140:143], v[80:83]
    s_cbranch_vccnz k4_r8
k4_ok8:
    v_mfma_f32_16x16x32_bf16 v[64:67], a[72:75], v[176:179], v[64:67]
    buffer_load_dwordx4 v[196:199], v5, s[64:67], s88 offen offset:2048 sc1
    v_mfma_f32_16x16x32_bf16 v[68:71], a[12:15], v[176:179], v[68:71]
    buffer_store_dwordx2 v[42:43], v9, s[64:67], s42 offen sc1
    v_fma_f32 v106, -v48, v30, v106
    v_fma_f32 v110, -v52, v30, v110
    v_fma_f32 v107, -v48, v31, v107
    v_fma_f32 v111, -v52, v31, v111
    v_mfma_f32_16x16x32_bf16 v[72:75], a[28:31], v[176:179], v[72:75]
    v_mul_f32 v32, v104, v104
    v_mul_f32 v34, v108, v108
    v_mul_f32 v33, v105, v105
    v_mul_f32 v35, v109, v109
    v_mfma_f32_16x16x32_bf16 v[76:79], a[44:47], v[176:179], v[76:79]
    s_waitcnt lgkmcnt(1)
    v_fma_f32 v32, v32, v50, v49
    v_fma_f32 v34, v34, v54, v53
    v_fma_f32 v33, v33, v50, v49
    v_fma_f32 v35, v35, v54, v53
    v_mul_f32 v32, v32, v104
    v_mfma_f32_16x16x32_bf16 v[80:83], a[60:63], v[176:179], v[80:83]
    buffer_load_dwordx4 v[200:203], v5, s[64:67], s89 offen offset:2048 sc1
    v_mul_f32 v34, v34, v108
    v_mul_f32 v33, v33, v105
    v_mfma_f32_16x16x32_bf16 v[64:67], a[76:79], v[180:183], v[64:67]
    v_mul_f32 v35, v35, v109
    v_exp_f32 v32, v32
    v_mfma_f32_16x16x32_bf16 v[68:71], a[80:83], v[180:183], v[68:71]
    v_exp_f32 v34, v34
    v_exp_f32 v33, v33
    v_exp_f32 v35, v35
    v_mfma_f32_16x16x32_bf16 v[72:75], a[96:99], v[180:183], v[72:75]
    v_mul_f32 v104, v104, v106
    v_mul_f32 v108, v108, v110
    v_mul_f32 v105, v105, v107
    v_mul_f32 v109, v109, v111
    v_mfma_f32_16x16x32_bf16 v[76:79], a[112:115], v[180:183], v[76:79]
    s_waitcnt vmcnt(19) lgkmcnt(0)
    v_fma_f32 v32, v32, v51, v51
    v_fma_f32 v34, v34, v55, v55
    v_fma_f32 v33, v33, v51, v51
    v_fma_f32 v35, v35, v55, v55
    v_mfma_f32_16x16x32_bf16 v[80:83], a[128:131], v[180:183], v[80:83]
    buffer_load_dwordx4 v[204:207], v5, s[64:67], s90 offen offset:2048 sc1
    v_rcp_f32 v32, v32
    v_mfma_f32_16x16x32_bf16 v[64:67], a[144:147], v[184:187], v[64:67]
    buffer_load_dwordx4 v[208:211], v5, s[64:67], s91 offen offset:2048 sc1
    v_rcp_f32 v34, v34
    v_mfma_f32_16x16x32_bf16 v[68:71], a[148:151], v[184:187], v[68:71]
    v_rcp_f32 v33, v33
    v_rcp_f32 v35, v35
    v_mfma_f32_16x16x32_bf16 v[72:75], a[88:91], v[184:187], v[72:75]
    s_add_u32 s42, s43, 296960
    v_mul_f32 v32, v32, v104
    v_mul_f32 v34, v34, v108
    v_mul_f32 v33, v33, v105
    v_mul_f32 v35, v35, v109
    v_cvt_pk_bf16_f32 v40, v32, v33
    v_cvt_pk_bf16_f32 v41, v34, v35
    v_mfma_f32_16x16x32_bf16 v[76:79], a[252:255], v[184:187], v[76:79]
    s_waitcnt vmcnt(15)
    v_mfma_f32_16x16x32_bf16 v[80:83], a[0:3], v[184:187], v[80:83]
    v_permlane16_swap_b32 v40, v41
    v_mfma_f32_16x16x32_bf16 v[64:67], a[16:19], v[188:191], v[64:67]
    s_nop 0
    buffer_store_dwordx2 v[40:41], v9, s[64:67], s42 offen sc1
    v_mfma_f32_16x16x32_bf16 v[68:71], a[32:35], v[188:191], v[68:71]
    s_waitcnt vmcnt(12)
    v_max3_u32 v16, v148, v152, v156
    v_max_u32 v16, v16, v160
    v_mfma_f32_16x16x32_bf16 v[72:75], a[48:51], v[188:191], v[72:75]
    v_cmp_eq_u32 vcc, -1, v16
    v_mfma_f32_16x16x32_bf16 v[76:79], a[64:67], v[188:191], v[76:79]
    buffer_load_dwordx4 v[212:215], v6, s[64:67], s88 offen offset:0 sc1
    v_mfma_f32_16x16x32_bf16 v[80:83], a[4:7], v[188:191], v[80:83]
    s_cbranch_vccnz k4_r12
k4_ok12:
    v_mfma_f32_16x16x32_bf16 v[88:91], a[104:107], v[148:151], 0
    v_mfma_f32_16x16x32_bf16 v[92:95], a[120:123], v[148:151], 0
    v_mfma_f32_16x16x32_bf16 v[96:99], a[136:139], v[148:151], 0
    buffer_load_dwordx4 v[216:219], v6, s[64:67], s89 offen offset:0 sc1
    v_mfma_f32_16x16x32_bf16 v[100:103], a[152:155], v[148:151], 0
    ds_write_b128 v56, v[64:67] offset:0
    v_mfma_f32_16x16x32_bf16 v[84:87], a[92:95], v[148:151], 0
    ds_write_b128 v56, v[68:71] offset:1152
    v_mfma_f32_16x16x32_bf16 v[88:91], a[108:111], v[152:155], v[88:91]
    ds_write_b128 v56, v[72:75] offset:2304
    v_mfma_f32_16x16x32_bf16 v[92:95], a[124:127], v[152:155], v[92:95]
    buffer_load_dwordx4 v[220:223], v6, s[64:67], s90 offen offset:0 sc1
    v_mfma_f32_16x16x32_bf16 v[96:99], a[140:143], v[152:155], v[96:99]
    ds_write_b128 v56, v[76:79] offset:3456
    v_mfma_f32_16x16x32_bf16 v[100:103], a[156:159], v[152:155], v[100:103]
    ds_write_b128 v56, v[80:83] offset:4608
    v_cmp_u_f32 s[82:83], v64, v64
    v_mfma_f32_16x16x32_bf16 v[84:87], a[160:163], v[152:155], v[84:87]
    v_mfma_f32_16x16x32_bf16 v[88:91], a[164:167], v[156:159], v[88:91]
    buffer_load_dwordx4 v[144:147], v6, s[64:67], s91 offen offset:0 sc1
    v_mfma_f32_16x16x32_bf16 v[92:95], a[168:171], v[156:159], v[92:95]
    s_and_b64 s[82:83], s[82:83], s[84:85]
    s_cselect_b32 s43, 27262976, s43
    s_waitcnt lgkmcnt(0)
    s_barrier
    v_mfma_f32_16x16x32_bf16 v[96:99], a[172:175], v[156:159], v[96:99]
    ds_read_b128 v[20:23], v57 offset:0
    ds_read_b128 v[24:27], v57 offset:288
    v_mfma_f32_16x16x32_bf16 v[100:103], a[176:179], v[156:159], v[100:103]
    ds_read_b128 v[28:31], v57 offset:5760
    ds_read_b128 v[32:35], v57 offset:6048
    v_mfma_f32_16x16x32_bf16 v[84:87], a[180:183], v[156:159], v[84:87]
    ds_read_b128 v[36:39], v57 offset:11520
    ds_read_b128 v[40:43], v57 offset:11808
    v_mfma_f32_16x16x32_bf16 v[88:91], a[184:187], v[160:163], v[88:91]
    buffer_load_dwordx4 v[224:227], v6, s[64:67], s88 offen offset:1024 sc1
    v_mfma_f32_16x16x32_bf16 v[92:95], a[188:191], v[160:163], v[92:95]
    s_waitcnt vmcnt(11)
    v_max3_u32 v16, v164, v168, v172
    v_max_u32 v16, v16, v192
    v_mfma_f32_16x16x32_bf16 v[96:99], a[192:195], v[160:163], v[96:99]
    v_cmp_eq_u32 vcc, -1, v16
    v_mfma_f32_16x16x32_bf16 v[100:103], a[196:199], v[160:163], v[100:103]
    ds_read_b128 v[44:47], v57 offset:17280
    ds_read_b128 v[48:51], v57 offset:17568
    v_mfma_f32_16x16x32_bf16 v[84:87], a[200:203], v[160:163], v[84:87]
    s_cbranch_vccnz k4_r16
k4_ok16:
    v_mfma_f32_16x16x32_bf16 v[88:91], a[204:207], v[164:167], v[88:91]
    buffer_load_dwordx4 v[228:231], v6, s[64:67], s89 offen offset:1024 sc1
    v_mfma_f32_16x16x32_bf16 v[92:95], a[208:211], v[164:167], v[92:95]
    v_mfma_f32_16x16x32_bf16 v[96:99], a[212:215], v[164:167], v[96:99]
    v_mfma_f32_16x16x32_bf16 v[100:103], a[216:219], v[164:167], v[100:103]
    s_waitcnt lgkmcnt(4)
    v_add_f32 v20, v20, v28
    v_add_f32 v21, v21, v29
    v_add_f32 v22, v22, v30
    v_add_f32 v23, v23, v31
    v_mfma_f32_16x16x32_bf16 v[84:87], a[220:223], v[164:167], v[84:87]
    v_add_f32 v24, v24, v32
    v_add_f32 v25, v25, v33
    v_mfma_f32_16x16x32_bf16 v[88:91], a[224:227], v[168:171], v[88:91]
    buffer_load_dwordx4 v[232:235], v6, s[64:67], s90 offen offset:1024 sc1
    v_mfma_f32_16x16x32_bf16 v[92:95], a[228:231], v[168:171], v[92:95]
    s_waitcnt lgkmcnt(0)
    v_add_f32 v26, v26, v34
    v_add_f32 v27, v27, v35
    v_mfma_f32_16x16x32_bf16 v[96:99], a[232:235], v[168:171], v[96:99]
    v_add_f32 v36, v36, v44
    v_add_f32 v37, v37, v45
    v_mfma_f32_16x16x32_bf16 v[100:103], a[236:239], v[168:171], v[100:103]
    s_add_u32 s44, s45, 40960
    v_add_f32 v38, v38, v46
    v_add_f32 v39, v39, v47
    v_add_f32 v40, v40, v48
    v_mfma_f32_16x16x32_bf16 v[84:87], a[240:243], v[168:171], v[84:87]
    buffer_load_dwordx4 v[52:55], v58, s[64:67], s44 offen sc1
    v_mfma_f32_16x16x32_bf16 v[88:91], a[244:247], v[172:175], v[88:91]
    buffer_load_dwordx4 v[236:239], v6, s[64:67], s91 offen offset:1024 sc1
    v_mfma_f32_16x16x32_bf16 v[92:95], a[248:251], v[172:175], v[92:95]
    v_add_f32 v41, v41, v49
    v_add_f32 v42, v42, v50
    v_mfma_f32_16x16x32_bf16 v[96:99], a[20:23], v[172:175], v[96:99]
    v_add_f32 v43, v43, v51
    v_add_f32 v20, v20, v36
    v_mfma_f32_16x16x32_bf16 v[100:103], a[36:39], v[172:175], v[100:103]
    v_add_f32 v21, v21, v37
    v_add_f32 v22, v22, v38
    v_mfma_f32_16x16x32_bf16 v[84:87], a[52:55], v[172:175], v[84:87]
    v_add_f32 v23, v23, v39
    v_add_f32 v24, v24, v40
    v_add_f32 v25, v25, v41
    v_mfma_f32_16x16x32_bf16 v[88:91], a[68:71], v[192:195], v[88:91]
    v_add_f32 v26, v26, v42
    v_add_f32 v27, v27, v43
    v_mfma_f32_16x16x32_bf16 v[92:95], a[8:11], v[192:195], v[92:95]
    s_waitcnt vmcnt(10)
    v_max3_u32 v16, v196, v200, v204
    v_max_u32 v16, v16, v208
    v_mfma_f32_16x16x32_bf16 v[96:99], a[24:27], v[192:195], v[96:99]
    v_cmp_eq_u32 vcc, -1, v16
    v_cvt_pk_bf16_f32 v28, v20, v21
    v_mfma_f32_16x16x32_bf16 v[100:103], a[40:43], v[192:195], v[100:103]
    buffer_load_dwordx4 v[240:243], v6, s[64:67], s88 offen offset:2048 sc1
    v_mfma_f32_16x16x32_bf16 v[84:87], a[56:59], v[192:195], v[84:87]
    s_cbranch_vccnz k4_r20
k4_ok20:
    v_mfma_f32_16x16x32_bf16 v[88:91], a[72:75], v[196:199], v[88:91]
    v_cvt_pk_bf16_f32 v29, v22, v23
    v_cvt_pk_bf16_f32 v30, v24, v25
    v_cvt_pk_bf16_f32 v31, v26, v27
    v_mfma_f32_16x16x32_bf16 v[92:95], a[12:15], v[196:199], v[92:95]
    s_waitcnt vmcnt(17)
    v_lshlrev_b32 v36, 16, v60
    v_and_b32 v37, 0xffff0000, v60
    v_mfma_f32_16x16x32_bf16 v[96:99], a[28:31], v[196:199], v[96:99]
    v_lshlrev_b32 v38, 16, v61
    v_and_b32 v39, 0xffff0000, v61
    v_mfma_f32_16x16x32_bf16 v[100:103], a[44:47], v[196:199], v[100:103]
    buffer_load_dwordx4 v[244:247], v6, s[64:67], s89 offen offset:2048 sc1
    v_mfma_f32_16x16x32_bf16 v[84:87], a[60:63], v[196:199], v[84:87]
    v_lshlrev_b32 v40, 16, v62
    v_and_b32 v41, 0xffff0000, v62
    v_mfma_f32_16x16x32_bf16 v[88:91], a[76:79], v[200:203], v[88:91]
    v_lshlrev_b32 v42, 16, v63
    v_and_b32 v43, 0xffff0000, v63
    v_lshlrev_b32 v20, 16, v28
    v_mfma_f32_16x16x32_bf16 v[92:95], a[80:83], v[200:203], v[92:95]
    v_and_b32 v21, 0xffff0000, v28
    v_lshlrev_b32 v22, 16, v29
    v_mfma_f32_16x16x32_bf16 v[96:99], a[96:99], v[200:203], v[96:99]
    buffer_load_dwordx4 v[248:251], v6, s[64:67], s90 offen offset:2048 sc1
    v_mfma_f32_16x16x32_bf16 v[100:103], a[112:115], v[200:203], v[100:103]
    v_and_b32 v23, 0xffff0000, v29
    v_lshlrev_b32 v24, 16, v30
    v_mfma_f32_16x16x32_bf16 v[84:87], a[128:131], v[200:203], v[84:87]
    v_and_b32 v25, 0xffff0000, v30
    v_lshlrev_b32 v26, 16, v31
    v_mfma_f32_16x16x32_bf16 v[88:91], a[144:147], v[204:207], v[88:91]
    buffer_load_dwordx4 v[252:255], v6, s[64:67], s91 offen offset:2048 sc1
    v_and_b32 v27, 0xffff0000, v31
    v_mfma_f32_16x16x32_bf16 v[92:95], a[148:151], v[204:207], v[92:95]
    s_add_u32 s42, s46, 0
    v_add_f32 v20, v20, v36
    v_add_f32 v21, v21, v37
    v_mfma_f32_16x16x32_bf16 v[96:99], a[88:91], v[204:207], v[96:99]
    v_add_f32 v22, v22, v38
    v_add_f32 v23, v23, v39
    v_mfma_f32_16x16x32_bf16 v[100:103], a[252:255], v[204:207], v[100:103]
    v_add_f32 v24, v24, v40
    v_add_f32 v25, v25, v41
    v_mfma_f32_16x16x32_bf16 v[84:87], a[0:3], v[204:207], v[84:87]
    v_add_f32 v26, v26, v42
    v_add_f32 v27, v27, v43
    v_mfma_f32_16x16x32_bf16 v[88:91], a[16:19], v[208:211], v[88:91]
    v_cvt_pk_bf16_f32 v44, v20, v21
    v_cvt_pk_bf16_f32 v45, v22, v23
    v_mfma_f32_16x16x32_bf16 v[92:95], a[32:35], v[208:211], v[92:95]
    s_waitcnt vmcnt(9)
    v_max3_u32 v16, v212, v216, v220
    v_max_u32 v16, v16, v144
    v_cvt_pk_bf16_f32 v46, v24, v25
    v_mfma_f32_16x16x32_bf16 v[96:99], a[48:51], v[208:211], v[96:99]
    v_cmp_eq_u32 vcc, -1, v16
    v_cvt_pk_bf16_f32 v47, v26, v27
    v_mfma_f32_16x16x32_bf16 v[100:103], a[64:67], v[208:211], v[100:103]
    buffer_store_dwordx4 v[44:47], v59, s[24:27], s42 offen sc1
    v_mfma_f32_16x16x32_bf16 v[84:87], a[4:7], v[208:211], v[84:87]
    s_cbranch_vccnz k4_r24
k4_ok24:
    v_mfma_f32_16x16x32_bf16 v[64:67], a[104:107], v[212:215], 0
    s_add_u32 s44, s45, 81920
    v_mfma_f32_16x16x32_bf16 v[68:71], a[120:123], v[212:215], 0
    buffer_load_dwordx4 v[60:63], v58, s[64:67], s44 offen sc1
    v_mfma_f32_16x16x32_bf16 v[72:75], a[136:139], v[212:215], 0
    ds_write_b128 v56, v[88:91] offset:23040
    v_mfma_f32_16x16x32_bf16 v[76:79], a[152:155], v[212:215], 0
    ds_write_b128 v56, v[92:95] offset:24192
    v_mfma_f32_16x16x32_bf16 v[80:83], a[92:95], v[212:215], 0
    ds_write_b128 v56, v[96:99] offset:25344
    v_mfma_f32_16x16x32_bf16 v[64:67], a[108:111], v[216:219], v[64:67]
    ds_write_b128 v56, v[100:103] offset:26496
    v_mfma_f32_16x16x32_bf16 v[68:71], a[124:127], v[216:219], v[68:71]
    ds_write_b128 v56, v[84:87] offset:27648
    v_cmp_u_f32 s[82:83], v88, v88
    v_mfma_f32_16x16x32_bf16 v[72:75], a[140:143], v[216:219], v[72:75]
    v_mfma_f32_16x16x32_bf16 v[76:79], a[156:159], v[216:219], v[76:79]
    v_mfma_f32_16x16x32_bf16 v[80:83], a[160:163], v[216:219], v[80:83]
    s_and_b64 s[82:83], s[82:83], s[84:85]
    s_cselect_b32 s43, 27262976, s43
    s_waitcnt lgkmcnt(0)
    s_barrier
    v_mfma_f32_16x16x32_bf16 v[64:67], a[164:167], v[220:223], v[64:67]
    buffer_load_dwordx4 v[112:115], v7, s[64:67], s88 offen offset:0 sc1
    v_mfma_f32_16x16x32_bf16 v[68:71], a[168:171], v[220:223], v[68:71]
    buffer_load_dwordx4 v[116:119], v7, s[64:67], s89 offen offset:0 sc1
    ds_read_b128 v[20:23], v57 offset:23040
    v_mfma_f32_16x16x32_bf16 v[72:75], a[172:175], v[220:223], v[72:75]
    buffer_load_dwordx4 v[120:123], v7, s[64:67], s90 offen offset:0 sc1
    v_mfma_f32_16x16x32_bf16 v[76:79], a[176:179], v[220:223], v[76:79]
    buffer_load_dwordx4 v[124:127], v7, s[64:67], s91 offen offset:0 sc1
    v_mfma_f32_16x16x32_bf16 v[80:83], a[180:183], v[220:223], v[80:83]
    ds_read_b128 v[24:27], v57 offset:23328
    ds_read_b128 v[28:31], v57 offset:28800
    v_mfma_f32_16x16x32_bf16 v[64:67], a[184:187], v[144:147], v[64:67]
    ds_read_b128 v[32:35], v57 offset:29088
    ds_read_b128 v[36:39], v57 offset:34560
    ds_read_b128 v[40:43], v57 offset:34848
    v_mfma_f32_16x16x32_bf16 v[68:71], a[188:191], v[144:147], v[68:71]
    s_waitcnt vmcnt(10)
    v_max3_u32 v16, v224, v228, v232
    v_max_u32 v16, v16, v236
    v_mfma_f32_16x16x32_bf16 v[72:75], a[192:195], v[144:147], v[72:75]
    v_cmp_eq_u32 vcc, -1, v16
    v_mfma_f32_16x16x32_bf16 v[76:79], a[196:199], v[144:147], v[76:79]
    ds_read_b128 v[44:47], v57 offset:40320
    ds_read_b128 v[48:51], v57 offset:40608
    v_mfma_f32_16x16x32_bf16 v[80:83], a[200:203], v[144:147], v[80:83]
    s_cbranch_vccnz k4_r28
k4_ok28:
    v_mfma_f32_16x16x32_bf16 v[64:67], a[204:207], v[224:227], v[64:67]
    v_mfma_f32_16x16x32_bf16 v[68:71], a[208:211], v[224:227], v[68:71]
    v_mfma_f32_16x16x32_bf16 v[72:75], a[212:215], v[224:227], v[72:75]
    v_mfma_f32_16x16x32_bf16 v[76:79], a[216:219], v[224:227], v[76:79]
    s_waitcnt lgkmcnt(4)
    v_add_f32 v20, v20, v28
    v_add_f32 v21, v21, v29
    v_add_f32 v22, v22, v30
    v_add_f32 v23, v23, v31
    v_mfma_f32_16x16x32_bf16 v[80:83], a[220:223], v[224:227], v[80:83]
    v_add_f32 v24, v24, v32
    v_add_f32 v25, v25, v33
    v_mfma_f32_16x16x32_bf16 v[64:67], a[224:227], v[228:231], v[64:67]
    buffer_load_dwordx4 v[128:131], v7, s[64:67], s88 offen offset:1024 sc1
    v_mfma_f32_16x16x32_bf16 v[68:71], a[228:231], v[228:231], v[68:71]
    s_waitcnt lgkmcnt(0)
    v_add_f32 v26, v26, v34
    v_add_f32 v27, v27, v35
    v_add_f32 v36, v36, v44
    v_mfma_f32_16x16x32_bf16 v[72:75], a[232:235], v[228:231], v[72:75]
    v_add_f32 v37, v37, v45
    v_add_f32 v38, v38, v46
    v_mfma_f32_16x16x32_bf16 v[76:79], a[236:239], v[228:231], v[76:79]
    buffer_load_dwordx4 v[132:135], v7, s[64:67], s89 offen offset:1024 sc1
    v_mfma_f32_16x16x32_bf16 v[80:83], a[240:243], v[228:231], v[80:83]
    buffer_load_dwordx4 v[136:139], v7, s[64:67], s90 offen offset:1024 sc1
    v_mfma_f32_16x16x32_bf16 v[64:67], a[244:247], v[232:235], v[64:67]
    buffer_load_dwordx4 v[140:143], v7, s[64:67], s91 offen offset:1024 sc1
    v_add_f32 v39, v39, v47
    v_mfma_f32_16x16x32_bf16 v[68:71], a[248:251], v[232:235], v[68:71]
    v_add_f32 v40, v40, v48
    v_add_f32 v41, v41, v49
    v_mfma_f32_16x16x32_bf16 v[72:75], a[20:23], v[232:235], v[72:75]
    v_add_f32 v42, v42, v50
    v_add_f32 v43, v43, v51
    v_mfma_f32_16x16x32_bf16 v[76:79], a[36:39], v[232:235], v[76:79]
    v_add_f32 v20, v20, v36
    v_add_f32 v21, v21, v37
    v_mfma_f32_16x16x32_bf16 v[80:83], a[52:55], v[232:235], v[80:83]
    v_add_f32 v22, v22, v38
    v_add_f32 v23, v23, v39
    v_add_f32 v24, v24, v40
    v_mfma_f32_16x16x32_bf16 v[64:67], a[68:71], v[236:239], v[64:67]
    v_add_f32 v25, v25, v41
    v_add_f32 v26, v26, v42
    v_mfma_f32_16x16x32_bf16 v[68:71], a[8:11], v[236:239], v[68:71]
    s_waitcnt vmcnt(10)
    v_max3_u32 v16, v240, v244, v248
    v_max_u32 v16, v16, v252
    v_mfma_f32_16x16x32_bf16 v[72:75], a[24:27], v[236:239], v[72:75]
    v_cmp_eq_u32 vcc, -1, v16
    v_add_f32 v27, v27, v43
    v_mfma_f32_16x16x32_bf16 v[76:79], a[40:43], v[236:239], v[76:79]
    v_cvt_pk_bf16_f32 v28, v20, v21
    v_cvt_pk_bf16_f32 v29, v22, v23
    v_cvt_pk_bf16_f32 v30, v24, v25
    v_mfma_f32_16x16x32_bf16 v[80:83], a[56:59], v[236:239], v[80:83]
    s_cbranch_vccnz k4_r32
k4_ok32:
    v_mfma_f32_16x16x32_bf16 v[64:67], a[72:75], v[240:243], v[64:67]
    s_waitcnt vmcnt(15)
    v_cvt_pk_bf16_f32 v31, v26, v27
    v_lshlrev_b32 v36, 16, v52
    v_mfma_f32_16x16x32_bf16 v[68:71], a[12:15], v[240:243], v[68:71]
    v_and_b32 v37, 0xffff0000, v52
    v_lshlrev_b32 v38, 16, v53
    v_mfma_f32_16x16x32_bf16 v[72:75], a[28:31], v[240:243], v[72:75]
    v_and_b32 v39, 0xffff0000, v53
    v_lshlrev_b32 v40, 16, v54
    v_and_b32 v41, 0xffff0000, v54
    v_mfma_f32_16x16x32_bf16 v[76:79], a[44:47], v[240:243], v[76:79]
    v_lshlrev_b32 v42, 16, v55
    v_and_b32 v43, 0xffff0000, v55
    v_mfma_f32_16x16x32_bf16 v[80:83], a[60:63], v[240:243], v[80:83]
    buffer_load_dwordx4 v[176:179], v7, s[64:67], s88 offen offset:2048 sc1
    v_mfma_f32_16x16x32_bf16 v[64:67], a[76:79], v[244:247], v[64:67]
    v_lshlrev_b32 v20, 16, v28
    v_and_b32 v21, 0xffff0000, v28
    v_mfma_f32_16x16x32_bf16 v[68:71], a[80:83], v[244:247], v[68:71]
    v_lshlrev_b32 v22, 16, v29
    v_and_b32 v23, 0xffff0000, v29
    v_lshlrev_b32 v24, 16, v30
    v_mfma_f32_16x16x32_bf16 v[72:75], a[96:99], v[244:247], v[72:75]
    v_and_b32 v25, 0xffff0000, v30
    v_lshlrev_b32 v26, 16, v31
    v_mfma_f32_16x16x32_bf16 v[76:79], a[112:115], v[244:247], v[76:79]
    buffer_load_dwordx4 v[180:183], v7, s[64:67], s89 offen offset:2048 sc1
    v_mfma_f32_16x16x32_bf16 v[80:83], a[128:131], v[244:247], v[80:83]
    buffer_load_dwordx4 v[184:187], v7, s[64:67], s90 offen offset:2048 sc1
    v_and_b32 v27, 0xffff0000, v31
    v_mfma_f32_16x16x32_bf16 v[64:67], a[144:147], v[248:251], v[64:67]
    buffer_load_dwordx4 v[188:191], v7, s[64:67], s91 offen offset:2048 sc1
    v_mfma_f32_16x16x32_bf16 v[68:71], a[148:151], v[248:251], v[68:71]
    s_add_u32 s42, s46, 40960
    v_add_f32 v20, v20, v36
    v_add_f32 v21, v21, v37
    v_mfma_f32_16x16x32_bf16 v[72:75], a[88:91], v[248:251], v[72:75]
    v_add_f32 v22, v22, v38
    v_add_f32 v23, v23, v39
    v_mfma_f32_16x16x32_bf16 v[76:79], a[252:255], v[248:251], v[76:79]
    v_add_f32 v24, v24, v40
    v_add_f32 v25, v25, v41
    v_add_f32 v26, v26, v42
    v_mfma_f32_16x16x32_bf16 v[80:83], a[0:3], v[248:251], v[80:83]
    v_add_f32 v27, v27, v43
    v_cvt_pk_bf16_f32 v44, v20, v21
    v_mfma_f32_16x16x32_bf16 v[64:67], a[16:19], v[252:255], v[64:67]
    v_cvt_pk_bf16_f32 v45, v22, v23
    v_cvt_pk_bf16_f32 v46, v24, v25
    v_mfma_f32_16x16x32_bf16 v[68:71], a[32:35], v[252:255], v[68:71]
    s_waitcnt vmcnt(8)
    v_max3_u32 v16, v112, v116, v120
    v_max_u32 v16, v16, v124
    v_mfma_f32_16x16x32_bf16 v[72:75], a[48:51], v[252:255], v[72:75]
    v_cmp_eq_u32 vcc, -1, v16
    v_cvt_pk_bf16_f32 v47, v26, v27
    v_mfma_f32_16x16x32_bf16 v[76:79], a[64:67], v[252:255], v[76:79]
    buffer_store_dwordx4 v[44:47], v59, s[24:27], s42 offen sc1
    v_mfma_f32_16x16x32_bf16 v[80:83], a[4:7], v[252:255], v[80:83]
    s_cbranch_vccnz k4_r36
k4_ok36:
    v_mfma_f32_16x16x32_bf16 v[88:91], a[104:107], v[112:115], 0
    v_mfma_f32_16x16x32_bf16 v[92:95], a[120:123], v[112:115], 0
    s_add_u32 s44, s45, 122880
    v_mfma_f32_16x16x32_bf16 v[96:99], a[136:139], v[112:115], 0
    buffer_load_dwordx4 v[52:55], v58, s[64:67], s44 offen sc1
    v_mfma_f32_16x16x32_bf16 v[100:103], a[152:155], v[112:115], 0
    ds_write_b128 v56, v[64:67] offset:0
    v_mfma_f32_16x16x32_bf16 v[84:87], a[92:95], v[112:115], 0
    ds_write_b128 v56, v[68:71] offset:1152
    v_mfma_f32_16x16x32_bf16 v[88:91], a[108:111], v[116:119], v[88:91]
    ds_write_b128 v56, v[72:75] offset:2304
    v_mfma_f32_16x16x32_bf16 v[92:95], a[124:127], v[116:119], v[92:95]
    ds_write_b128 v56, v[76:79] offset:3456
    v_mfma_f32_16x16x32_bf16 v[96:99], a[140:143], v[116:119], v[96:99]
    ds_write_b128 v56, v[80:83] offset:4608
    v_mfma_f32_16x16x32_bf16 v[100:103], a[156:159], v[116:119], v[100:103]
    v_cmp_u_f32 s[82:83], v64, v64
    v_mfma_f32_16x16x32_bf16 v[84:87], a[160:163], v[116:119], v[84:87]
    v_mfma_f32_16x16x32_bf16 v[88:91], a[164:167], v[120:123], v[88:91]
    v_mfma_f32_16x16x32_bf16 v[92:95], a[168:171], v[120:123], v[92:95]
    s_and_b64 s[82:83], s[82:83], s[84:85]
    s_cselect_b32 s43, 27262976, s43
    s_waitcnt lgkmcnt(0)
    v_mfma_f32_16x16x32_bf16 v[96:99], a[172:175], v[120:123], v[96:99]
    s_barrier
    ds_read_b128 v[20:23], v57 offset:0
    ds_read_b128 v[24:27], v57 offset:288
    v_mfma_f32_16x16x32_bf16 v[100:103], a[176:179], v[120:123], v[100:103]
    ds_read_b128 v[28:31], v57 offset:5760
    ds_read_b128 v[32:35], v57 offset:6048
    v_mfma_f32_16x16x32_bf16 v[84:87], a[180:183], v[120:123], v[84:87]
    ds_read_b128 v[36:39], v57 offset:11520
    ds_read_b128 v[40:43], v57 offset:11808
    v_mfma_f32_16x16x32_bf16 v[88:91], a[184:187], v[124:127], v[88:91]
    ds_read_b128 v[44:47], v57 offset:17280
    ds_read_b128 v[48:51], v57 offset:17568
    v_mfma_f32_16x16x32_bf16 v[92:95], a[188:191], v[124:127], v[92:95]
    s_waitcnt vmcnt(6)
    v_max3_u32 v16, v128, v132, v136
    v_max_u32 v16, v16, v140
    v_mfma_f32_16x16x32_bf16 v[96:99], a[192:195], v[124:127], v[96:99]
    v_cmp_eq_u32 vcc, -1, v16
    v_mfma_f32_16x16x32_bf16 v[100:103], a[196:199], v[124:127], v[100:103]
    v_mfma_f32_16x16x32_bf16 v[84:87], a[200:203], v[124:127], v[84:87]
    s_cbranch_vccnz k4_r40
k4_ok40:
    v_mfma_f32_16x16x32_bf16 v[88:91], a[204:207], v[128:131], v[88:91]
    s_waitcnt lgkmcnt(4)
    v_add_f32 v20, v20, v28
    v_add_f32 v21, v21, v29
    v_mfma_f32_16x16x32_bf16 v[92:95], a[208:211], v[128:131], v[92:95]
    v_add_f32 v22, v22, v30
    v_add_f32 v23, v23, v31
    v_mfma_f32_16x16x32_bf16 v[96:99], a[212:215], v[128:131], v[96:99]
    v_add_f32 v24, v24, v32
    v_add_f32 v25, v25, v33
    v_mfma_f32_16x16x32_bf16 v[100:103], a[216:219], v[128:131], v[100:103]
    s_waitcnt lgkmcnt(0)
    v_add_f32 v26, v26, v34
    v_add_f32 v27, v27, v35
    v_mfma_f32_16x16x32_bf16 v[84:87], a[220:223], v[128:131], v[84:87]
    v_add_f32 v36, v36, v44
    v_add_f32 v37, v37, v45
    v_mfma_f32_16x16x32_bf16 v[88:91], a[224:227], v[132:135], v[88:91]
    v_add_f32 v38, v38, v46
    v_add_f32 v39, v39, v47
    v_mfma_f32_16x16x32_bf16 v[92:95], a[228:231], v[132:135], v[92:95]
    v_add_f32 v40, v40, v48
    v_add_f32 v41, v41, v49
    v_mfma_f32_16x16x32_bf16 v[96:99], a[232:235], v[132:135], v[96:99]
    v_add_f32 v42, v42, v50
    v_add_f32 v43, v43, v51
    v_mfma_f32_16x16x32_bf16 v[100:103], a[236:239], v[132:135], v[100:103]
    v_add_f32 v20, v20, v36
    v_add_f32 v21, v21, v37
    v_mfma_f32_16x16x32_bf16 v[84:87], a[240:243], v[132:135], v[84:87]
    v_add_f32 v22, v22, v38
    v_add_f32 v23, v23, v39
    v_mfma_f32_16x16x32_bf16 v[88:91], a[244:247], v[136:139], v[88:91]
    v_add_f32 v24, v24, v40
    v_add_f32 v25, v25, v41
    v_mfma_f32_16x16x32_bf16 v[92:95], a[248:251], v[136:139], v[92:95]
    v_add_f32 v26, v26, v42
    v_add_f32 v27, v27, v43
    v_mfma_f32_16x16x32_bf16 v[96:99], a[20:23], v[136:139], v[96:99]
    v_cvt_pk_bf16_f32 v28, v20, v21
    v_cvt_pk_bf16_f32 v29, v22, v23
    v_mfma_f32_16x16x32_bf16 v[100:103], a[36:39], v[136:139], v[100:103]
    s_waitcnt vmcnt(14)
    v_cvt_pk_bf16_f32 v30, v24, v25
    v_cvt_pk_bf16_f32 v31, v26, v27
    v_mfma_f32_16x16x32_bf16 v[84:87], a[52:55], v[136:139], v[84:87]
    v_lshlrev_b32 v36, 16, v60
    v_and_b32 v37, 0xffff0000, v60
    v_mfma_f32_16x16x32_bf16 v[88:91], a[68:71], v[140:143], v[88:91]
    v_lshlrev_b32 v38, 16, v61
    v_and_b32 v39, 0xffff0000, v61
    v_mfma_f32_16x16x32_bf16 v[92:95], a[8:11], v[140:143], v[92:95]
    s_waitcnt vmcnt(2)
    v_max3_u32 v16, v176, v180, v184
    v_max_u32 v16, v16, v188
    v_mfma_f32_16x16x32_bf16 v[96:99], a[24:27], v[140:143], v[96:99]
    v_cmp_eq_u32 vcc, -1, v16
    v_lshlrev_b32 v40, 16, v62
    v_mfma_f32_16x16x32_bf16 v[100:103], a[40:43], v[140:143], v[100:103]
    v_and_b32 v41, 0xffff0000, v62
    v_lshlrev_b32 v42, 16, v63
    v_mfma_f32_16x16x32_bf16 v[84:87], a[56:59], v[140:143], v[84:87]
    s_cbranch_vccnz k4_r44
k4_ok44:
    v_mfma_f32_16x16x32_bf16 v[88:91], a[72:75], v[176:179], v[88:91]
    v_and_b32 v43, 0xffff0000, v63
    v_lshlrev_b32 v20, 16, v28
    v_mfma_f32_16x16x32_bf16 v[92:95], a[12:15], v[176:179], v[92:95]
    v_and_b32 v21, 0xffff0000, v28
    v_lshlrev_b32 v22, 16, v29
    v_mfma_f32_16x16x32_bf16 v[96:99], a[28:31], v[176:179], v[96:99]
    v_and_b32 v23, 0xffff0000, v29
    v_lshlrev_b32 v24, 16, v30
    v_mfma_f32_16x16x32_bf16 v[100:103], a[44:47], v[176:179], v[100:103]
    v_and_b32 v25, 0xffff0000, v30
    v_lshlrev_b32 v26, 16, v31
    v_mfma_f32_16x16x32_bf16 v[84:87], a[60:63], v[176:179], v[84:87]
    s_add_u32 s42, s46, 81920
    v_and_b32 v27, 0xffff0000, v31
    v_add_f32 v20, v20, v36
    v_mfma_f32_16x16x32_bf16 v[88:91], a[76:79], v[180:183], v[88:91]
    v_add_f32 v21, v21, v37
    v_add_f32 v22, v22, v38
    v_mfma_f32_16x16x32_bf16 v[92:95], a[80:83], v[180:183], v[92:95]
    v_add_f32 v23, v23, v39
    v_add_f32 v24, v24, v40
    v_mfma_f32_16x16x32_bf16 v[96:99], a[96:99], v[180:183], v[96:99]
    v_add_f32 v25, v25, v41
    v_add_f32 v26, v26, v42
    v_mfma_f32_16x16x32_bf16 v[100:103], a[112:115], v[180:183], v[100:103]
    v_add_f32 v27, v27, v43
    v_cvt_pk_bf16_f32 v44, v20, v21
    v_mfma_f32_16x16x32_bf16 v[84:87], a[128:131], v[180:183], v[84:87]
    v_cvt_pk_bf16_f32 v45, v22, v23
    v_cvt_pk_bf16_f32 v46, v24, v25
    v_mfma_f32_16x16x32_bf16 v[88:91], a[144:147], v[184:187], v[88:91]
    v_cvt_pk_bf16_f32 v47, v26, v27
    v_mfma_f32_16x16x32_bf16 v[92:95], a[148:151], v[184:187], v[92:95]
    buffer_store_dwordx4 v[44:47], v59, s[24:27], s42 offen sc1
    v_mfma_f32_16x16x32_bf16 v[96:99], a[88:91], v[184:187], v[96:99]
    s_lshl_b32 s22, s16, 2
    s_add_u32 s22, s22, 46080
    v_mov_b32 v18, s22
    v_mfma_f32_16x16x32_bf16 v[100:103], a[252:255], v[184:187], v[100:103]
    v_mov_b32 v19, 46080
    v_mfma_f32_16x16x32_bf16 v[84:87], a[0:3], v[184:187], v[84:87]
    v_mfma_f32_16x16x32_bf16 v[88:91], a[16:19], v[188:191], v[88:91]
    v_mfma_f32_16x16x32_bf16 v[92:95], a[32:35], v[188:191], v[92:95]
    v_mfma_f32_16x16x32_bf16 v[96:99], a[48:51], v[188:191], v[96:99]
    v_mfma_f32_16x16x32_bf16 v[100:103], a[64:67], v[188:191], v[100:103]
    v_mfma_f32_16x16x32_bf16 v[84:87], a[4:7], v[188:191], v[84:87]
    s_nop 7
    s_nop 3
    v_cmp_u_f32 s[82:83], v88, v88
    ds_write_b128 v56, v[88:91] offset:23040
    ds_write_b128 v56, v[92:95] offset:24192
    ds_write_b128 v56, v[96:99] offset:25344
    ds_write_b128 v56, v[100:103] offset:26496
    ds_write_b128 v56, v[84:87] offset:27648
    s_and_b64 s[82:83], s[82:83], s[84:85]
    s_cselect_b32 s43, 27262976, s43
    s_cmp_eq_u32 s43, 27262976
    s_cselect_b32 s22, 1, 0
    s_or_b32 s22, s22, s71
    v_mov_b32 v16, s22
    ds_write_b32 v18, v16
    s_waitcnt lgkmcnt(0)
    s_barrier
    ds_read_b128 v[20:23], v57 offset:23040
    ds_read_b128 v[24:27], v57 offset:23328
    ds_read_b128 v[28:31], v57 offset:28800
    ds_read_b128 v[32:35], v57 offset:29088
    ds_read_b128 v[36:39], v57 offset:34560
    ds_read_b128 v[40:43], v57 offset:34848
    ds_read_b128 v[44:47], v57 offset:40320
    ds_read_b128 v[48:51], v57 offset:40608
    ds_read_b128 v[60:63], v19
    s_waitcnt lgkmcnt(5)
    v_pk_add_f32 v[20:21], v[20:21], v[28:29]
    v_pk_add_f32 v[22:23], v[22:23], v[30:31]
    v_pk_add_f32 v[24:25], v[24:25], v[32:33]
    v_pk_add_f32 v[26:27], v[26:27], v[34:35]
    s_waitcnt lgkmcnt(1)
    v_pk_add_f32 v[36:37], v[36:37], v[44:45]
    v_pk_add_f32 v[38:39], v[38:39], v[46:47]
    v_pk_add_f32 v[40:41], v[40:41], v[48:49]
    v_pk_add_f32 v[42:43], v[42:43], v[50:51]
    v_pk_add_f32 v[20:21], v[20:21], v[36:37]
    v_pk_add_f32 v[22:23], v[22:23], v[38:39]
    v_pk_add_f32 v[24:25], v[24:25], v[40:41]
    v_pk_add_f32 v[26:27], v[26:27], v[42:43]
    v_cvt_pk_bf16_f32 v28, v20, v21
    v_cvt_pk_bf16_f32 v29, v22, v23
    v_cvt_pk_bf16_f32 v30, v24, v25
    v_cvt_pk_bf16_f32 v31, v26, v27
    s_waitcnt vmcnt(1)
    v_lshlrev_b32 v36, 16, v52
    v_and_b32 v37, 0xffff0000, v52
    v_lshlrev_b32 v38, 16, v53
    v_and_b32 v39, 0xffff0000, v53
    v_lshlrev_b32 v40, 16, v54
    v_and_b32 v41, 0xffff0000, v54
    v_lshlrev_b32 v42, 16, v55
    v_and_b32 v43, 0xffff0000, v55
    v_lshlrev_b32 v20, 16, v28
    v_and_b32 v21, 0xffff0000, v28
    v_lshlrev_b32 v22, 16, v29
    v_and_b32 v23, 0xffff0000, v29
    v_lshlrev_b32 v24, 16, v30
    v_and_b32 v25, 0xffff0000, v30
    v_lshlrev_b32 v26, 16, v31
    v_and_b32 v27, 0xffff0000, v31
    s_add_u32 s42, s46, 122880
    v_pk_add_f32 v[20:21], v[20:21], v[36:37]
    v_pk_add_f32 v[22:23], v[22:23], v[38:39]
    v_pk_add_f32 v[24:25], v[24:25], v[40:41]
    v_pk_add_f32 v[26:27], v[26:27], v[42:43]
    v_cvt_pk_bf16_f32 v44, v20, v21
    v_cvt_pk_bf16_f32 v45, v22, v23
    v_cvt_pk_bf16_f32 v46, v24, v25
    v_cvt_pk_bf16_f32 v47, v26, v27
    buffer_store_dwordx4 v[44:47], v59, s[24:27], s42 offen sc1
    s_waitcnt lgkmcnt(0)
    v_or3_b32 v60, v60, v61, v62
    v_or_b32 v60, v60, v63
    s_nop 0
    v_readfirstlane_b32 s22, v60
    s_or_b32 s23, s22, s70
    s_cbranch_scc1 kf_more
kf_fin:
kf_end:
    s_endpgm
kf_cold:
k2_retry:
    s_cmp_lg_u32 s70, 0
    s_cbranch_scc1 k2_own
k2_retryl:
    s_cmp_eq_u32 s69, 0
    s_cbranch_scc1 k2_retryf
    s_sub_u32 s69, s69, 1
    buffer_load_dwordx4 v[72:75], v8, s[64:67], s68 offen offset:0 sc1
    buffer_load_dwordx4 v[76:79], v8, s[64:67], s68 offen offset:1024 sc1
    buffer_load_dwordx2 v[80:81], v7, s[64:67], s68 offen offset:2048 sc1
    s_waitcnt vmcnt(0)
    v_max3_u32 v232, v72, v73, v74
    v_max3_u32 v233, v75, v76, v77
    v_max3_u32 v234, v78, v79, v80
    v_max3_u32 v232, v232, v233, v81
    v_max_u32 v232, v232, v234
    v_cmp_eq_u32 vcc, -1, v232
    s_cbranch_vccnz k2_retryl
    s_cmp_gt_u32 s69, 396
    s_cbranch_scc1 k2_own
    buffer_store_dwordx4 v[16:19], v8, s[64:67], s63 offen offset:0 sc1
    buffer_store_dwordx4 v[20:23], v8, s[64:67], s63 offen offset:1024 sc1
    buffer_store_dwordx2 v[24:25], v7, s[64:67], s63 offen offset:2048 sc1
    s_branch k2_own
k2_retryf:
    s_cmp_eq_u32 s71, 0
    s_cselect_b32 s71, 2, s71
    s_waitcnt vmcnt(0)
    s_branch k2_skip
kf_gr:
    s_cmp_lg_u32 s70, 0
    s_cbranch_scc1 kf_gok
kf_grl:
    s_cmp_eq_u32 s69, 0
    s_cbranch_scc1 kf_grf
    s_sub_u32 s69, s69, 1
    buffer_load_dword v10, v9, s[64:67], s48 offen sc1
    s_waitcnt vmcnt(0)
    v_cmp_u_f32 vcc, v10, v10
    s_cbranch_vccnz kf_grl
    s_cmp_gt_u32 s69, 388
    s_cbranch_scc1 kf_gok
    s_cmp_lg_u32 s72, 2
    s_cbranch_scc1 kf_gok
    s_cmp_lg_u32 s71, 0
    s_cbranch_scc1 kf_gok
    v_lshlrev_b32 v46, 13, v3
    v_lshl_add_u32 v46, v2, 3, v46
    buffer_store_dwordx2 v[44:45], v46, s[64:67], s45 offen sc1
    s_sub_u32 s45, s45, 32768
    s_branch kf_gok
kf_grf:
    s_cmp_eq_u32 s71, 0
    s_cselect_b32 s71, 2, s71
    v_mov_b32 v48, -1
    v_mov_b32 v49, -1
    v_mov_b32 v50, -1
    v_mov_b32 v51, -1
    s_mov_b32 s82, 28311552
    kf_gn:
    buffer_store_dwordx4 v[48:51], v8, s[64:67], s82 offen sc1
    s_add_u32 s82, s82, 1024
    s_cmp_lt_u32 s82, 28479488
    s_cbranch_scc1 kf_gn
    s_waitcnt vmcnt(0)
    s_add_u32 s28, s29, 28311552
    s_mov_b32 s43, 27262976
    s_mov_b32 s92, 27262976
    s_mov_b32 s93, 27262976
    s_mov_b32 s94, 27262976
    s_mov_b32 s95, 27262976
    s_branch kf_gok
cp1_f:
    s_mov_b32 s71, 2
    s_mov_b32 s82, 28311552
    cp1_n:
    buffer_store_dwordx4 v[156:159], v8, s[64:67], s82 offen sc1
    s_add_u32 s82, s82, 1024
    s_cmp_lt_u32 s82, 28327936
    s_cbranch_scc1 cp1_n
    s_waitcnt vmcnt(0)
    v_mov_b32 v24, v8
    v_mov_b32 v25, v8
    v_mov_b32 v26, v8
    v_mov_b32 v27, v8
    v_mov_b32 v28, v8
    s_mov_b32 s47, 28311552
    s_mov_b32 s77, 27262976
    s_branch cp1_ok
cp2_r:
    s_cmp_lg_u32 s70, 0
    s_cbranch_scc1 cp2_ok
cp2_l:
    s_cmp_eq_u32 s69, 0
    s_cbranch_scc1 cp2_f
    s_sub_u32 s69, s69, 1
    s_and_b32 s82, s69, 7
    s_cbranch_scc1 cp2_p
    s_mov_b64 exec, 0xffff
    buffer_store_dword v13, v12, s[64:67], s48 offen sc1
    s_mov_b64 exec, -1
    cp2_p:
    buffer_load_dword v31, v14, s[64:67], s60 offen sc1
    s_waitcnt vmcnt(0)
    v_cmp_gt_i32 vcc, 1, v31
    s_and_b32 s82, vcc_lo, 240
    s_cbranch_scc0 cp2_ok
    s_branch cp2_l
cp2_f:
    s_mov_b32 s71, 2
    s_mov_b32 s82, 28311552
    cp2_n:
    buffer_store_dwordx4 v[156:159], v8, s[64:67], s82 offen sc1
    s_add_u32 s82, s82, 1024
    s_cmp_lt_u32 s82, 28327936
    s_cbranch_scc1 cp2_n
    s_waitcnt vmcnt(0)
    v_mov_b32 v24, v8
    v_mov_b32 v25, v8
    v_mov_b32 v26, v8
    v_mov_b32 v27, v8
    v_mov_b32 v28, v8
    s_mov_b32 s47, 28311552
    s_mov_b32 s77, 27262976
    s_branch cp2_ok
cp3_r:
    s_cmp_lg_u32 s70, 0
    s_cbranch_scc1 cp3_ok
cp3_l:
    s_cmp_eq_u32 s69, 0
    s_cbranch_scc1 cp3_f
    s_sub_u32 s69, s69, 1
    s_and_b32 s82, s69, 7
    s_cbranch_scc1 cp3_p
    s_mov_b64 exec, 0xffff
    buffer_store_dword v13, v12, s[64:67], s48 offen sc1
    s_mov_b64 exec, -1
    cp3_p:
    buffer_load_dword v31, v14, s[64:67], s60 offen sc1
    s_waitcnt vmcnt(0)
    v_cmp_gt_i32 vcc, 1, v31
    s_and_b32 s82, vcc_lo, 65280
    s_cbranch_scc0 cp3_ok
    s_branch cp3_l
cp3_f:
    s_mov_b32 s71, 2
    s_mov_b32 s82, 28311552
    cp3_n:
    buffer_store_dwordx4 v[156:159], v8, s[64:67], s82 offen sc1
    s_add_u32 s82, s82, 1024
    s_cmp_lt_u32 s82, 28327936
    s_cbranch_scc1 cp3_n
    s_waitcnt vmcnt(0)
    v_mov_b32 v24, v8
    v_mov_b32 v25, v8
    v_mov_b32 v26, v8
    v_mov_b32 v27, v8
    v_mov_b32 v28, v8
    s_mov_b32 s47, 28311552
    s_mov_b32 s77, 27262976
    s_branch cp3_ok
cp4_r:
    s_cmp_lg_u32 s70, 0
    s_cbranch_scc1 cp4_ok
cp4_l:
    s_cmp_eq_u32 s69, 0
    s_cbranch_scc1 cp4_f
    s_sub_u32 s69, s69, 1
    s_and_b32 s82, s69, 7
    s_cbranch_scc1 cp4_p
    s_mov_b64 exec, 0xffff
    buffer_store_dword v13, v12, s[64:67], s48 offen sc1
    s_mov_b64 exec, -1
    cp4_p:
    buffer_load_dword v31, v14, s[64:67], s60 offen sc1
    s_waitcnt vmcnt(0)
    v_cmp_gt_i32 vcc, 2, v31
    s_cmp_lg_u64 vcc, 0
    s_cbranch_scc0 cp4_ok
    s_branch cp4_l
cp4_f:
    s_mov_b32 s71, 2
    s_mov_b32 s82, 28311552
    cp4_n:
    buffer_store_dwordx4 v[156:159], v8, s[64:67], s82 offen sc1
    s_add_u32 s82, s82, 1024
    s_cmp_lt_u32 s82, 28327936
    s_cbranch_scc1 cp4_n
    s_waitcnt vmcnt(0)
    v_mov_b32 v24, v8
    v_mov_b32 v25, v8
    v_mov_b32 v26, v8
    v_mov_b32 v27, v8
    v_mov_b32 v28, v8
    s_mov_b32 s47, 28311552
    s_mov_b32 s77, 27262976
    s_branch cp4_ok
k4_r0:
    s_cmp_lg_u32 s70, 0
    s_cbranch_scc1 k4_ok0
    s_cmp_eq_u32 s43, 27262976
    s_cbranch_scc1 k4_ok0
k4_r0l:
    s_cmp_eq_u32 s69, 0
    s_cbranch_scc1 k4_r0f
    s_sub_u32 s69, s69, 1
    buffer_load_dwordx4 v[112:115], v4, s[64:67], s88 offen offset:0 sc1
    buffer_load_dwordx4 v[116:119], v4, s[64:67], s89 offen offset:0 sc1
    buffer_load_dwordx4 v[120:123], v4, s[64:67], s90 offen offset:0 sc1
    buffer_load_dwordx4 v[124:127], v4, s[64:67], s91 offen offset:0 sc1
    s_waitcnt vmcnt(0)
    v_max3_u32 v16, v112, v116, v120
    v_max_u32 v16, v16, v124
    v_cmp_eq_u32 vcc, -1, v16
    s_cbranch_vccz k4_ok0
    s_branch k4_r0l
k4_r0f:
    s_cmp_eq_u32 s71, 0
    s_cselect_b32 s71, 2, s71
    s_branch k4_ok0
k4_r4:
    s_cmp_lg_u32 s70, 0
    s_cbranch_scc1 k4_ok4
    s_cmp_eq_u32 s43, 27262976
    s_cbranch_scc1 k4_ok4
k4_r4l:
    s_cmp_eq_u32 s69, 0
    s_cbranch_scc1 k4_r4f
    s_sub_u32 s69, s69, 1
    buffer_load_dwordx4 v[128:131], v4, s[64:67], s88 offen offset:1024 sc1
    buffer_load_dwordx4 v[132:135], v4, s[64:67], s89 offen offset:1024 sc1
    buffer_load_dwordx4 v[136:139], v4, s[64:67], s90 offen offset:1024 sc1
    buffer_load_dwordx4 v[140:143], v4, s[64:67], s91 offen offset:1024 sc1
    s_waitcnt vmcnt(0)
    v_max3_u32 v16, v128, v132, v136
    v_max_u32 v16, v16, v140
    v_cmp_eq_u32 vcc, -1, v16
    s_cbranch_vccz k4_ok4
    s_branch k4_r4l
k4_r4f:
    s_cmp_eq_u32 s71, 0
    s_cselect_b32 s71, 2, s71
    s_branch k4_ok4
k4_r8:
    s_cmp_lg_u32 s70, 0
    s_cbranch_scc1 k4_ok8
    s_cmp_eq_u32 s43, 27262976
    s_cbranch_scc1 k4_ok8
k4_r8l:
    s_cmp_eq_u32 s69, 0
    s_cbranch_scc1 k4_r8f
    s_sub_u32 s69, s69, 1
    buffer_load_dwordx4 v[176:179], v4, s[64:67], s88 offen offset:2048 sc1
    buffer_load_dwordx4 v[180:183], v4, s[64:67], s89 offen offset:2048 sc1
    buffer_load_dwordx4 v[184:187], v4, s[64:67], s90 offen offset:2048 sc1
    buffer_load_dwordx4 v[188:191], v4, s[64:67], s91 offen offset:2048 sc1
    s_waitcnt vmcnt(0)
    v_max3_u32 v16, v176, v180, v184
    v_max_u32 v16, v16, v188
    v_cmp_eq_u32 vcc, -1, v16
    s_cbranch_vccz k4_ok8
    s_branch k4_r8l
k4_r8f:
    s_cmp_eq_u32 s71, 0
    s_cselect_b32 s71, 2, s71
    s_branch k4_ok8
k4_r12:
    s_cmp_lg_u32 s70, 0
    s_cbranch_scc1 k4_ok12
    s_cmp_eq_u32 s43, 27262976
    s_cbranch_scc1 k4_ok12
k4_r12l:
    s_cmp_eq_u32 s69, 0
    s_cbranch_scc1 k4_r12f
    s_sub_u32 s69, s69, 1
    buffer_load_dwordx4 v[148:151], v5, s[64:67], s88 offen offset:0 sc1
    buffer_load_dwordx4 v[152:155], v5, s[64:67], s89 offen offset:0 sc1
    buffer_load_dwordx4 v[156:159], v5, s[64:67], s90 offen offset:0 sc1
    buffer_load_dwordx4 v[160:163], v5, s[64:67], s91 offen offset:0 sc1
    s_waitcnt vmcnt(0)
    v_max3_u32 v16, v148, v152, v156
    v_max_u32 v16, v16, v160
    v_cmp_eq_u32 vcc, -1, v16
    s_cbranch_vccz k4_ok12
    s_branch k4_r12l
k4_r12f:
    s_cmp_eq_u32 s71, 0
    s_cselect_b32 s71, 2, s71
    s_branch k4_ok12
k4_r16:
    s_cmp_lg_u32 s70, 0
    s_cbranch_scc1 k4_ok16
    s_cmp_eq_u32 s43, 27262976
    s_cbranch_scc1 k4_ok16
k4_r16l:
    s_cmp_eq_u32 s69, 0
    s_cbranch_scc1 k4_r16f
    s_sub_u32 s69, s69, 1
    buffer_load_dwordx4 v[164:167], v5, s[64:67], s88 offen offset:1024 sc1
    buffer_load_dwordx4 v[168:171], v5, s[64:67], s89 offen offset:1024 sc1
    buffer_load_dwordx4 v[172:175], v5, s[64:67], s90 offen offset:1024 sc1
    buffer_load_dwordx4 v[192:195], v5, s[64:67], s91 offen offset:1024 sc1
    s_waitcnt vmcnt(0)
    v_max3_u32 v16, v164, v168, v172
    v_max_u32 v16, v16, v192
    v_cmp_eq_u32 vcc, -1, v16
    s_cbranch_vccz k4_ok16
    s_branch k4_r16l
k4_r16f:
    s_cmp_eq_u32 s71, 0
    s_cselect_b32 s71, 2, s71
    s_branch k4_ok16
k4_r20:
    s_cmp_lg_u32 s70, 0
    s_cbranch_scc1 k4_ok20
    s_cmp_eq_u32 s43, 27262976
    s_cbranch_scc1 k4_ok20
k4_r20l:
    s_cmp_eq_u32 s69, 0
    s_cbranch_scc1 k4_r20f
    s_sub_u32 s69, s69, 1
    buffer_load_dwordx4 v[196:199], v5, s[64:67], s88 offen offset:2048 sc1
    buffer_load_dwordx4 v[200:203], v5, s[64:67], s89 offen offset:2048 sc1
    buffer_load_dwordx4 v[204:207], v5, s[64:67], s90 offen offset:2048 sc1
    buffer_load_dwordx4 v[208:211], v5, s[64:67], s91 offen offset:2048 sc1
    s_waitcnt vmcnt(0)
    v_max3_u32 v16, v196, v200, v204
    v_max_u32 v16, v16, v208
    v_cmp_eq_u32 vcc, -1, v16
    s_cbranch_vccz k4_ok20
    s_branch k4_r20l
k4_r20f:
    s_cmp_eq_u32 s71, 0
    s_cselect_b32 s71, 2, s71
    s_branch k4_ok20
k4_r24:
    s_cmp_lg_u32 s70, 0
    s_cbranch_scc1 k4_ok24
    s_cmp_eq_u32 s43, 27262976
    s_cbranch_scc1 k4_ok24
k4_r24l:
    s_cmp_eq_u32 s69, 0
    s_cbranch_scc1 k4_r24f
    s_sub_u32 s69, s69, 1
    buffer_load_dwordx4 v[212:215], v6, s[64:67], s88 offen offset:0 sc1
    buffer_load_dwordx4 v[216:219], v6, s[64:67], s89 offen offset:0 sc1
    buffer_load_dwordx4 v[220:223], v6, s[64:67], s90 offen offset:0 sc1
    buffer_load_dwordx4 v[144:147], v6, s[64:67], s91 offen offset:0 sc1
    s_waitcnt vmcnt(0)
    v_max3_u32 v16, v212, v216, v220
    v_max_u32 v16, v16, v144
    v_cmp_eq_u32 vcc, -1, v16
    s_cbranch_vccz k4_ok24
    s_branch k4_r24l
k4_r24f:
    s_cmp_eq_u32 s71, 0
    s_cselect_b32 s71, 2, s71
    s_branch k4_ok24
k4_r28:
    s_cmp_lg_u32 s70, 0
    s_cbranch_scc1 k4_ok28
    s_cmp_eq_u32 s43, 27262976
    s_cbranch_scc1 k4_ok28
k4_r28l:
    s_cmp_eq_u32 s69, 0
    s_cbranch_scc1 k4_r28f
    s_sub_u32 s69, s69, 1
    buffer_load_dwordx4 v[224:227], v6, s[64:67], s88 offen offset:1024 sc1
    buffer_load_dwordx4 v[228:231], v6, s[64:67], s89 offen offset:1024 sc1
    buffer_load_dwordx4 v[232:235], v6, s[64:67], s90 offen offset:1024 sc1
    buffer_load_dwordx4 v[236:239], v6, s[64:67], s91 offen offset:1024 sc1
    s_waitcnt vmcnt(0)
    v_max3_u32 v16, v224, v228, v232
    v_max_u32 v16, v16, v236
    v_cmp_eq_u32 vcc, -1, v16
    s_cbranch_vccz k4_ok28
    s_branch k4_r28l
k4_r28f:
    s_cmp_eq_u32 s71, 0
    s_cselect_b32 s71, 2, s71
    s_branch k4_ok28
k4_r32:
    s_cmp_lg_u32 s70, 0
    s_cbranch_scc1 k4_ok32
    s_cmp_eq_u32 s43, 27262976
    s_cbranch_scc1 k4_ok32
k4_r32l:
    s_cmp_eq_u32 s69, 0
    s_cbranch_scc1 k4_r32f
    s_sub_u32 s69, s69, 1
    buffer_load_dwordx4 v[240:243], v6, s[64:67], s88 offen offset:2048 sc1
    buffer_load_dwordx4 v[244:247], v6, s[64:67], s89 offen offset:2048 sc1
    buffer_load_dwordx4 v[248:251], v6, s[64:67], s90 offen offset:2048 sc1
    buffer_load_dwordx4 v[252:255], v6, s[64:67], s91 offen offset:2048 sc1
    s_waitcnt vmcnt(0)
    v_max3_u32 v16, v240, v244, v248
    v_max_u32 v16, v16, v252
    v_cmp_eq_u32 vcc, -1, v16
    s_cbranch_vccz k4_ok32
    s_branch k4_r32l
k4_r32f:
    s_cmp_eq_u32 s71, 0
    s_cselect_b32 s71, 2, s71
    s_branch k4_ok32
k4_r36:
    s_cmp_lg_u32 s70, 0
    s_cbranch_scc1 k4_ok36
    s_cmp_eq_u32 s43, 27262976
    s_cbranch_scc1 k4_ok36
k4_r36l:
    s_cmp_eq_u32 s69, 0
    s_cbranch_scc1 k4_r36f
    s_sub_u32 s69, s69, 1
    buffer_load_dwordx4 v[112:115], v7, s[64:67], s88 offen offset:0 sc1
    buffer_load_dwordx4 v[116:119], v7, s[64:67], s89 offen offset:0 sc1
    buffer_load_dwordx4 v[120:123], v7, s[64:67], s90 offen offset:0 sc1
    buffer_load_dwordx4 v[124:127], v7, s[64:67], s91 offen offset:0 sc1
    s_waitcnt vmcnt(0)
    v_max3_u32 v16, v112, v116, v120
    v_max_u32 v16, v16, v124
    v_cmp_eq_u32 vcc, -1, v16
    s_cbranch_vccz k4_ok36
    s_branch k4_r36l
k4_r36f:
    s_cmp_eq_u32 s71, 0
    s_cselect_b32 s71, 2, s71
    s_branch k4_ok36
k4_r40:
    s_cmp_lg_u32 s70, 0
    s_cbranch_scc1 k4_ok40
    s_cmp_eq_u32 s43, 27262976
    s_cbranch_scc1 k4_ok40
k4_r40l:
    s_cmp_eq_u32 s69, 0
    s_cbranch_scc1 k4_r40f
    s_sub_u32 s69, s69, 1
    buffer_load_dwordx4 v[128:131], v7, s[64:67], s88 offen offset:1024 sc1
    buffer_load_dwordx4 v[132:135], v7, s[64:67], s89 offen offset:1024 sc1
    buffer_load_dwordx4 v[136:139], v7, s[64:67], s90 offen offset:1024 sc1
    buffer_load_dwordx4 v[140:143], v7, s[64:67], s91 offen offset:1024 sc1
    s_waitcnt vmcnt(0)
    v_max3_u32 v16, v128, v132, v136
    v_max_u32 v16, v16, v140
    v_cmp_eq_u32 vcc, -1, v16
    s_cbranch_vccz k4_ok40
    s_branch k4_r40l
k4_r40f:
    s_cmp_eq_u32 s71, 0
    s_cselect_b32 s71, 2, s71
    s_branch k4_ok40
k4_r44:
    s_cmp_lg_u32 s70, 0
    s_cbranch_scc1 k4_ok44
    s_cmp_eq_u32 s43, 27262976
    s_cbranch_scc1 k4_ok44
k4_r44l:
    s_cmp_eq_u32 s69, 0
    s_cbranch_scc1 k4_r44f
    s_sub_u32 s69, s69, 1
    buffer_load_dwordx4 v[176:179], v7, s[64:67], s88 offen offset:2048 sc1
    buffer_load_dwordx4 v[180:183], v7, s[64:67], s89 offen offset:2048 sc1
    buffer_load_dwordx4 v[184:187], v7, s[64:67], s90 offen offset:2048 sc1
    buffer_load_dwordx4 v[188:191], v7, s[64:67], s91 offen offset:2048 sc1
    s_waitcnt vmcnt(0)
    v_max3_u32 v16, v176, v180, v184
    v_max_u32 v16, v16, v188
    v_cmp_eq_u32 vcc, -1, v16
    s_cbranch_vccz k4_ok44
    s_branch k4_r44l
k4_r44f:
    s_cmp_eq_u32 s71, 0
    s_cselect_b32 s71, 2, s71
    s_branch k4_ok44
kf_more:
    s_waitcnt vmcnt(0) lgkmcnt(0)
    s_barrier
    s_cmp_lg_u32 s70, 0
    s_cbranch_scc1 kf_p3
    s_bitcmp1_b32 s22, 1
    s_cbranch_scc1 kf_priv
    s_cmp_eq_u32 s72, 0
    s_cbranch_scc1 kf_priv
    s_sub_u32 s72, s72, 1
    s_mov_b32 s71, 0
    s_mov_b32 s69, 400
k3_gen:
    s_mul_i32 s22, s73, 12
    s_add_u32 s22, s22, s16
    s_mul_i32 s77, s22, 20480
    s_add_u32 s77, s77, 16777216
    s_add_u32 s83, s77, 0
    buffer_load_dwordx4 v[112:115], v8, s[64:67], s83 offen offset:0
    s_add_u32 s83, s77, 81920
    buffer_load_dwordx4 v[116:119], v8, s[64:67], s83 offen offset:0
    s_add_u32 s83, s77, 163840
    buffer_load_dwordx4 v[120:123], v8, s[64:67], s83 offen offset:0
    s_add_u32 s83, s77, 0
    buffer_load_dwordx4 v[124:127], v8, s[64:67], s83 offen offset:1024
    s_add_u32 s83, s77, 81920
    buffer_load_dwordx4 v[128:131], v8, s[64:67], s83 offen offset:1024
    s_add_u32 s83, s77, 163840
    buffer_load_dwordx4 v[132:135], v8, s[64:67], s83 offen offset:1024
    s_add_u32 s83, s77, 0
    buffer_load_dwordx4 v[136:139], v8, s[64:67], s83 offen offset:2048
    s_add_u32 s83, s77, 81920
    buffer_load_dwordx4 v[140:143], v8, s[64:67], s83 offen offset:2048
    s_add_u32 s83, s77, 163840
    buffer_load_dwordx4 v[176:179], v8, s[64:67], s83 offen offset:2048
    s_add_u32 s83, s77, 0
    buffer_load_dwordx4 v[180:183], v8, s[64:67], s83 offen offset:3072
    s_add_u32 s83, s77, 81920
    buffer_load_dwordx4 v[184:187], v8, s[64:67], s83 offen offset:3072
    s_add_u32 s83, s77, 163840
    buffer_load_dwordx4 v[188:191], v8, s[64:67], s83 offen offset:3072
    s_add_u32 s83, s77, 4096
    buffer_load_dwordx4 a[252:255], v8, s[64:67], s83 offen offset:0
    s_add_u32 s83, s77, 86016
    buffer_load_dwordx4 a[0:3], v8, s[64:67], s83 offen offset:0
    s_add_u32 s83, s77, 167936
    buffer_load_dwordx4 a[16:19], v8, s[64:67], s83 offen offset:0
    s_add_u32 s83, s77, 4096
    buffer_load_dwordx4 a[32:35], v8, s[64:67], s83 offen offset:1024
    s_add_u32 s83, s77, 86016
    buffer_load_dwordx4 a[48:51], v8, s[64:67], s83 offen offset:1024
    s_add_u32 s83, s77, 167936
    buffer_load_dwordx4 a[64:67], v8, s[64:67], s83 offen offset:1024
    s_add_u32 s83, s77, 4096
    buffer_load_dwordx4 a[4:7], v8, s[64:67], s83 offen offset:2048
    s_add_u32 s83, s77, 86016
    buffer_load_dwordx4 a[20:23], v8, s[64:67], s83 offen offset:2048
    s_add_u32 s83, s77, 167936
    buffer_load_dwordx4 a[36:39], v8, s[64:67], s83 offen offset:2048
    s_add_u32 s83, s77, 4096
    buffer_load_dwordx4 a[52:55], v8, s[64:67], s83 offen offset:3072
    s_add_u32 s83, s77, 86016
    buffer_load_dwordx4 a[68:71], v8, s[64:67], s83 offen offset:3072
    s_add_u32 s83, s77, 167936
    buffer_load_dwordx4 a[8:11], v8, s[64:67], s83 offen offset:3072
    s_add_u32 s83, s77, 8192
    buffer_load_dwordx4 a[24:27], v8, s[64:67], s83 offen offset:0
    s_add_u32 s83, s77, 90112
    buffer_load_dwordx4 a[40:43], v8, s[64:67], s83 offen offset:0
    s_add_u32 s83, s77, 172032
    buffer_load_dwordx4 a[56:59], v8, s[64:67], s83 offen offset:0
    s_add_u32 s83, s77, 8192
    buffer_load_dwordx4 a[72:75], v8, s[64:67], s83 offen offset:1024
    s_add_u32 s83, s77, 90112
    buffer_load_dwordx4 a[12:15], v8, s[64:67], s83 offen offset:1024
    s_add_u32 s83, s77, 172032
    buffer_load_dwordx4 a[28:31], v8, s[64:67], s83 offen offset:1024
    s_add_u32 s83, s77, 8192
    buffer_load_dwordx4 a[44:47], v8, s[64:67], s83 offen offset:2048
    s_add_u32 s83, s77, 90112
    buffer_load_dwordx4 a[60:63], v8, s[64:67], s83 offen offset:2048
    s_add_u32 s83, s77, 172032
    buffer_load_dwordx4 a[76:79], v8, s[64:67], s83 offen offset:2048
    s_add_u32 s83, s77, 8192
    buffer_load_dwordx4 a[80:83], v8, s[64:67], s83 offen offset:3072
    s_add_u32 s83, s77, 90112
    buffer_load_dwordx4 a[96:99], v8, s[64:67], s83 offen offset:3072
    s_add_u32 s83, s77, 172032
    buffer_load_dwordx4 a[112:115], v8, s[64:67], s83 offen offset:3072
    s_add_u32 s83, s77, 12288
    buffer_load_dwordx4 a[128:131], v8, s[64:67], s83 offen offset:0
    s_add_u32 s83, s77, 94208
    buffer_load_dwordx4 a[144:147], v8, s[64:67], s83 offen offset:0
    s_add_u32 s83, s77, 176128
    buffer_load_dwordx4 a[84:87], v8, s[64:67], s83 offen offset:0
    s_add_u32 s83, s77, 12288
    buffer_load_dwordx4 a[100:103], v8, s[64:67], s83 offen offset:1024
    s_add_u32 s83, s77, 94208
    buffer_load_dwordx4 a[116:119], v8, s[64:67], s83 offen offset:1024
    s_add_u32 s83, s77, 176128
    buffer_load_dwordx4 a[132:135], v8, s[64:67], s83 offen offset:1024
    s_add_u32 s83, s77, 12288
    buffer_load_dwordx4 a[148:151], v8, s[64:67], s83 offen offset:2048
    s_add_u32 s83, s77, 94208
    buffer_load_dwordx4 a[88:91], v8, s[64:67], s83 offen offset:2048
    s_add_u32 s83, s77, 176128
    buffer_load_dwordx4 v[144:147], v8, s[64:67], s83 offen offset:2048
    s_add_u32 s83, s77, 12288
    buffer_load_dwordx4 v[148:151], v8, s[64:67], s83 offen offset:3072
    s_add_u32 s83, s77, 94208
    buffer_load_dwordx4 v[152:155], v8, s[64:67], s83 offen offset:3072
    s_add_u32 s83, s77, 176128
    buffer_load_dwordx4 v[156:159], v8, s[64:67], s83 offen offset:3072
    s_add_u32 s83, s77, 16384
    buffer_load_dwordx4 v[160:163], v8, s[64:67], s83 offen offset:0
    s_add_u32 s83, s77, 98304
    buffer_load_dwordx4 v[164:167], v8, s[64:67], s83 offen offset:0
    s_add_u32 s83, s77, 180224
    buffer_load_dwordx4 v[168:171], v8, s[64:67], s83 offen offset:0
    s_add_u32 s83, s77, 16384
    buffer_load_dwordx4 v[172:175], v8, s[64:67], s83 offen offset:1024
    s_add_u32 s83, s77, 98304
    buffer_load_dwordx4 v[192:195], v8, s[64:67], s83 offen offset:1024
    s_add_u32 s83, s77, 180224
    buffer_load_dwordx4 v[196:199], v8, s[64:67], s83 offen offset:1024
    s_add_u32 s83, s77, 16384
    buffer_load_dwordx4 v[200:203], v8, s[64:67], s83 offen offset:2048
    s_add_u32 s83, s77, 98304
    buffer_load_dwordx4 v[204:207], v8, s[64:67], s83 offen offset:2048
    s_add_u32 s83, s77, 180224
    buffer_load_dwordx4 v[208:211], v8, s[64:67], s83 offen offset:2048
    s_add_u32 s83, s77, 16384
    buffer_load_dwordx4 v[212:215], v8, s[64:67], s83 offen offset:3072
    s_add_u32 s83, s77, 98304
    buffer_load_dwordx4 v[216:219], v8, s[64:67], s83 offen offset:3072
    s_add_u32 s83, s77, 180224
    buffer_load_dwordx4 v[220:223], v8, s[64:67], s83 offen offset:3072
    s_waitcnt vmcnt(0)
    s_branch kf_gate
kf_priv:
    s_mov_b32 s70, 1
    s_mul_i32 s74, s76, 11534336
    s_add_u32 s74, s74, 52428800
    s_mov_b32 s71, 0
    s_mov_b32 s69, 0
    s_mov_b32 s72, 0
kf_p2:
    s_mov_b32 s23, s72
    s_cmp_lt_u32 s72, 256
    s_cbranch_scc1 k1_body
    s_and_b32 s23, s2, 0x1e
    s_and_b32 s22, s72, 1
    s_or_b32 s23, s23, s22
    s_bfe_u32 s22, s72, 0x30001
    s_lshl_b32 s22, s22, 5
    s_or_b32 s23, s23, s22
    s_branch k1_body
k1_priv:
    s_branch cp1_ok
k1_priv2:
    s_cmp_ge_u32 s72, 256
    s_cbranch_scc1 k1_go
    s_branch k2_pvd
k2_priv:
    s_waitcnt vmcnt(0)
    s_andn2_b32 s68, s63, 8192
    s_add_u32 s68, s68, 4096
    s_cmp_lg_u32 s17, 0
    s_cbranch_scc1 k2_pv1
    buffer_store_dwordx4 v[144:147], v8, s[64:67], s68 offen offset:0 sc1
    buffer_store_dwordx4 v[148:151], v8, s[64:67], s68 offen offset:1024 sc1
    buffer_store_dwordx2 v[152:153], v7, s[64:67], s68 offen offset:2048 sc1
    s_branch k2_pvd
k2_pv1:
    v_lshlrev_b32 v232, 16, v72
    v_and_b32 v233, 0xffff0000, v72
    v_lshlrev_b32 v234, 16, v73
    v_and_b32 v235, 0xffff0000, v73
    v_pk_add_f32 v[232:233], v[212:213], v[232:233] neg_lo:[0,1] neg_hi:[0,1]
    v_pk_add_f32 v[234:235], v[214:215], v[234:235] neg_lo:[0,1] neg_hi:[0,1]
    v_cvt_pk_bf16_f32 v236, v232, v233
    v_cvt_pk_bf16_f32 v237, v234, v235
    v_lshlrev_b32 v232, 16, v236
    v_and_b32 v233, 0xffff0000, v236
    v_lshlrev_b32 v234, 16, v237
    v_and_b32 v235, 0xffff0000, v237
    v_pk_fma_f32 v[232:233], v[232:233], v[168:169], v[192:193]
    v_pk_fma_f32 v[234:235], v[234:235], v[168:169], v[194:195]
    v_cvt_pk_bf16_f32 v32, v232, v233
    v_cvt_pk_bf16_f32 v33, v234, v235
    buffer_store_dwordx2 v[32:33], v7, s[64:67], s62 offen offset:0 sc1
    v_lshlrev_b32 v240, 16, v74
    v_and_b32 v241, 0xffff0000, v74
    v_lshlrev_b32 v242, 16, v75
    v_and_b32 v243, 0xffff0000, v75
    v_pk_add_f32 v[240:241], v[216:217], v[240:241] neg_lo:[0,1] neg_hi:[0,1]
    v_pk_add_f32 v[242:243], v[218:219], v[242:243] neg_lo:[0,1] neg_hi:[0,1]
    v_cvt_pk_bf16_f32 v244, v240, v241
    v_cvt_pk_bf16_f32 v245, v242, v243
    v_lshlrev_b32 v240, 16, v244
    v_and_b32 v241, 0xffff0000, v244
    v_lshlrev_b32 v242, 16, v245
    v_and_b32 v243, 0xffff0000, v245
    v_pk_fma_f32 v[240:241], v[240:241], v[168:169], v[196:197]
    v_pk_fma_f32 v[242:243], v[242:243], v[168:169], v[198:199]
    v_cvt_pk_bf16_f32 v34, v240, v241
    v_cvt_pk_bf16_f32 v35, v242, v243
    buffer_store_dwordx2 v[34:35], v7, s[64:67], s62 offen offset:512 sc1
    v_lshlrev_b32 v232, 16, v76
    v_and_b32 v233, 0xffff0000, v76
    v_lshlrev_b32 v234, 16, v77
    v_and_b32 v235, 0xffff0000, v77
    v_pk_add_f32 v[232:233], v[220:221], v[232:233] neg_lo:[0,1] neg_hi:[0,1]
    v_pk_add_f32 v[234:235], v[222:223], v[234:235] neg_lo:[0,1] neg_hi:[0,1]
    v_cvt_pk_bf16_f32 v236, v232, v233
    v_cvt_pk_bf16_f32 v237, v234, v235
    v_lshlrev_b32 v232, 16, v236
    v_and_b32 v233, 0xffff0000, v236
    v_lshlrev_b32 v234, 16, v237
    v_and_b32 v235, 0xffff0000, v237
    v_pk_fma_f32 v[232:233], v[232:233], v[168:169], v[200:201]
    v_pk_fma_f32 v[234:235], v[234:235], v[168:169], v[202:203]
    v_cvt_pk_bf16_f32 v36, v232, v233
    v_cvt_pk_bf16_f32 v37, v234, v235
    buffer_store_dwordx2 v[36:37], v7, s[64:67], s62 offen offset:1024 sc1
    v_lshlrev_b32 v240, 16, v78
    v_and_b32 v241, 0xffff0000, v78
    v_lshlrev_b32 v242, 16, v79
    v_and_b32 v243, 0xffff0000, v79
    v_pk_add_f32 v[240:241], v[224:225], v[240:241] neg_lo:[0,1] neg_hi:[0,1]
    v_pk_add_f32 v[242:243], v[226:227], v[242:243] neg_lo:[0,1] neg_hi:[0,1]
    v_cvt_pk_bf16_f32 v244, v240, v241
    v_cvt_pk_bf16_f32 v245, v242, v243
    v_lshlrev_b32 v240, 16, v244
    v_and_b32 v241, 0xffff0000, v244
    v_lshlrev_b32 v242, 16, v245
    v_and_b32 v243, 0xffff0000, v245
    v_pk_fma_f32 v[240:241], v[240:241], v[168:169], v[204:205]
    v_pk_fma_f32 v[242:243], v[242:243], v[168:169], v[206:207]
    v_cvt_pk_bf16_f32 v38, v240, v241
    v_cvt_pk_bf16_f32 v39, v242, v243
    buffer_store_dwordx2 v[38:39], v7, s[64:67], s62 offen offset:1536 sc1
    v_lshlrev_b32 v232, 16, v80
    v_and_b32 v233, 0xffff0000, v80
    v_lshlrev_b32 v234, 16, v81
    v_and_b32 v235, 0xffff0000, v81
    v_pk_add_f32 v[232:233], v[228:229], v[232:233] neg_lo:[0,1] neg_hi:[0,1]
    v_pk_add_f32 v[234:235], v[230:231], v[234:235] neg_lo:[0,1] neg_hi:[0,1]
    v_cvt_pk_bf16_f32 v236, v232, v233
    v_cvt_pk_bf16_f32 v237, v234, v235
    v_lshlrev_b32 v232, 16, v236
    v_and_b32 v233, 0xffff0000, v236
    v_lshlrev_b32 v234, 16, v237
    v_and_b32 v235, 0xffff0000, v237
    v_pk_fma_f32 v[232:233], v[232:233], v[168:169], v[208:209]
    v_pk_fma_f32 v[234:235], v[234:235], v[168:169], v[210:211]
    v_cvt_pk_bf16_f32 v40, v232, v233
    v_cvt_pk_bf16_f32 v41, v234, v235
    buffer_store_dwordx2 v[40:41], v7, s[64:67], s62 offen offset:2048 sc1
    v_mov_b32 v44, 0
    v_mov_b32 v45, 0
    s_mov_b32 s23, 0x3f803f80
    v_dot2_f32_bf16 v44, v32, s23, v44
    v_dot2_f32_bf16 v45, v32, v32, v45
    v_dot2_f32_bf16 v44, v33, s23, v44
    v_dot2_f32_bf16 v45, v33, v33, v45
    v_dot2_f32_bf16 v44, v34, s23, v44
    v_dot2_f32_bf16 v45, v34, v34, v45
    v_dot2_f32_bf16 v44, v35, s23, v44
    v_dot2_f32_bf16 v45, v35, v35, v45
    v_dot2_f32_bf16 v44, v36, s23, v44
    v_dot2_f32_bf16 v45, v36, v36, v45
    v_dot2_f32_bf16 v44, v37, s23, v44
    v_dot2_f32_bf16 v45, v37, v37, v45
    v_dot2_f32_bf16 v44, v38, s23, v44
    v_dot2_f32_bf16 v45, v38, v38, v45
    v_dot2_f32_bf16 v44, v39, s23, v44
    v_dot2_f32_bf16 v45, v39, v39, v45
    v_dot2_f32_bf16 v44, v40, s23, v44
    v_dot2_f32_bf16 v45, v40, v40, v45
    v_dot2_f32_bf16 v44, v41, s23, v44
    v_dot2_f32_bf16 v45, v41, v41, v45
    s_nop 3
    v_mov_b32 v46, v44
    v_mov_b32 v47, v45
    s_nop 1
    v_permlane16_swap_b32 v44, v46
    v_permlane16_swap_b32 v45, v47
    s_nop 1
    v_add_f32 v44, v44, v46
    v_add_f32 v45, v45, v47
    s_nop 3
    v_mov_b32 v46, v44
    v_mov_b32 v47, v45
    s_nop 1
    v_permlane32_swap_b32 v44, v46
    v_permlane32_swap_b32 v45, v47
    s_nop 1
    v_add_f32 v44, v44, v46
    v_add_f32 v45, v45, v47
    s_mov_b32 exec_hi, 0
    buffer_store_dwordx2 v[44:45], v10, s[64:67], s45 offen sc1
    s_mov_b64 exec, -1
    s_xor_b32 s21, s21, 1
    s_mul_i32 s44, s21, 20480
    s_mul_i32 s62, s20, 2560
    s_add_u32 s62, s62, s44
    s_add_u32 s62, s62, s74
    s_mul_i32 s22, s20, 160
    s_add_u32 s44, s44, s22
    s_and_b32 s45, s21, 7
    s_lshl_b32 s45, s45, 7
    s_lshl_b32 s22, s20, 10
    s_add_u32 s45, s45, s22
    s_lshl_b32 s22, s19, 17
    s_add_u32 s45, s45, s22
    s_add_u32 s45, s45, s74
    s_add_u32 s45, s45, 9437184
    buffer_load_dwordx4 v[72:75], v8, s[64:67], s68 offen offset:0 sc1
    buffer_load_dwordx4 v[76:79], v8, s[64:67], s68 offen offset:1024 sc1
    buffer_load_dwordx2 v[80:81], v7, s[64:67], s68 offen offset:2048 sc1
    buffer_load_dwordx2 a[240:241], v11, s[24:27], s44 offen offset:0
    buffer_load_dwordx2 a[242:243], v11, s[24:27], s44 offen offset:32
    buffer_load_dwordx2 a[244:245], v11, s[24:27], s44 offen offset:64
    buffer_load_dwordx2 a[246:247], v11, s[24:27], s44 offen offset:96
    buffer_load_dwordx2 a[248:249], v11, s[24:27], s44 offen offset:128
    s_waitcnt vmcnt(0)
    v_accvgpr_read_b32 v156, a240
    v_accvgpr_read_b32 v157, a241
    v_accvgpr_read_b32 v158, a242
    v_accvgpr_read_b32 v159, a243
    v_accvgpr_read_b32 v160, a244
    v_accvgpr_read_b32 v161, a245
    v_accvgpr_read_b32 v162, a246
    v_accvgpr_read_b32 v163, a247
    v_accvgpr_read_b32 v164, a248
    v_accvgpr_read_b32 v165, a249
    v_lshlrev_b32 v192, 16, v156
    v_and_b32 v193, 0xffff0000, v156
    v_lshlrev_b32 v194, 16, v157
    v_and_b32 v195, 0xffff0000, v157
    v_lshlrev_b32 v196, 16, v158
    v_and_b32 v197, 0xffff0000, v158
    v_lshlrev_b32 v198, 16, v159
    v_and_b32 v199, 0xffff0000, v159
    v_lshlrev_b32 v200, 16, v160
    v_and_b32 v201, 0xffff0000, v160
    v_lshlrev_b32 v202, 16, v161
    v_and_b32 v203, 0xffff0000, v161
    v_lshlrev_b32 v204, 16, v162
    v_and_b32 v205, 0xffff0000, v162
    v_lshlrev_b32 v206, 16, v163
    v_and_b32 v207, 0xffff0000, v163
    v_lshlrev_b32 v208, 16, v164
    v_and_b32 v209, 0xffff0000, v164
    v_lshlrev_b32 v210, 16, v165
    v_and_b32 v211, 0xffff0000, v165
    v_lshlrev_b32 v212, 16, v16
    v_and_b32 v213, 0xffff0000, v16
    v_lshlrev_b32 v214, 16, v17
    v_and_b32 v215, 0xffff0000, v17
    v_lshlrev_b32 v216, 16, v18
    v_and_b32 v217, 0xffff0000, v18
    v_lshlrev_b32 v218, 16, v19
    v_and_b32 v219, 0xffff0000, v19
    v_lshlrev_b32 v220, 16, v20
    v_and_b32 v221, 0xffff0000, v20
    v_lshlrev_b32 v222, 16, v21
    v_and_b32 v223, 0xffff0000, v21
    v_lshlrev_b32 v224, 16, v22
    v_and_b32 v225, 0xffff0000, v22
    v_lshlrev_b32 v226, 16, v23
    v_and_b32 v227, 0xffff0000, v23
    v_lshlrev_b32 v228, 16, v24
    v_and_b32 v229, 0xffff0000, v24
    v_lshlrev_b32 v230, 16, v25
    v_and_b32 v231, 0xffff0000, v25
    v_lshlrev_b32 v232, 16, v72
    v_and_b32 v233, 0xffff0000, v72
    v_lshlrev_b32 v234, 16, v73
    v_and_b32 v235, 0xffff0000, v73
    v_pk_add_f32 v[232:233], v[212:213], v[232:233] neg_lo:[0,1] neg_hi:[0,1]
    v_pk_add_f32 v[234:235], v[214:215], v[234:235] neg_lo:[0,1] neg_hi:[0,1]
    v_cvt_pk_bf16_f32 v236, v232, v233
    v_cvt_pk_bf16_f32 v237, v234, v235
    v_lshlrev_b32 v232, 16, v236
    v_and_b32 v233, 0xffff0000, v236
    v_lshlrev_b32 v234, 16, v237
    v_and_b32 v235, 0xffff0000, v237
    v_pk_fma_f32 v[232:233], v[232:233], v[168:169], v[192:193]
    v_pk_fma_f32 v[234:235], v[234:235], v[168:169], v[194:195]
    v_cvt_pk_bf16_f32 v32, v232, v233
    v_cvt_pk_bf16_f32 v33, v234, v235
    buffer_store_dwordx2 v[32:33], v7, s[64:67], s62 offen offset:0 sc1
    v_lshlrev_b32 v240, 16, v74
    v_and_b32 v241, 0xffff0000, v74
    v_lshlrev_b32 v242, 16, v75
    v_and_b32 v243, 0xffff0000, v75
    v_pk_add_f32 v[240:241], v[216:217], v[240:241] neg_lo:[0,1] neg_hi:[0,1]
    v_pk_add_f32 v[242:243], v[218:219], v[242:243] neg_lo:[0,1] neg_hi:[0,1]
    v_cvt_pk_bf16_f32 v244, v240, v241
    v_cvt_pk_bf16_f32 v245, v242, v243
    v_lshlrev_b32 v240, 16, v244
    v_and_b32 v241, 0xffff0000, v244
    v_lshlrev_b32 v242, 16, v245
    v_and_b32 v243, 0xffff0000, v245
    v_pk_fma_f32 v[240:241], v[240:241], v[168:169], v[196:197]
    v_pk_fma_f32 v[242:243], v[242:243], v[168:169], v[198:199]
    v_cvt_pk_bf16_f32 v34, v240, v241
    v_cvt_pk_bf16_f32 v35, v242, v243
    buffer_store_dwordx2 v[34:35], v7, s[64:67], s62 offen offset:512 sc1
    v_lshlrev_b32 v232, 16, v76
    v_and_b32 v233, 0xffff0000, v76
    v_lshlrev_b32 v234, 16, v77
    v_and_b32 v235, 0xffff0000, v77
    v_pk_add_f32 v[232:233], v[220:221], v[232:233] neg_lo:[0,1] neg_hi:[0,1]
    v_pk_add_f32 v[234:235], v[222:223], v[234:235] neg_lo:[0,1] neg_hi:[0,1]
    v_cvt_pk_bf16_f32 v236, v232, v233
    v_cvt_pk_bf16_f32 v237, v234, v235
    v_lshlrev_b32 v232, 16, v236
    v_and_b32 v233, 0xffff0000, v236
    v_lshlrev_b32 v234, 16, v237
    v_and_b32 v235, 0xffff0000, v237
    v_pk_fma_f32 v[232:233], v[232:233], v[168:169], v[200:201]
    v_pk_fma_f32 v[234:235], v[234:235], v[168:169], v[202:203]
    v_cvt_pk_bf16_f32 v36, v232, v233
    v_cvt_pk_bf16_f32 v37, v234, v235
    buffer_store_dwordx2 v[36:37], v7, s[64:67], s62 offen offset:1024 sc1
    v_lshlrev_b32 v240, 16, v78
    v_and_b32 v241, 0xffff0000, v78
    v_lshlrev_b32 v242, 16, v79
    v_and_b32 v243, 0xffff0000, v79
    v_pk_add_f32 v[240:241], v[224:225], v[240:241] neg_lo:[0,1] neg_hi:[0,1]
    v_pk_add_f32 v[242:243], v[226:227], v[242:243] neg_lo:[0,1] neg_hi:[0,1]
    v_cvt_pk_bf16_f32 v244, v240, v241
    v_cvt_pk_bf16_f32 v245, v242, v243
    v_lshlrev_b32 v240, 16, v244
    v_and_b32 v241, 0xffff0000, v244
    v_lshlrev_b32 v242, 16, v245
    v_and_b32 v243, 0xffff0000, v245
    v_pk_fma_f32 v[240:241], v[240:241], v[168:169], v[204:205]
    v_pk_fma_f32 v[242:243], v[242:243], v[168:169], v[206:207]
    v_cvt_pk_bf16_f32 v38, v240, v241
    v_cvt_pk_bf16_f32 v39, v242, v243
    buffer_store_dwordx2 v[38:39], v7, s[64:67], s62 offen offset:1536 sc1
    v_lshlrev_b32 v232, 16, v80
    v_and_b32 v233, 0xffff0000, v80
    v_lshlrev_b32 v234, 16, v81
    v_and_b32 v235, 0xffff0000, v81
    v_pk_add_f32 v[232:233], v[228:229], v[232:233] neg_lo:[0,1] neg_hi:[0,1]
    v_pk_add_f32 v[234:235], v[230:231], v[234:235] neg_lo:[0,1] neg_hi:[0,1]
    v_cvt_pk_bf16_f32 v236, v232, v233
    v_cvt_pk_bf16_f32 v237, v234, v235
    v_lshlrev_b32 v232, 16, v236
    v_and_b32 v233, 0xffff0000, v236
    v_lshlrev_b32 v234, 16, v237
    v_and_b32 v235, 0xffff0000, v237
    v_pk_fma_f32 v[232:233], v[232:233], v[168:169], v[208:209]
    v_pk_fma_f32 v[234:235], v[234:235], v[168:169], v[210:211]
    v_cvt_pk_bf16_f32 v40, v232, v233
    v_cvt_pk_bf16_f32 v41, v234, v235
    buffer_store_dwordx2 v[40:41], v7, s[64:67], s62 offen offset:2048 sc1
    v_mov_b32 v44, 0
    v_mov_b32 v45, 0
    s_mov_b32 s23, 0x3f803f80
    v_dot2_f32_bf16 v44, v32, s23, v44
    v_dot2_f32_bf16 v45, v32, v32, v45
    v_dot2_f32_bf16 v44, v33, s23, v44
    v_dot2_f32_bf16 v45, v33, v33, v45
    v_dot2_f32_bf16 v44, v34, s23, v44
    v_dot2_f32_bf16 v45, v34, v34, v45
    v_dot2_f32_bf16 v44, v35, s23, v44
    v_dot2_f32_bf16 v45, v35, v35, v45
    v_dot2_f32_bf16 v44, v36, s23, v44
    v_dot2_f32_bf16 v45, v36, v36, v45
    v_dot2_f32_bf16 v44, v37, s23, v44
    v_dot2_f32_bf16 v45, v37, v37, v45
    v_dot2_f32_bf16 v44, v38, s23, v44
    v_dot2_f32_bf16 v45, v38, v38, v45
    v_dot2_f32_bf16 v44, v39, s23, v44
    v_dot2_f32_bf16 v45, v39, v39, v45
    v_dot2_f32_bf16 v44, v40, s23, v44
    v_dot2_f32_bf16 v45, v40, v40, v45
    v_dot2_f32_bf16 v44, v41, s23, v44
    v_dot2_f32_bf16 v45, v41, v41, v45
    s_nop 3
    v_mov_b32 v46, v44
    v_mov_b32 v47, v45
    s_nop 1
    v_permlane16_swap_b32 v44, v46
    v_permlane16_swap_b32 v45, v47
    s_nop 1
    v_add_f32 v44, v44, v46
    v_add_f32 v45, v45, v47
    s_nop 3
    v_mov_b32 v46, v44
    v_mov_b32 v47, v45
    s_nop 1
    v_permlane32_swap_b32 v44, v46
    v_permlane32_swap_b32 v45, v47
    s_nop 1
    v_add_f32 v44, v44, v46
    v_add_f32 v45, v45, v47
    s_mov_b32 exec_hi, 0
    buffer_store_dwordx2 v[44:45], v10, s[64:67], s45 offen sc1
    s_mov_b64 exec, -1
k2_pvd:
    s_waitcnt vmcnt(0) lgkmcnt(0)
    s_barrier
    s_add_u32 s72, s72, 1
    s_cmp_lt_u32 s72, 272
    s_cbranch_scc1 kf_p2
    s_mov_b32 s72, 0
kf_p3:
    s_cmp_eq_u32 s72, 17
    s_cbranch_scc1 kf_fin
    s_and_b32 s73, s72, 15
    s_add_u32 s72, s72, 1
    s_branch k3_gen
code_end:
.section .rodata,"a"
.p2align 6
.amdhsa_kernel kf_kernel
  .amdhsa_next_free_vgpr 512
  .amdhsa_next_free_sgpr 102
  .amdhsa_accum_offset 256
  .amdhsa_group_segment_fixed_size 0
  .amdhsa_kernarg_size 96
  .amdhsa_user_sgpr_count 2
  .amdhsa_user_sgpr_kernarg_segment_ptr 1
  .amdhsa_system_sgpr_workgroup_id_x 1
.end_amdhsa_kernel
```
